```python
import torch

def _softmax(x, axis=-1):
    return torch.softmax(x, dim=axis)
def _gelu(x):
    return torch.nn.functional.gelu(x, approximate="tanh")
def _silu(x):
    return torch.nn.functional.silu(x)
def _sigmoid(x):
    return torch.sigmoid(x)
def _layernorm(x, axis=-1, eps=1e-5):
    m = x.mean(dim=axis, keepdim=True)
    v = x.var(dim=axis, keepdim=True, unbiased=False)
    return (x - m) / torch.sqrt(v + eps)
def _scatter_add(tgt, idx, src, axis=0):
    return tgt.clone().index_add_(axis, idx, src)
def _segment_sum(src, seg, n):
    out = torch.zeros((n,) + src.shape[1:], dtype=src.dtype)
    return out.index_add_(0, seg, src)
def _pad(x, pw):
    flat = tuple(v for pair in reversed(pw) for v in pair)
    return torch.nn.functional.pad(x, flat)

kernel_name = 'parallel_sum__sliding_local_dilated__glu_gated_swiglu__prompt'

def setup_inputs():

    _w = (lambda a: (lambda t: t.to(torch.bfloat16) if t.is_floating_point() else t)(torch.as_tensor(a)))
    def _A_setup():
        B, S, D = 1, 2048, 576
        return {
            "x": _w((lambda *s: torch.randn(*s, dtype=torch.bfloat16) * 0.05)(B, S, D)),
            "wqkv": _w((lambda *s: torch.randn(*s, dtype=torch.bfloat16) * 0.05)(D, 3 * D)),
            "wo": _w((lambda *s: torch.randn(*s, dtype=torch.bfloat16) * 0.05)(D, D)),
        }
    _A_in = _A_setup()

    def _B_setup():
        B, S, D, F = 1, 2048, 576, 4608
        return {
            "x": _w((lambda *s: torch.randn(*s, dtype=torch.bfloat16) * 0.05)(B, S, D)),
            "w1": _w((lambda *s: torch.randn(*s, dtype=torch.bfloat16) * 0.8)(D, F) * (2.0 / D) ** 0.5),
            "w3": _w((lambda *s: torch.randn(*s, dtype=torch.bfloat16) * 0.8)(D, F) * (2.0 / D) ** 0.5),
            "w2": _w((lambda *s: torch.randn(*s, dtype=torch.bfloat16) * 0.8)(F, D) * (2.0 / F) ** 0.5),
        }
    _B_in = _B_setup()

    return {
        "A_x": _A_in["x"],
        "A_wqkv": _A_in["wqkv"],
        "A_wo": _A_in["wo"],
        "B_x": _B_in["x"],
        "B_w1": _B_in["w1"],
        "B_w3": _B_in["w3"],
        "B_w2": _B_in["w2"],
    }

def reference(A_x, A_wqkv, A_wo, B_x, B_w1, B_w3, B_w2):
    def _A_ref(x, wqkv, wo):
        B, S, D = x.shape
        H = 32; Dh = D // H
        W, dil = 8, 2
        qkv = (lambda x, *d: x.permute(*d))((x @ wqkv).reshape(B, S, 3, H, Dh), 2, 0, 3, 1, 4)
        q, k, v = qkv[0], qkv[1], qkv[2]
        scale = Dh ** -0.5
        pos = torch.arange(S)
        off = torch.arange(W) * dil
        idx = pos[:, None] - off[None, :]
        mask = idx >= 0
        idx_c = torch.where(mask, idx, 0).reshape(-1)
        kg = k[:, :, idx_c, :].reshape(B, H, S, W, Dh)
        vg = v[:, :, idx_c, :].reshape(B, H, S, W, Dh)
        logits = torch.einsum("bhsd,bhswd->bhsw", q, kg) * scale
        logits = torch.where(mask[None, None, :, :], logits, -1e9)
        attn = _softmax(logits, axis=-1)
        o = torch.einsum("bhsw,bhswd->bhsd", attn, vg)
        return (lambda x, *d: x.permute(*d))(o, 0, 2, 1, 3).reshape(B, S, D) @ wo

    def _B_ref(x, w1, w3, w2):
        gate = torch.einsum("bsd,df->bsf", x, w1)
        up = torch.einsum("bsd,df->bsf", x, w3)
        h = _silu(gate) * up
        out = torch.einsum("bsf,fd->bsd", h, w2)
        return out

    x = A_x
    xn = _layernorm(x, axis=-1)
    return x + _A_ref(xn, A_wqkv, A_wo) + _B_ref(xn, B_w1, B_w3, B_w2)
```

```asm
; @launch kernel=k0_ln_kernel grid=(256,1,1) block=(256,1,1) lds=0
; @launch kernel=km_main_kernel grid=(256,1,1) block=(512,1,1) lds=163840
.amdgcn_target "amdgcn-amd-amdhsa--gfx950"
.text
.globl k0_ln_kernel
.p2align 8
.type k0_ln_kernel,@function
k0_ln_kernel:
    s_cmp_ge_u32 s2, 256
    s_cbranch_scc1 K0_END
    s_load_dwordx2 s[4:5], s[0:1], 0
    s_load_dwordx2 s[6:7], s[0:1], 72
    s_load_dwordx4 s[24:27], s[0:1], 32
    s_load_dwordx2 s[36:37], s[0:1], 8
    v_lshrrev_b32 v1, 5, v0
    v_and_b32 v2, 31, v0
    s_lshl_b32 s3, s2, 3
    v_add_u32 v1, s3, v1
    v_mul_u32_u24 v3, 1152, v1
    v_lshl_add_u32 v3, v2, 4, v3
    s_mov_b32 s20, 0xff
    s_mov_b32 s21, 0xff
    s_mov_b32 s10, 0x240000
    s_mov_b32 s11, 0x00020000
    v_mov_b32 v16, 0
    v_mov_b32 v17, 0
    v_mov_b32 v18, 0
    v_mov_b32 v19, 0
    s_waitcnt lgkmcnt(0)
    s_mov_b32 s8, s4
    s_and_b32 s9, s5, 0xffff
    buffer_load_dwordx4 v[8:11], v3, s[8:11], 0 offen
    buffer_load_dwordx4 v[12:15], v3, s[8:11], 0 offen offset:512
    s_mov_b64 exec, s[20:21]
    buffer_load_dwordx4 v[16:19], v3, s[8:11], 0 offen offset:1024
    s_mov_b64 exec, -1
    s_and_b32 s40, s2, 7
    s_lshr_b32 s41, s2, 3
    s_mul_i32 s41, s41, 18
    s_lshr_b32 s43, s40, 2
    s_and_b32 s40, s40, 3
    s_lshl_b32 s40, s40, 1
    s_add_u32 s40, s40, s43
    s_mul_i32 s42, s41, 9216
    s_mul_i32 s43, s40, 1152
    s_add_u32 s42, s42, s43
    s_mul_i32 s44, s41, 3456
    s_lshl_b32 s43, s40, 9
    s_add_u32 s44, s44, s43
    v_mul_u32_u24 v54, 57, v0
    v_lshrrev_b32 v54, 9, v54
    v_mul_u32_u24 v55, 8064, v54
    v_lshl_add_u32 v55, v0, 7, v55
    v_mov_b32 v56, 0x7fffff00
    v_cmp_gt_u32 vcc, 162, v0
    v_lshrrev_b32 v54, 2, v0
    v_mul_u32_u24 v54, 2944, v54
    v_cndmask_b32 v55, v56, v55, vcc
    v_lshl_add_u32 v54, v0, 7, v54
    v_cmp_gt_u32 vcc, 72, v0
    s_mov_b32 s28, s24
    s_and_b32 s29, s25, 0xffff
    s_mov_b32 s30, 0x510000
    s_mov_b32 s31, 0x00020000
    s_mov_b32 s32, s26
    s_and_b32 s33, s27, 0xffff
    s_mov_b32 s34, 0x510000
    s_mov_b32 s35, 0x00020000
    v_cndmask_b32 v54, v56, v54, vcc
    s_and_b32 s37, s37, 0xffff
    s_mov_b32 s38, 0x1e6000
    s_mov_b32 s39, 0x00020000
    v_lshrrev_b32 v55, 2, v0
    v_mul_u32_u24 v55, 8192, v55
    v_lshl_add_u32 v55, v0, 8, v55
    v_cndmask_b32 v55, v56, v55, vcc
    buffer_load_dword v57, v55, s[28:31], s42 offen
    buffer_load_dword v58, v55, s[32:35], s42 offen
    s_getpc_b64 s[48:49]
K0_PC:
    s_add_u32 s48, s48, km_main_kernel-K0_PC
    s_addc_u32 s49, s49, 0
    s_and_b32 s49, s49, 0xffff
    s_mov_b32 s50, KM_END-km_main_kernel
    s_mov_b32 s51, 0x00020000
    s_lshr_b32 s52, s2, 3
    s_lshl_b32 s52, s52, 12
    v_lshlrev_b32 v60, 7, v0
    v_cmp_gt_u32 vcc, 32, v0
    v_mov_b32 v61, 0x7fffff00
    s_nop 0
    v_cndmask_b32 v60, v61, v60, vcc
    buffer_load_dword v62, v60, s[48:51], s52 offen
    s_mov_b32 s12, s6
    s_and_b32 s13, s7, 0xffff
    s_mov_b32 s14, 0x29e0000
    s_mov_b32 s15, 0x00020000
    v_lshrrev_b32 v4, 4, v1
    v_mul_u32_u24 v4, 18432, v4
    v_lshl_add_u32 v4, v2, 8, v4
    v_and_b32 v5, 15, v1
    v_lshl_add_u32 v4, v5, 4, v4
    s_mov_b32 s16, 0x27a0000
    s_mov_b32 s17, 0x27a2000
    s_mov_b32 s18, 0x27a4000
    v_mov_b32 v50, 0x3ae38e39
    s_waitcnt vmcnt(3)
    v_lshlrev_b32 v24, 16, v8
    v_and_b32 v25, 0xffff0000, v8
    v_lshlrev_b32 v26, 16, v9
    v_and_b32 v27, 0xffff0000, v9
    v_lshlrev_b32 v28, 16, v10
    v_and_b32 v29, 0xffff0000, v10
    v_lshlrev_b32 v30, 16, v11
    v_and_b32 v31, 0xffff0000, v11
    v_lshlrev_b32 v32, 16, v12
    v_and_b32 v33, 0xffff0000, v12
    v_lshlrev_b32 v34, 16, v13
    v_and_b32 v35, 0xffff0000, v13
    v_lshlrev_b32 v36, 16, v14
    v_and_b32 v37, 0xffff0000, v14
    v_lshlrev_b32 v38, 16, v15
    v_and_b32 v39, 0xffff0000, v15
    v_lshlrev_b32 v40, 16, v16
    v_and_b32 v41, 0xffff0000, v16
    v_lshlrev_b32 v42, 16, v17
    v_and_b32 v43, 0xffff0000, v17
    v_lshlrev_b32 v44, 16, v18
    v_and_b32 v45, 0xffff0000, v18
    v_lshlrev_b32 v46, 16, v19
    v_and_b32 v47, 0xffff0000, v19
    v_add_f32 v6, v24, v25
    v_add_f32 v7, v26, v27
    v_add_f32 v6, v6, v28
    v_add_f32 v7, v7, v29
    v_add_f32 v6, v6, v30
    v_add_f32 v7, v7, v31
    v_add_f32 v6, v6, v32
    v_add_f32 v7, v7, v33
    v_add_f32 v6, v6, v34
    v_add_f32 v7, v7, v35
    v_add_f32 v6, v6, v36
    v_add_f32 v7, v7, v37
    v_add_f32 v6, v6, v38
    v_add_f32 v7, v7, v39
    v_add_f32 v6, v6, v40
    v_add_f32 v7, v7, v41
    v_add_f32 v6, v6, v42
    v_add_f32 v7, v7, v43
    v_add_f32 v6, v6, v44
    v_add_f32 v7, v7, v45
    v_add_f32 v6, v6, v46
    v_add_f32 v7, v7, v47
    v_add_f32 v6, v6, v7
    s_nop 1
    v_add_f32_dpp v6, v6, v6 quad_perm:[1,0,3,2] row_mask:0xf bank_mask:0xf
    s_nop 1
    v_add_f32_dpp v6, v6, v6 quad_perm:[2,3,0,1] row_mask:0xf bank_mask:0xf
    s_nop 1
    v_add_f32_dpp v6, v6, v6 row_half_mirror row_mask:0xf bank_mask:0xf
    s_nop 1
    v_add_f32_dpp v6, v6, v6 row_mirror row_mask:0xf bank_mask:0xf
    v_mov_b32 v7, v6
    s_nop 1
    v_permlane16_swap_b32 v6, v7
    s_nop 0
    v_add_f32 v6, v6, v7
    v_mul_f32 v6, v50, v6
    v_mov_b32 v20, 0
    v_mov_b32 v21, 0
    v_sub_f32 v48, v24, v6
    v_sub_f32 v49, v25, v6
    v_fmac_f32 v20, v48, v48
    v_fmac_f32 v21, v49, v49
    v_sub_f32 v48, v26, v6
    v_sub_f32 v49, v27, v6
    v_fmac_f32 v20, v48, v48
    v_fmac_f32 v21, v49, v49
    v_sub_f32 v48, v28, v6
    v_sub_f32 v49, v29, v6
    v_fmac_f32 v20, v48, v48
    v_fmac_f32 v21, v49, v49
    v_sub_f32 v48, v30, v6
    v_sub_f32 v49, v31, v6
    v_fmac_f32 v20, v48, v48
    v_fmac_f32 v21, v49, v49
    v_sub_f32 v48, v32, v6
    v_sub_f32 v49, v33, v6
    v_fmac_f32 v20, v48, v48
    v_fmac_f32 v21, v49, v49
    v_sub_f32 v48, v34, v6
    v_sub_f32 v49, v35, v6
    v_fmac_f32 v20, v48, v48
    v_fmac_f32 v21, v49, v49
    v_sub_f32 v48, v36, v6
    v_sub_f32 v49, v37, v6
    v_fmac_f32 v20, v48, v48
    v_fmac_f32 v21, v49, v49
    v_sub_f32 v48, v38, v6
    v_sub_f32 v49, v39, v6
    v_fmac_f32 v20, v48, v48
    v_fmac_f32 v21, v49, v49
    s_mov_b64 exec, s[20:21]
    v_sub_f32 v48, v40, v6
    v_sub_f32 v49, v41, v6
    v_fmac_f32 v20, v48, v48
    v_fmac_f32 v21, v49, v49
    v_sub_f32 v48, v42, v6
    v_sub_f32 v49, v43, v6
    v_fmac_f32 v20, v48, v48
    v_fmac_f32 v21, v49, v49
    v_sub_f32 v48, v44, v6
    v_sub_f32 v49, v45, v6
    v_fmac_f32 v20, v48, v48
    v_fmac_f32 v21, v49, v49
    v_sub_f32 v48, v46, v6
    v_sub_f32 v49, v47, v6
    v_fmac_f32 v20, v48, v48
    v_fmac_f32 v21, v49, v49
    s_mov_b64 exec, -1
    v_add_f32 v20, v20, v21
    v_cvt_pk_bf16_f32 v6, v6, v6
    v_and_b32 v6, 0xffff0000, v6
    s_nop 1
    v_add_f32_dpp v20, v20, v20 quad_perm:[1,0,3,2] row_mask:0xf bank_mask:0xf
    s_nop 1
    v_add_f32_dpp v20, v20, v20 quad_perm:[2,3,0,1] row_mask:0xf bank_mask:0xf
    s_nop 1
    v_add_f32_dpp v20, v20, v20 row_half_mirror row_mask:0xf bank_mask:0xf
    s_nop 1
    v_add_f32_dpp v20, v20, v20 row_mirror row_mask:0xf bank_mask:0xf
    v_mov_b32 v21, v20
    s_nop 1
    v_permlane16_swap_b32 v20, v21
    s_nop 0
    v_add_f32 v20, v20, v21
    v_mul_f32 v20, v50, v20
    v_cvt_pk_bf16_f32 v20, v20, v20
    v_and_b32 v20, 0xffff0000, v20
    v_add_f32 v20, 0x3727c5ac, v20
    v_cvt_pk_bf16_f32 v20, v20, v20
    v_and_b32 v20, 0xffff0000, v20
    v_sqrt_f32 v20, v20
    s_nop 0
    v_cvt_pk_bf16_f32 v20, v20, v20
    v_and_b32 v20, 0xffff0000, v20
    v_rcp_f32 v20, v20
    v_sub_f32 v24, v24, v6
    v_sub_f32 v25, v25, v6
    v_cvt_pk_bf16_f32 v48, v24, v25
    v_lshlrev_b32 v24, 16, v48
    v_and_b32 v25, 0xffff0000, v48
    v_mul_f32 v24, v24, v20
    v_mul_f32 v25, v25, v20
    v_cvt_pk_bf16_f32 v8, v24, v25
    v_sub_f32 v26, v26, v6
    v_sub_f32 v27, v27, v6
    v_cvt_pk_bf16_f32 v48, v26, v27
    v_lshlrev_b32 v26, 16, v48
    v_and_b32 v27, 0xffff0000, v48
    v_mul_f32 v26, v26, v20
    v_mul_f32 v27, v27, v20
    v_cvt_pk_bf16_f32 v9, v26, v27
    v_sub_f32 v28, v28, v6
    v_sub_f32 v29, v29, v6
    v_cvt_pk_bf16_f32 v48, v28, v29
    v_lshlrev_b32 v28, 16, v48
    v_and_b32 v29, 0xffff0000, v48
    v_mul_f32 v28, v28, v20
    v_mul_f32 v29, v29, v20
    v_cvt_pk_bf16_f32 v10, v28, v29
    v_sub_f32 v30, v30, v6
    v_sub_f32 v31, v31, v6
    v_cvt_pk_bf16_f32 v48, v30, v31
    v_lshlrev_b32 v30, 16, v48
    v_and_b32 v31, 0xffff0000, v48
    v_mul_f32 v30, v30, v20
    v_mul_f32 v31, v31, v20
    v_cvt_pk_bf16_f32 v11, v30, v31
    buffer_store_dwordx4 v[8:11], v4, s[12:15], s16 offen
    v_sub_f32 v32, v32, v6
    v_sub_f32 v33, v33, v6
    v_cvt_pk_bf16_f32 v48, v32, v33
    v_lshlrev_b32 v32, 16, v48
    v_and_b32 v33, 0xffff0000, v48
    v_mul_f32 v32, v32, v20
    v_mul_f32 v33, v33, v20
    v_cvt_pk_bf16_f32 v12, v32, v33
    v_sub_f32 v34, v34, v6
    v_sub_f32 v35, v35, v6
    v_cvt_pk_bf16_f32 v48, v34, v35
    v_lshlrev_b32 v34, 16, v48
    v_and_b32 v35, 0xffff0000, v48
    v_mul_f32 v34, v34, v20
    v_mul_f32 v35, v35, v20
    v_cvt_pk_bf16_f32 v13, v34, v35
    v_sub_f32 v36, v36, v6
    v_sub_f32 v37, v37, v6
    v_cvt_pk_bf16_f32 v48, v36, v37
    v_lshlrev_b32 v36, 16, v48
    v_and_b32 v37, 0xffff0000, v48
    v_mul_f32 v36, v36, v20
    v_mul_f32 v37, v37, v20
    v_cvt_pk_bf16_f32 v14, v36, v37
    v_sub_f32 v38, v38, v6
    v_sub_f32 v39, v39, v6
    v_cvt_pk_bf16_f32 v48, v38, v39
    v_lshlrev_b32 v38, 16, v48
    v_and_b32 v39, 0xffff0000, v48
    v_mul_f32 v38, v38, v20
    v_mul_f32 v39, v39, v20
    v_cvt_pk_bf16_f32 v15, v38, v39
    buffer_store_dwordx4 v[12:15], v4, s[12:15], s17 offen
    v_sub_f32 v40, v40, v6
    v_sub_f32 v41, v41, v6
    v_cvt_pk_bf16_f32 v48, v40, v41
    v_lshlrev_b32 v40, 16, v48
    v_and_b32 v41, 0xffff0000, v48
    v_mul_f32 v40, v40, v20
    v_mul_f32 v41, v41, v20
    v_cvt_pk_bf16_f32 v16, v40, v41
    v_sub_f32 v42, v42, v6
    v_sub_f32 v43, v43, v6
    v_cvt_pk_bf16_f32 v48, v42, v43
    v_lshlrev_b32 v42, 16, v48
    v_and_b32 v43, 0xffff0000, v48
    v_mul_f32 v42, v42, v20
    v_mul_f32 v43, v43, v20
    v_cvt_pk_bf16_f32 v17, v42, v43
    v_sub_f32 v44, v44, v6
    v_sub_f32 v45, v45, v6
    v_cvt_pk_bf16_f32 v48, v44, v45
    v_lshlrev_b32 v44, 16, v48
    v_and_b32 v45, 0xffff0000, v48
    v_mul_f32 v44, v44, v20
    v_mul_f32 v45, v45, v20
    v_cvt_pk_bf16_f32 v18, v44, v45
    v_sub_f32 v46, v46, v6
    v_sub_f32 v47, v47, v6
    v_cvt_pk_bf16_f32 v48, v46, v47
    v_lshlrev_b32 v46, 16, v48
    v_and_b32 v47, 0xffff0000, v48
    v_mul_f32 v46, v46, v20
    v_mul_f32 v47, v47, v20
    v_cvt_pk_bf16_f32 v19, v46, v47
    s_mov_b64 exec, s[20:21]
    buffer_store_dwordx4 v[16:19], v4, s[12:15], s18 offen
    s_mov_b64 exec, -1
    v_mov_b32 v52, 0
    v_lshlrev_b32 v53, 2, v0
    s_lshl_b32 s19, s2, 9
    s_add_u32 s19, s19, 0x2780000
    v_cmp_gt_u32 vcc, 128, v0
    s_and_saveexec_b64 s[22:23], vcc
    s_cbranch_execz K0_NOZ
    buffer_store_dword v52, v53, s[12:15], s19 offen
K0_NOZ:
    s_mov_b64 exec, -1
K0_END:
    s_endpgm
.text
.globl km_main_kernel
.p2align 8
.type km_main_kernel,@function
km_main_kernel:
    s_cmp_ge_u32 s2, 256
    s_cbranch_scc1 KM_END
    s_load_dwordx4 s[84:87], s[0:1], 32
    s_load_dwordx2 s[24:25], s[0:1], 72
    s_load_dwordx2 s[56:57], s[0:1], 8
    s_load_dwordx2 s[4:5], s[0:1], 48
    s_load_dwordx2 s[8:9], s[0:1], 16
    v_lshrrev_b32 v232, 6, v0
    v_and_b32 v255, 63, v0
    v_readfirstlane_b32 s12, v232
    s_and_b32 s13, s2, 7
    s_lshr_b32 s14, s2, 3
    s_lshr_b32 s15, s13, 2
    s_lshl_b32 s15, s15, 2
    s_and_b32 s32, s14, 3
    s_add_u32 s15, s15, s32
    s_and_b32 s32, s13, 3
    s_lshl_b32 s32, s32, 3
    s_lshr_b32 s33, s14, 2
    s_add_u32 s32, s32, s33
    s_lshl_b32 s33, s15, 3
    s_add_u32 s33, s33, s12
    s_lshr_b32 s34, s32, 2
    s_mul_i32 s34, s34, 36
    s_and_b32 s35, s32, 3
    s_lshl_b32 s40, s35, 3
    s_add_u32 s40, s40, s34
    s_and_b32 s45, s12, 2
    v_lshrrev_b32 v232, 3, v255
    v_bfe_u32 v233, v255, 1, 2
    v_bfe_u32 v234, v255, 4, 1
    v_or_b32 v234, s45, v234
    v_xor_b32 v234, v234, v233
    s_lshr_b32 s45, s12, 1
    s_lshl_b32 s45, s45, 3
    v_add_u32 v235, s45, v232
    v_and_b32 v236, 1, v255
    v_lshlrev_b32 v236, 4, v236
    v_mul_u32_u24 v237, 9216, v235
    v_add_u32 v237, v237, v236
    v_add_u32 v246, s40, v234
    v_lshl_add_u32 v246, v246, 5, v237
    v_lshlrev_b32 v245, 4, v255
    s_mul_i32 s54, s33, 36864
    s_add_u32 s54, s54, 0x27a0000
    s_add_u32 s55, s54, 18432
    s_lshl_b32 s52, s12, 10
    s_mov_b32 s18, 0x510000
    s_mov_b32 s19, 0x00020000
    s_mov_b32 s26, 0x29e0000
    s_mov_b32 s27, 0x00020000
    s_bitcmp1_b32 s12, 0
    s_waitcnt lgkmcnt(0)
    s_cselect_b64 s[16:17], s[86:87], s[84:85]
    s_and_b32 s17, s17, 0xffff
    s_and_b32 s25, s25, 0xffff
    s_add_u32 m0, s52, 0x0
    s_mov_b32 s50, 0
    buffer_load_dwordx4 v246, s[16:19], s50 offen lds
    s_add_u32 m0, s52, 0x2000
    s_add_u32 s50, s50, 294912
    buffer_load_dwordx4 v246, s[16:19], s50 offen lds
    buffer_load_dwordx4 v[0:3], v245, s[24:27], s54 offen offset:0
    buffer_load_dwordx4 v[4:7], v245, s[24:27], s55 offen offset:0
    buffer_load_dwordx4 v[8:11], v245, s[24:27], s54 offen offset:1024
    buffer_load_dwordx4 v[12:15], v245, s[24:27], s55 offen offset:1024
    v_lshrrev_b32 v208, 4, v255
    v_bfe_u32 v209, v255, 2, 2
    v_and_b32 v210, 3, v255
    v_lshlrev_b32 v210, 3, v210
    v_lshl_add_u32 v210, v209, 7, v210
    v_lshl_add_u32 v210, v208, 11, v210
    v_bfe_u32 v211, v255, 3, 2
    v_lshl_add_u32 v240, v211, 5, v210
    v_xor_b32 v241, 32, v240
    v_xor_b32 v242, 64, v240
    v_xor_b32 v243, 96, v240
    s_add_u32 s41, s40, 2
    s_add_u32 s42, s40, 4
    s_add_u32 s43, s40, 6
    s_add_u32 s44, s34, s35
    s_add_u32 s44, s44, 32
    s_mov_b64 s[28:29], s[24:25]
    s_mov_b32 s31, 0x00020000
    s_and_b32 s45, s13, 3
    s_lshr_b32 s47, s14, 2
    s_mul_i32 s49, s45, 6
    s_add_u32 s49, s49, s47
    s_lshl_b32 s45, s45, 1
    s_add_u32 s45, s45, s47
    s_sub_u32 s45, s45, 6
    s_and_b32 s48, s45, 1
    s_lshl_b32 s48, s48, 1
    s_lshr_b32 s45, s45, 1
    s_add_u32 s45, s45, 24
    s_cmp_ge_u32 s14, 24
    s_cselect_b32 s49, s45, s49
    s_cselect_b32 s48, s48, 0
    s_cmp_ge_u32 s49, 27
    s_cselect_b32 s30, 0, s26
    s_and_b32 s5, s5, 0xffff
    s_mov_b32 s6, 0x510000
    s_mov_b32 s7, 0x00020000
    s_and_b32 s9, s9, 0xffff
    s_mov_b32 s10, 0xa2000
    s_mov_b32 s11, 0x00020000
    s_and_b32 s57, s57, 0xffff
    s_mov_b32 s58, 0x1e6000
    s_mov_b32 s59, 0x00020000
    v_add_u32 v247, 128, v246
    s_min_u32 s49, s49, 26
    v_xor_b32 v234, s48, v234
    s_lshl_b32 s45, s49, 2
    v_mul_u32_u24 v237, 3456, v235
    v_add_u32 v238, s45, v234
    v_lshl_add_u32 v237, v238, 5, v237
    v_lshrrev_b32 v238, 1, v255
    v_mul_u32_u24 v238, 9216, v238
    s_lshl_b32 s45, s44, 5
    v_add_u32 v238, s45, v238
    s_bitcmp1_b32 s12, 0
    s_cselect_b64 vcc, -1, 0
    s_mov_b32 s51, 110592
    s_cselect_b32 s51, 294912, s51
    s_cselect_b64 s[20:21], s[84:85], s[56:57]
    s_cselect_b32 s22, s18, s58
    v_cndmask_b32 v248, v237, v238, vcc
    v_add_u32 v248, v248, v236
    s_cmp_eq_u32 s12, 3
    s_cselect_b64 s[20:21], s[86:87], s[20:21]
    s_and_b32 s21, s21, 0xffff
    s_and_b32 s45, s12, 5
    s_cmp_eq_u32 s45, 5
    s_cselect_b32 s22, 0, s22
    s_mov_b32 s23, 0x00020000
    v_lshrrev_b32 v232, 4, v255
    v_and_b32 v244, 15, v255
    v_lshlrev_b32 v244, 3, v244
    v_lshl_add_u32 v249, v232, 14, v244
    v_lshl_add_u32 v244, v232, 8, v244
    v_mov_b32 v250, 0xbfb8aa3b
    v_lshlrev_b32 v251, 3, v255
    s_lshl_b32 s36, s15, 2
    s_lshr_b32 s37, s12, 1
    s_add_u32 s36, s36, s37
    s_lshl_b32 s37, s36, 2
    s_add_u32 s37, s37, s35
    s_mul_i32 s36, s36, 9216
    s_lshl_b32 s53, s35, 8
    s_add_u32 s36, s36, s53
    s_add_u32 s36, s36, 128
    s_mul_i32 s37, s37, 9216
    s_add_u32 s37, s37, 1024
    v_mul_u32_u24 v252, 294912, v255
    v_add_u32 v252, s36, v252
    v_subrev_u32 v253, 18, v255
    v_and_b32 v253, 7, v253
    v_mul_u32_u24 v253, 1179648, v253
    v_add_u32 v253, s37, v253
    v_cmp_gt_u32 vcc, 18, v255
    s_lshl_b32 s53, s34, 5
    s_mul_i32 s38, s33, 3456
    s_lshl_b32 s45, s49, 7
    s_add_u32 s38, s38, s45
    v_cndmask_b32 v252, v253, v252, vcc
    v_mul_u32_u24 v253, 221184, v255
    s_and_b32 s36, s13, 3
    s_mul_i32 s36, s36, 1327104
    s_lshl_b32 s45, s14, 3
    s_add_u32 s45, s45, s12
    s_lshr_b32 s47, s13, 2
    s_lshl_b32 s47, s47, 8
    s_add_u32 s47, s47, s45
    s_mul_i32 s47, s47, 2688
    s_add_u32 s36, s36, s47
    s_and_b32 s37, s13, 1
    s_mul_i32 s37, s37, 331776
    s_mul_i32 s47, s45, 1408
    s_add_u32 s37, s37, s47
    v_lshlrev_b32 v254, 7, v255
    s_mul_i32 s45, s33, 290
    s_and_b32 s46, s44, 1
    s_lshl_b32 s46, s46, 9
    s_lshr_b32 s40, s40, 1
    s_add_u32 s40, s40, s45
    s_lshl_b32 s40, s40, 10
    s_lshr_b32 s41, s41, 1
    s_add_u32 s41, s41, s45
    s_lshl_b32 s41, s41, 10
    s_lshr_b32 s42, s42, 1
    s_add_u32 s42, s42, s45
    s_lshl_b32 s42, s42, 10
    s_lshr_b32 s43, s43, 1
    s_add_u32 s43, s43, s45
    s_lshl_b32 s43, s43, 10
    s_lshr_b32 s44, s44, 1
    s_add_u32 s44, s44, s45
    s_lshl_b32 s44, s44, 10
    s_add_u32 s44, s44, s46
    s_lshl_b32 s46, s49, 18
    s_lshl_b32 s47, s33, 8
    s_add_u32 s46, s46, s47
    s_add_u32 s46, s46, 0x1300000
    s_lshl_b32 s48, s48, 16
    s_add_u32 s46, s46, s48
    s_lshr_b32 s39, s33, 2
    s_mul_i32 s39, s39, 12
    s_lshr_b32 s45, s32, 3
    s_add_u32 s39, s39, s45
    s_lshl_b32 s39, s39, 7
    s_add_u32 s39, s39, 0x2798000
    s_lshr_b32 s3, s33, 1
    s_lshl_b32 s3, s3, 8
    s_add_u32 s3, s3, 0x279e000
    s_cmp_ge_u32 s49, 9
    s_cselect_b32 s45, 9, 0
    s_sub_u32 s47, s49, s45
    s_cmp_ge_u32 s47, 9
    s_cselect_b32 s45, 9, 0
    s_sub_u32 s47, s47, s45
    s_cmp_le_u32 s47, 4
    s_cselect_b32 s100, 1, 0
    s_cmp_ge_u32 s47, 4
    s_cselect_b32 s45, 2, 0
    s_or_b32 s100, s100, s45
    s_lshl_b32 s45, s100, 2
    s_bitcmp1_b32 s33, 0
    s_cselect_b32 s45, s45, 0
    s_cmp_eq_u32 s33, 63
    s_cselect_b32 s45, 0, s45
    s_or_b32 s100, s100, s45
    s_add_u32 m0, s52, 0x4000
    s_add_u32 s50, s50, 294912
    buffer_load_dwordx4 v246, s[16:19], s50 offen lds
    s_add_u32 m0, s52, 0x6000
    s_add_u32 s50, s50, 294912
    buffer_load_dwordx4 v246, s[16:19], s50 offen lds
    buffer_load_dwordx4 v[16:19], v245, s[24:27], s54 offen offset:2048
    buffer_load_dwordx4 v[20:23], v245, s[24:27], s55 offen offset:2048
    buffer_load_dwordx4 v[24:27], v245, s[24:27], s54 offen offset:3072
    buffer_load_dwordx4 v[28:31], v245, s[24:27], s55 offen offset:3072
    s_cmp_ge_u32 s14, 24
    s_cbranch_scc1 KM_CONST
KM_CONSTX:
    s_waitcnt vmcnt(10)
    s_barrier
    ds_read_b64_tr_b16 v[208:209], v240 offset:0
    ds_read_b64_tr_b16 v[210:211], v240 offset:512
    ds_read_b64_tr_b16 v[212:213], v240 offset:1024
    ds_read_b64_tr_b16 v[214:215], v240 offset:1536
    ds_read_b64_tr_b16 v[216:217], v240 offset:8192
    ds_read_b64_tr_b16 v[218:219], v240 offset:8704
    ds_read_b64_tr_b16 v[220:221], v240 offset:9216
    ds_read_b64_tr_b16 v[222:223], v240 offset:9728
    ds_read_b64_tr_b16 v[224:225], v241 offset:0
    ds_read_b64_tr_b16 v[226:227], v241 offset:512
    s_waitcnt vmcnt(8) lgkmcnt(6)
    s_setprio 3
    v_mfma_f32_16x16x32_bf16 v[144:147], v[208:211], v[0:3], 0
    ds_read_b64_tr_b16 v[228:229], v241 offset:1024
    v_mfma_f32_16x16x32_bf16 v[148:151], v[208:211], v[4:7], 0
    ds_read_b64_tr_b16 v[230:231], v241 offset:1536
    v_mfma_f32_16x16x32_bf16 v[152:155], v[212:215], v[0:3], 0
    ds_read_b64_tr_b16 v[208:209], v241 offset:8192
    v_mfma_f32_16x16x32_bf16 v[156:159], v[212:215], v[4:7], 0
    ds_read_b64_tr_b16 v[210:211], v241 offset:8704
    s_add_u32 m0, s52, 0x8000
    s_add_u32 s50, s50, 294912
    buffer_load_dwordx4 v246, s[16:19], s50 offen lds
    s_waitcnt vmcnt(7) lgkmcnt(6)
    v_mfma_f32_16x16x32_bf16 v[144:147], v[216:219], v[8:11], v[144:147]
    ds_read_b64_tr_b16 v[212:213], v241 offset:9216
    v_mfma_f32_16x16x32_bf16 v[148:151], v[216:219], v[12:15], v[148:151]
    ds_read_b64_tr_b16 v[214:215], v241 offset:9728
    s_setprio 2
    v_mfma_f32_16x16x32_bf16 v[152:155], v[220:223], v[8:11], v[152:155]
    ds_read_b64_tr_b16 v[216:217], v242 offset:0
    v_mfma_f32_16x16x32_bf16 v[156:159], v[220:223], v[12:15], v[156:159]
    ds_read_b64_tr_b16 v[218:219], v242 offset:512
    s_add_u32 m0, s52, 0xa000
    s_add_u32 s50, s50, 294912
    buffer_load_dwordx4 v246, s[16:19], s50 offen lds
    s_waitcnt lgkmcnt(6)
    v_mfma_f32_16x16x32_bf16 v[160:163], v[224:227], v[0:3], 0
    ds_read_b64_tr_b16 v[220:221], v242 offset:1024
    v_mfma_f32_16x16x32_bf16 v[164:167], v[224:227], v[4:7], 0
    ds_read_b64_tr_b16 v[222:223], v242 offset:1536
    v_mfma_f32_16x16x32_bf16 v[168:171], v[228:231], v[0:3], 0
    ds_read_b64_tr_b16 v[224:225], v242 offset:8192
    v_mfma_f32_16x16x32_bf16 v[172:175], v[228:231], v[4:7], 0
    ds_read_b64_tr_b16 v[226:227], v242 offset:8704
    s_add_u32 m0, s52, 0xc000
    s_add_u32 s50, s50, 294912
    buffer_load_dwordx4 v246, s[16:19], s50 offen lds
    s_waitcnt lgkmcnt(6)
    s_setprio 1
    v_mfma_f32_16x16x32_bf16 v[160:163], v[208:211], v[8:11], v[160:163]
    ds_read_b64_tr_b16 v[228:229], v242 offset:9216
    v_mfma_f32_16x16x32_bf16 v[164:167], v[208:211], v[12:15], v[164:167]
    ds_read_b64_tr_b16 v[230:231], v242 offset:9728
    v_mfma_f32_16x16x32_bf16 v[168:171], v[212:215], v[8:11], v[168:171]
    ds_read_b64_tr_b16 v[208:209], v243 offset:0
    v_mfma_f32_16x16x32_bf16 v[172:175], v[212:215], v[12:15], v[172:175]
    ds_read_b64_tr_b16 v[210:211], v243 offset:512
    s_add_u32 m0, s52, 0xe000
    s_add_u32 s50, s50, 294912
    buffer_load_dwordx4 v246, s[16:19], s50 offen lds
    s_waitcnt lgkmcnt(6)
    v_mfma_f32_16x16x32_bf16 v[176:179], v[216:219], v[0:3], 0
    ds_read_b64_tr_b16 v[212:213], v243 offset:1024
    v_mfma_f32_16x16x32_bf16 v[180:183], v[216:219], v[4:7], 0
    ds_read_b64_tr_b16 v[214:215], v243 offset:1536
    s_setprio 0
    v_mfma_f32_16x16x32_bf16 v[184:187], v[220:223], v[0:3], 0
    ds_read_b64_tr_b16 v[216:217], v243 offset:8192
    v_mfma_f32_16x16x32_bf16 v[188:191], v[220:223], v[4:7], 0
    ds_read_b64_tr_b16 v[218:219], v243 offset:8704
    s_add_u32 s54, s54, 4096
    buffer_load_dwordx4 v[32:35], v245, s[24:27], s54 offen offset:0
    s_waitcnt lgkmcnt(6)
    v_mfma_f32_16x16x32_bf16 v[176:179], v[224:227], v[8:11], v[176:179]
    ds_read_b64_tr_b16 v[220:221], v243 offset:9216
    v_mfma_f32_16x16x32_bf16 v[180:183], v[224:227], v[12:15], v[180:183]
    ds_read_b64_tr_b16 v[222:223], v243 offset:9728
    v_mfma_f32_16x16x32_bf16 v[184:187], v[228:231], v[8:11], v[184:187]
    v_mfma_f32_16x16x32_bf16 v[188:191], v[228:231], v[12:15], v[188:191]
    s_add_u32 s55, s55, 4096
    buffer_load_dwordx4 v[36:39], v245, s[24:27], s55 offen offset:0
    s_waitcnt lgkmcnt(4)
    v_mfma_f32_16x16x32_bf16 v[192:195], v[208:211], v[0:3], 0
    v_mfma_f32_16x16x32_bf16 v[196:199], v[208:211], v[4:7], 0
    s_waitcnt vmcnt(10) lgkmcnt(0)
    s_barrier
    ds_read_b64_tr_b16 v[224:225], v240 offset:16384
    ds_read_b64_tr_b16 v[226:227], v240 offset:16896
    ds_read_b64_tr_b16 v[228:229], v240 offset:17408
    ds_read_b64_tr_b16 v[230:231], v240 offset:17920
    s_setprio 3
    v_mfma_f32_16x16x32_bf16 v[200:203], v[212:215], v[0:3], 0
    ds_read_b64_tr_b16 v[208:209], v240 offset:24576
    v_mfma_f32_16x16x32_bf16 v[204:207], v[212:215], v[4:7], 0
    ds_read_b64_tr_b16 v[210:211], v240 offset:25088
    buffer_load_dwordx4 v[40:43], v245, s[24:27], s54 offen offset:1024
    v_mfma_f32_16x16x32_bf16 v[192:195], v[216:219], v[8:11], v[192:195]
    ds_read_b64_tr_b16 v[212:213], v240 offset:25600
    v_mfma_f32_16x16x32_bf16 v[196:199], v[216:219], v[12:15], v[196:199]
    ds_read_b64_tr_b16 v[214:215], v240 offset:26112
    v_mfma_f32_16x16x32_bf16 v[200:203], v[220:223], v[8:11], v[200:203]
    ds_read_b64_tr_b16 v[216:217], v241 offset:16384
    v_mfma_f32_16x16x32_bf16 v[204:207], v[220:223], v[12:15], v[204:207]
    ds_read_b64_tr_b16 v[218:219], v241 offset:16896
    buffer_load_dwordx4 v[44:47], v245, s[24:27], s55 offen offset:1024
    s_waitcnt vmcnt(10) lgkmcnt(6)
    v_mfma_f32_16x16x32_bf16 v[144:147], v[224:227], v[16:19], v[144:147]
    ds_read_b64_tr_b16 v[220:221], v241 offset:17408
    v_mfma_f32_16x16x32_bf16 v[148:151], v[224:227], v[20:23], v[148:151]
    ds_read_b64_tr_b16 v[222:223], v241 offset:17920
    s_setprio 2
    v_mfma_f32_16x16x32_bf16 v[152:155], v[228:231], v[16:19], v[152:155]
    ds_read_b64_tr_b16 v[224:225], v241 offset:24576
    v_mfma_f32_16x16x32_bf16 v[156:159], v[228:231], v[20:23], v[156:159]
    ds_read_b64_tr_b16 v[226:227], v241 offset:25088
    buffer_load_dwordx4 v[48:51], v245, s[24:27], s54 offen offset:2048
    s_waitcnt vmcnt(9) lgkmcnt(6)
    v_mfma_f32_16x16x32_bf16 v[144:147], v[208:211], v[24:27], v[144:147]
    ds_read_b64_tr_b16 v[228:229], v241 offset:25600
    v_mfma_f32_16x16x32_bf16 v[148:151], v[208:211], v[28:31], v[148:151]
    ds_read_b64_tr_b16 v[230:231], v241 offset:26112
    v_mfma_f32_16x16x32_bf16 v[152:155], v[212:215], v[24:27], v[152:155]
    ds_read_b64_tr_b16 v[208:209], v242 offset:16384
    v_mfma_f32_16x16x32_bf16 v[156:159], v[212:215], v[28:31], v[156:159]
    ds_read_b64_tr_b16 v[210:211], v242 offset:16896
    buffer_load_dwordx4 v[52:55], v245, s[24:27], s55 offen offset:2048
    s_waitcnt lgkmcnt(6)
    v_mfma_f32_16x16x32_bf16 v[160:163], v[216:219], v[16:19], v[160:163]
    ds_read_b64_tr_b16 v[212:213], v242 offset:17408
    v_mfma_f32_16x16x32_bf16 v[164:167], v[216:219], v[20:23], v[164:167]
    ds_read_b64_tr_b16 v[214:215], v242 offset:17920
    s_setprio 1
    v_mfma_f32_16x16x32_bf16 v[168:171], v[220:223], v[16:19], v[168:171]
    ds_read_b64_tr_b16 v[216:217], v242 offset:24576
    v_mfma_f32_16x16x32_bf16 v[172:175], v[220:223], v[20:23], v[172:175]
    ds_read_b64_tr_b16 v[218:219], v242 offset:25088
    buffer_load_dwordx4 v[56:59], v245, s[24:27], s54 offen offset:3072
    s_waitcnt lgkmcnt(6)
    v_mfma_f32_16x16x32_bf16 v[160:163], v[224:227], v[24:27], v[160:163]
    ds_read_b64_tr_b16 v[220:221], v242 offset:25600
    v_mfma_f32_16x16x32_bf16 v[164:167], v[224:227], v[28:31], v[164:167]
    ds_read_b64_tr_b16 v[222:223], v242 offset:26112
    v_mfma_f32_16x16x32_bf16 v[168:171], v[228:231], v[24:27], v[168:171]
    ds_read_b64_tr_b16 v[224:225], v243 offset:16384
    v_mfma_f32_16x16x32_bf16 v[172:175], v[228:231], v[28:31], v[172:175]
    ds_read_b64_tr_b16 v[226:227], v243 offset:16896
    buffer_load_dwordx4 v[60:63], v245, s[24:27], s55 offen offset:3072
    s_waitcnt lgkmcnt(6)
    v_mfma_f32_16x16x32_bf16 v[176:179], v[208:211], v[16:19], v[176:179]
    ds_read_b64_tr_b16 v[228:229], v243 offset:17408
    v_mfma_f32_16x16x32_bf16 v[180:183], v[208:211], v[20:23], v[180:183]
    ds_read_b64_tr_b16 v[230:231], v243 offset:17920
    s_setprio 0
    v_mfma_f32_16x16x32_bf16 v[184:187], v[212:215], v[16:19], v[184:187]
    ds_read_b64_tr_b16 v[208:209], v243 offset:24576
    v_mfma_f32_16x16x32_bf16 v[188:191], v[212:215], v[20:23], v[188:191]
    ds_read_b64_tr_b16 v[210:211], v243 offset:25088
    s_add_u32 m0, s52, 0x10000
    s_add_u32 s50, s50, 294912
    buffer_load_dwordx4 v246, s[16:19], s50 offen lds
    s_waitcnt lgkmcnt(6)
    v_mfma_f32_16x16x32_bf16 v[176:179], v[216:219], v[24:27], v[176:179]
    ds_read_b64_tr_b16 v[212:213], v243 offset:25600
    v_mfma_f32_16x16x32_bf16 v[180:183], v[216:219], v[28:31], v[180:183]
    ds_read_b64_tr_b16 v[214:215], v243 offset:26112
    v_mfma_f32_16x16x32_bf16 v[184:187], v[220:223], v[24:27], v[184:187]
    v_mfma_f32_16x16x32_bf16 v[188:191], v[220:223], v[28:31], v[188:191]
    s_add_u32 m0, s52, 0x14000
    s_add_u32 s50, s50, 294912
    buffer_load_dwordx4 v246, s[16:19], s50 offen lds
    s_waitcnt lgkmcnt(4)
    v_mfma_f32_16x16x32_bf16 v[192:195], v[224:227], v[16:19], v[192:195]
    v_mfma_f32_16x16x32_bf16 v[196:199], v[224:227], v[20:23], v[196:199]
    s_waitcnt vmcnt(10) lgkmcnt(0)
    s_barrier
    ds_read_b64_tr_b16 v[216:217], v240 offset:32768
    ds_read_b64_tr_b16 v[218:219], v240 offset:33280
    ds_read_b64_tr_b16 v[220:221], v240 offset:33792
    ds_read_b64_tr_b16 v[222:223], v240 offset:34304
    s_setprio 3
    v_mfma_f32_16x16x32_bf16 v[200:203], v[228:231], v[16:19], v[200:203]
    ds_read_b64_tr_b16 v[224:225], v240 offset:40960
    v_mfma_f32_16x16x32_bf16 v[204:207], v[228:231], v[20:23], v[204:207]
    ds_read_b64_tr_b16 v[226:227], v240 offset:41472
    s_add_u32 m0, s52, 0x16000
    s_add_u32 s50, s50, 294912
    buffer_load_dwordx4 v246, s[16:19], s50 offen lds
    v_mfma_f32_16x16x32_bf16 v[192:195], v[208:211], v[24:27], v[192:195]
    ds_read_b64_tr_b16 v[228:229], v240 offset:41984
    v_mfma_f32_16x16x32_bf16 v[196:199], v[208:211], v[28:31], v[196:199]
    ds_read_b64_tr_b16 v[230:231], v240 offset:42496
    v_mfma_f32_16x16x32_bf16 v[200:203], v[212:215], v[24:27], v[200:203]
    ds_read_b64_tr_b16 v[208:209], v240 offset:49152
    v_mfma_f32_16x16x32_bf16 v[204:207], v[212:215], v[28:31], v[204:207]
    ds_read_b64_tr_b16 v[210:211], v240 offset:49664
    s_add_u32 m0, s52, 0x18000
    s_add_u32 s50, s50, 294912
    buffer_load_dwordx4 v246, s[16:19], s50 offen lds
    s_waitcnt vmcnt(10) lgkmcnt(6)
    v_mfma_f32_16x16x32_bf16 v[144:147], v[216:219], v[32:35], v[144:147]
    ds_read_b64_tr_b16 v[212:213], v240 offset:50176
    v_mfma_f32_16x16x32_bf16 v[148:151], v[216:219], v[36:39], v[148:151]
    ds_read_b64_tr_b16 v[214:215], v240 offset:50688
    v_mfma_f32_16x16x32_bf16 v[152:155], v[220:223], v[32:35], v[152:155]
    ds_read_b64_tr_b16 v[216:217], v240 offset:57344
    v_mfma_f32_16x16x32_bf16 v[156:159], v[220:223], v[36:39], v[156:159]
    ds_read_b64_tr_b16 v[218:219], v240 offset:57856
    s_add_u32 s54, s54, 4096
    buffer_load_dwordx4 v[64:67], v245, s[24:27], s54 offen offset:0
    s_waitcnt vmcnt(9) lgkmcnt(6)
    v_mfma_f32_16x16x32_bf16 v[144:147], v[224:227], v[40:43], v[144:147]
    ds_read_b64_tr_b16 v[220:221], v240 offset:58368
    v_mfma_f32_16x16x32_bf16 v[148:151], v[224:227], v[44:47], v[148:151]
    ds_read_b64_tr_b16 v[222:223], v240 offset:58880
    v_mfma_f32_16x16x32_bf16 v[152:155], v[228:231], v[40:43], v[152:155]
    ds_read_b64_tr_b16 v[224:225], v241 offset:32768
    v_mfma_f32_16x16x32_bf16 v[156:159], v[228:231], v[44:47], v[156:159]
    ds_read_b64_tr_b16 v[226:227], v241 offset:33280
    s_add_u32 s55, s55, 4096
    buffer_load_dwordx4 v[68:71], v245, s[24:27], s55 offen offset:0
    s_waitcnt vmcnt(8) lgkmcnt(6)
    v_mfma_f32_16x16x32_bf16 v[144:147], v[208:211], v[48:51], v[144:147]
    ds_read_b64_tr_b16 v[228:229], v241 offset:33792
    v_mfma_f32_16x16x32_bf16 v[148:151], v[208:211], v[52:55], v[148:151]
    ds_read_b64_tr_b16 v[230:231], v241 offset:34304
    s_setprio 2
    v_mfma_f32_16x16x32_bf16 v[152:155], v[212:215], v[48:51], v[152:155]
    ds_read_b64_tr_b16 v[208:209], v241 offset:40960
    v_mfma_f32_16x16x32_bf16 v[156:159], v[212:215], v[52:55], v[156:159]
    ds_read_b64_tr_b16 v[210:211], v241 offset:41472
    buffer_load_dwordx4 v[72:75], v245, s[24:27], s54 offen offset:1024
    s_waitcnt vmcnt(7) lgkmcnt(6)
    v_mfma_f32_16x16x32_bf16 v[144:147], v[216:219], v[56:59], v[144:147]
    ds_read_b64_tr_b16 v[212:213], v241 offset:41984
    v_mfma_f32_16x16x32_bf16 v[148:151], v[216:219], v[60:63], v[148:151]
    ds_read_b64_tr_b16 v[214:215], v241 offset:42496
    v_mfma_f32_16x16x32_bf16 v[152:155], v[220:223], v[56:59], v[152:155]
    ds_read_b64_tr_b16 v[216:217], v241 offset:49152
    v_mfma_f32_16x16x32_bf16 v[156:159], v[220:223], v[60:63], v[156:159]
    ds_read_b64_tr_b16 v[218:219], v241 offset:49664
    buffer_load_dwordx4 v[76:79], v245, s[24:27], s55 offen offset:1024
    s_waitcnt lgkmcnt(6)
    v_mfma_f32_16x16x32_bf16 v[160:163], v[224:227], v[32:35], v[160:163]
    ds_read_b64_tr_b16 v[220:221], v241 offset:50176
    v_mfma_f32_16x16x32_bf16 v[164:167], v[224:227], v[36:39], v[164:167]
    ds_read_b64_tr_b16 v[222:223], v241 offset:50688
    v_mfma_f32_16x16x32_bf16 v[168:171], v[228:231], v[32:35], v[168:171]
    ds_read_b64_tr_b16 v[224:225], v241 offset:57344
    v_mfma_f32_16x16x32_bf16 v[172:175], v[228:231], v[36:39], v[172:175]
    ds_read_b64_tr_b16 v[226:227], v241 offset:57856
    buffer_load_dwordx4 v[80:83], v245, s[24:27], s54 offen offset:2048
    s_waitcnt lgkmcnt(6)
    v_mfma_f32_16x16x32_bf16 v[160:163], v[208:211], v[40:43], v[160:163]
    ds_read_b64_tr_b16 v[228:229], v241 offset:58368
    v_mfma_f32_16x16x32_bf16 v[164:167], v[208:211], v[44:47], v[164:167]
    ds_read_b64_tr_b16 v[230:231], v241 offset:58880
    v_mfma_f32_16x16x32_bf16 v[168:171], v[212:215], v[40:43], v[168:171]
    ds_read_b64_tr_b16 v[208:209], v242 offset:32768
    v_mfma_f32_16x16x32_bf16 v[172:175], v[212:215], v[44:47], v[172:175]
    ds_read_b64_tr_b16 v[210:211], v242 offset:33280
    buffer_load_dwordx4 v[84:87], v245, s[24:27], s55 offen offset:2048
    s_waitcnt lgkmcnt(6)
    v_mfma_f32_16x16x32_bf16 v[160:163], v[216:219], v[48:51], v[160:163]
    ds_read_b64_tr_b16 v[212:213], v242 offset:33792
    v_mfma_f32_16x16x32_bf16 v[164:167], v[216:219], v[52:55], v[164:167]
    ds_read_b64_tr_b16 v[214:215], v242 offset:34304
    s_setprio 1
    v_mfma_f32_16x16x32_bf16 v[168:171], v[220:223], v[48:51], v[168:171]
    ds_read_b64_tr_b16 v[216:217], v242 offset:40960
    v_mfma_f32_16x16x32_bf16 v[172:175], v[220:223], v[52:55], v[172:175]
    ds_read_b64_tr_b16 v[218:219], v242 offset:41472
    buffer_load_dwordx4 v[88:91], v245, s[24:27], s54 offen offset:3072
    s_waitcnt lgkmcnt(6)
    v_mfma_f32_16x16x32_bf16 v[160:163], v[224:227], v[56:59], v[160:163]
    ds_read_b64_tr_b16 v[220:221], v242 offset:41984
    v_mfma_f32_16x16x32_bf16 v[164:167], v[224:227], v[60:63], v[164:167]
    ds_read_b64_tr_b16 v[222:223], v242 offset:42496
    v_mfma_f32_16x16x32_bf16 v[168:171], v[228:231], v[56:59], v[168:171]
    ds_read_b64_tr_b16 v[224:225], v242 offset:49152
    v_mfma_f32_16x16x32_bf16 v[172:175], v[228:231], v[60:63], v[172:175]
    ds_read_b64_tr_b16 v[226:227], v242 offset:49664
    buffer_load_dwordx4 v[92:95], v245, s[24:27], s55 offen offset:3072
    s_waitcnt lgkmcnt(6)
    v_mfma_f32_16x16x32_bf16 v[176:179], v[208:211], v[32:35], v[176:179]
    ds_read_b64_tr_b16 v[228:229], v242 offset:50176
    v_mfma_f32_16x16x32_bf16 v[180:183], v[208:211], v[36:39], v[180:183]
    ds_read_b64_tr_b16 v[230:231], v242 offset:50688
    v_mfma_f32_16x16x32_bf16 v[184:187], v[212:215], v[32:35], v[184:187]
    ds_read_b64_tr_b16 v[208:209], v242 offset:57344
    v_mfma_f32_16x16x32_bf16 v[188:191], v[212:215], v[36:39], v[188:191]
    ds_read_b64_tr_b16 v[210:211], v242 offset:57856
    s_add_u32 m0, s52, 0x1a000
    s_add_u32 s50, s50, 294912
    buffer_load_dwordx4 v246, s[16:19], s50 offen lds
    s_waitcnt lgkmcnt(6)
    v_mfma_f32_16x16x32_bf16 v[176:179], v[216:219], v[40:43], v[176:179]
    ds_read_b64_tr_b16 v[212:213], v242 offset:58368
    v_mfma_f32_16x16x32_bf16 v[180:183], v[216:219], v[44:47], v[180:183]
    ds_read_b64_tr_b16 v[214:215], v242 offset:58880
    v_mfma_f32_16x16x32_bf16 v[184:187], v[220:223], v[40:43], v[184:187]
    ds_read_b64_tr_b16 v[216:217], v243 offset:32768
    v_mfma_f32_16x16x32_bf16 v[188:191], v[220:223], v[44:47], v[188:191]
    ds_read_b64_tr_b16 v[218:219], v243 offset:33280
    s_add_u32 m0, s52, 0x1c000
    s_add_u32 s50, s50, 294912
    buffer_load_dwordx4 v246, s[16:19], s50 offen lds
    s_waitcnt lgkmcnt(6)
    v_mfma_f32_16x16x32_bf16 v[176:179], v[224:227], v[48:51], v[176:179]
    ds_read_b64_tr_b16 v[220:221], v243 offset:33792
    v_mfma_f32_16x16x32_bf16 v[180:183], v[224:227], v[52:55], v[180:183]
    ds_read_b64_tr_b16 v[222:223], v243 offset:34304
    s_setprio 0
    v_mfma_f32_16x16x32_bf16 v[184:187], v[228:231], v[48:51], v[184:187]
    ds_read_b64_tr_b16 v[224:225], v243 offset:40960
    v_mfma_f32_16x16x32_bf16 v[188:191], v[228:231], v[52:55], v[188:191]
    ds_read_b64_tr_b16 v[226:227], v243 offset:41472
    s_add_u32 m0, s52, 0x1e000
    s_add_u32 s50, s50, 294912
    buffer_load_dwordx4 v246, s[16:19], s50 offen lds
    s_waitcnt lgkmcnt(6)
    v_mfma_f32_16x16x32_bf16 v[176:179], v[208:211], v[56:59], v[176:179]
    ds_read_b64_tr_b16 v[228:229], v243 offset:41984
    v_mfma_f32_16x16x32_bf16 v[180:183], v[208:211], v[60:63], v[180:183]
    ds_read_b64_tr_b16 v[230:231], v243 offset:42496
    v_mfma_f32_16x16x32_bf16 v[184:187], v[212:215], v[56:59], v[184:187]
    ds_read_b64_tr_b16 v[208:209], v243 offset:49152
    v_mfma_f32_16x16x32_bf16 v[188:191], v[212:215], v[60:63], v[188:191]
    ds_read_b64_tr_b16 v[210:211], v243 offset:49664
    s_add_u32 m0, s52, 0x20000
    s_add_u32 s50, s50, 294912
    buffer_load_dwordx4 v246, s[16:19], s50 offen lds
    s_waitcnt lgkmcnt(6)
    v_mfma_f32_16x16x32_bf16 v[192:195], v[216:219], v[32:35], v[192:195]
    ds_read_b64_tr_b16 v[212:213], v243 offset:50176
    v_mfma_f32_16x16x32_bf16 v[196:199], v[216:219], v[36:39], v[196:199]
    ds_read_b64_tr_b16 v[214:215], v243 offset:50688
    v_mfma_f32_16x16x32_bf16 v[200:203], v[220:223], v[32:35], v[200:203]
    ds_read_b64_tr_b16 v[216:217], v243 offset:57344
    v_mfma_f32_16x16x32_bf16 v[204:207], v[220:223], v[36:39], v[204:207]
    ds_read_b64_tr_b16 v[218:219], v243 offset:57856
    s_add_u32 m0, s52, 0x22000
    s_add_u32 s50, s50, 294912
    buffer_load_dwordx4 v246, s[16:19], s50 offen lds
    s_waitcnt lgkmcnt(6)
    v_mfma_f32_16x16x32_bf16 v[192:195], v[224:227], v[40:43], v[192:195]
    ds_read_b64_tr_b16 v[220:221], v243 offset:58368
    v_mfma_f32_16x16x32_bf16 v[196:199], v[224:227], v[44:47], v[196:199]
    ds_read_b64_tr_b16 v[222:223], v243 offset:58880
    v_mfma_f32_16x16x32_bf16 v[200:203], v[228:231], v[40:43], v[200:203]
    v_mfma_f32_16x16x32_bf16 v[204:207], v[228:231], v[44:47], v[204:207]
    s_add_u32 m0, s52, 0x24000
    s_add_u32 s50, s50, 294912
    buffer_load_dwordx4 v246, s[16:19], s50 offen lds
    s_waitcnt lgkmcnt(4)
    v_mfma_f32_16x16x32_bf16 v[192:195], v[208:211], v[48:51], v[192:195]
    v_mfma_f32_16x16x32_bf16 v[196:199], v[208:211], v[52:55], v[196:199]
    s_waitcnt vmcnt(14) lgkmcnt(0)
    s_barrier
    v_add_u32 v240, 0x10000, v240
    ds_read_b64_tr_b16 v[224:225], v240 offset:0
    ds_read_b64_tr_b16 v[226:227], v240 offset:512
    ds_read_b64_tr_b16 v[228:229], v240 offset:1024
    ds_read_b64_tr_b16 v[230:231], v240 offset:1536
    s_setprio 3
    v_mfma_f32_16x16x32_bf16 v[200:203], v[212:215], v[48:51], v[200:203]
    ds_read_b64_tr_b16 v[208:209], v240 offset:16384
    v_mfma_f32_16x16x32_bf16 v[204:207], v[212:215], v[52:55], v[204:207]
    ds_read_b64_tr_b16 v[210:211], v240 offset:16896
    s_add_u32 s54, s54, 4096
    buffer_load_dwordx4 v[96:99], v245, s[24:27], s54 offen offset:0
    v_mfma_f32_16x16x32_bf16 v[192:195], v[216:219], v[56:59], v[192:195]
    ds_read_b64_tr_b16 v[212:213], v240 offset:17408
    v_mfma_f32_16x16x32_bf16 v[196:199], v[216:219], v[60:63], v[196:199]
    ds_read_b64_tr_b16 v[214:215], v240 offset:17920
    v_mfma_f32_16x16x32_bf16 v[200:203], v[220:223], v[56:59], v[200:203]
    ds_read_b64_tr_b16 v[216:217], v240 offset:24576
    v_mfma_f32_16x16x32_bf16 v[204:207], v[220:223], v[60:63], v[204:207]
    ds_read_b64_tr_b16 v[218:219], v240 offset:25088
    s_add_u32 s55, s55, 4096
    buffer_load_dwordx4 v[100:103], v245, s[24:27], s55 offen offset:0
    s_waitcnt vmcnt(14) lgkmcnt(6)
    v_mfma_f32_16x16x32_bf16 v[144:147], v[224:227], v[64:67], v[144:147]
    ds_read_b64_tr_b16 v[220:221], v240 offset:25600
    v_mfma_f32_16x16x32_bf16 v[148:151], v[224:227], v[68:71], v[148:151]
    ds_read_b64_tr_b16 v[222:223], v240 offset:26112
    v_mfma_f32_16x16x32_bf16 v[152:155], v[228:231], v[64:67], v[152:155]
    ds_read_b64_tr_b16 v[224:225], v240 offset:32768
    v_mfma_f32_16x16x32_bf16 v[156:159], v[228:231], v[68:71], v[156:159]
    ds_read_b64_tr_b16 v[226:227], v240 offset:33280
    buffer_load_dwordx4 v[104:107], v245, s[24:27], s54 offen offset:1024
    s_waitcnt vmcnt(13) lgkmcnt(6)
    v_mfma_f32_16x16x32_bf16 v[144:147], v[208:211], v[72:75], v[144:147]
    ds_read_b64_tr_b16 v[228:229], v240 offset:33792
    v_mfma_f32_16x16x32_bf16 v[148:151], v[208:211], v[76:79], v[148:151]
    ds_read_b64_tr_b16 v[230:231], v240 offset:34304
    v_mfma_f32_16x16x32_bf16 v[152:155], v[212:215], v[72:75], v[152:155]
    v_add_u32 v241, 0x10000, v241
    ds_read_b64_tr_b16 v[208:209], v241 offset:0
    v_mfma_f32_16x16x32_bf16 v[156:159], v[212:215], v[76:79], v[156:159]
    ds_read_b64_tr_b16 v[210:211], v241 offset:512
    buffer_load_dwordx4 v[108:111], v245, s[24:27], s55 offen offset:1024
    s_waitcnt vmcnt(12) lgkmcnt(6)
    v_mfma_f32_16x16x32_bf16 v[144:147], v[216:219], v[80:83], v[144:147]
    ds_read_b64_tr_b16 v[212:213], v241 offset:1024
    v_mfma_f32_16x16x32_bf16 v[148:151], v[216:219], v[84:87], v[148:151]
    ds_read_b64_tr_b16 v[214:215], v241 offset:1536
    s_setprio 2
    v_mfma_f32_16x16x32_bf16 v[152:155], v[220:223], v[80:83], v[152:155]
    ds_read_b64_tr_b16 v[216:217], v241 offset:16384
    v_mfma_f32_16x16x32_bf16 v[156:159], v[220:223], v[84:87], v[156:159]
    ds_read_b64_tr_b16 v[218:219], v241 offset:16896
    buffer_load_dwordx4 v[112:115], v245, s[24:27], s54 offen offset:2048
    s_waitcnt vmcnt(11) lgkmcnt(6)
    v_mfma_f32_16x16x32_bf16 v[144:147], v[224:227], v[88:91], v[144:147]
    ds_read_b64_tr_b16 v[220:221], v241 offset:17408
    v_mfma_f32_16x16x32_bf16 v[148:151], v[224:227], v[92:95], v[148:151]
    ds_read_b64_tr_b16 v[222:223], v241 offset:17920
    v_mfma_f32_16x16x32_bf16 v[152:155], v[228:231], v[88:91], v[152:155]
    ds_read_b64_tr_b16 v[224:225], v241 offset:24576
    v_mfma_f32_16x16x32_bf16 v[156:159], v[228:231], v[92:95], v[156:159]
    ds_read_b64_tr_b16 v[226:227], v241 offset:25088
    buffer_load_dwordx4 v[116:119], v245, s[24:27], s55 offen offset:2048
    s_waitcnt lgkmcnt(6)
    v_mfma_f32_16x16x32_bf16 v[160:163], v[208:211], v[64:67], v[160:163]
    ds_read_b64_tr_b16 v[228:229], v241 offset:25600
    v_mfma_f32_16x16x32_bf16 v[164:167], v[208:211], v[68:71], v[164:167]
    ds_read_b64_tr_b16 v[230:231], v241 offset:26112
    v_mfma_f32_16x16x32_bf16 v[168:171], v[212:215], v[64:67], v[168:171]
    ds_read_b64_tr_b16 v[208:209], v241 offset:32768
    v_mfma_f32_16x16x32_bf16 v[172:175], v[212:215], v[68:71], v[172:175]
    ds_read_b64_tr_b16 v[210:211], v241 offset:33280
    buffer_load_dwordx4 v[120:123], v245, s[24:27], s54 offen offset:3072
    s_waitcnt lgkmcnt(6)
    v_mfma_f32_16x16x32_bf16 v[160:163], v[216:219], v[72:75], v[160:163]
    ds_read_b64_tr_b16 v[212:213], v241 offset:33792
    v_mfma_f32_16x16x32_bf16 v[164:167], v[216:219], v[76:79], v[164:167]
    ds_read_b64_tr_b16 v[214:215], v241 offset:34304
    v_mfma_f32_16x16x32_bf16 v[168:171], v[220:223], v[72:75], v[168:171]
    v_add_u32 v242, 0x10000, v242
    ds_read_b64_tr_b16 v[216:217], v242 offset:0
    v_mfma_f32_16x16x32_bf16 v[172:175], v[220:223], v[76:79], v[172:175]
    ds_read_b64_tr_b16 v[218:219], v242 offset:512
    buffer_load_dwordx4 v[124:127], v245, s[24:27], s55 offen offset:3072
    s_waitcnt lgkmcnt(6)
    v_mfma_f32_16x16x32_bf16 v[160:163], v[224:227], v[80:83], v[160:163]
    ds_read_b64_tr_b16 v[220:221], v242 offset:1024
    v_mfma_f32_16x16x32_bf16 v[164:167], v[224:227], v[84:87], v[164:167]
    ds_read_b64_tr_b16 v[222:223], v242 offset:1536
    s_setprio 1
    v_mfma_f32_16x16x32_bf16 v[168:171], v[228:231], v[80:83], v[168:171]
    ds_read_b64_tr_b16 v[224:225], v242 offset:16384
    v_mfma_f32_16x16x32_bf16 v[172:175], v[228:231], v[84:87], v[172:175]
    ds_read_b64_tr_b16 v[226:227], v242 offset:16896
    s_add_u32 s54, s54, 4096
    buffer_load_dwordx4 v[128:131], v245, s[24:27], s54 offen offset:0
    s_waitcnt lgkmcnt(6)
    v_mfma_f32_16x16x32_bf16 v[160:163], v[208:211], v[88:91], v[160:163]
    ds_read_b64_tr_b16 v[228:229], v242 offset:17408
    v_mfma_f32_16x16x32_bf16 v[164:167], v[208:211], v[92:95], v[164:167]
    ds_read_b64_tr_b16 v[230:231], v242 offset:17920
    v_mfma_f32_16x16x32_bf16 v[168:171], v[212:215], v[88:91], v[168:171]
    ds_read_b64_tr_b16 v[208:209], v242 offset:24576
    v_mfma_f32_16x16x32_bf16 v[172:175], v[212:215], v[92:95], v[172:175]
    ds_read_b64_tr_b16 v[210:211], v242 offset:25088
    s_add_u32 s55, s55, 4096
    buffer_load_dwordx4 v[132:135], v245, s[24:27], s55 offen offset:0
    s_waitcnt lgkmcnt(6)
    v_mfma_f32_16x16x32_bf16 v[176:179], v[216:219], v[64:67], v[176:179]
    ds_read_b64_tr_b16 v[212:213], v242 offset:25600
    v_mfma_f32_16x16x32_bf16 v[180:183], v[216:219], v[68:71], v[180:183]
    ds_read_b64_tr_b16 v[214:215], v242 offset:26112
    v_mfma_f32_16x16x32_bf16 v[184:187], v[220:223], v[64:67], v[184:187]
    ds_read_b64_tr_b16 v[216:217], v242 offset:32768
    v_mfma_f32_16x16x32_bf16 v[188:191], v[220:223], v[68:71], v[188:191]
    ds_read_b64_tr_b16 v[218:219], v242 offset:33280
    buffer_load_dwordx4 v[136:139], v245, s[24:27], s54 offen offset:1024
    s_waitcnt lgkmcnt(6)
    v_mfma_f32_16x16x32_bf16 v[176:179], v[224:227], v[72:75], v[176:179]
    ds_read_b64_tr_b16 v[220:221], v242 offset:33792
    v_mfma_f32_16x16x32_bf16 v[180:183], v[224:227], v[76:79], v[180:183]
    ds_read_b64_tr_b16 v[222:223], v242 offset:34304
    v_mfma_f32_16x16x32_bf16 v[184:187], v[228:231], v[72:75], v[184:187]
    v_add_u32 v243, 0x10000, v243
    ds_read_b64_tr_b16 v[224:225], v243 offset:0
    v_mfma_f32_16x16x32_bf16 v[188:191], v[228:231], v[76:79], v[188:191]
    ds_read_b64_tr_b16 v[226:227], v243 offset:512
    s_mov_b32 exec_lo, 0x1ff
    s_mov_b32 exec_hi, 0x0
    buffer_load_dword v255, v253, s[56:59], s38 offen
    s_mov_b64 exec, -1
    buffer_load_dwordx4 v[140:143], v245, s[24:27], s55 offen offset:1024
    s_waitcnt lgkmcnt(6)
    v_mfma_f32_16x16x32_bf16 v[176:179], v[208:211], v[80:83], v[176:179]
    ds_read_b64_tr_b16 v[228:229], v243 offset:1024
    v_mfma_f32_16x16x32_bf16 v[180:183], v[208:211], v[84:87], v[180:183]
    ds_read_b64_tr_b16 v[230:231], v243 offset:1536
    s_setprio 0
    v_mfma_f32_16x16x32_bf16 v[184:187], v[212:215], v[80:83], v[184:187]
    ds_read_b64_tr_b16 v[208:209], v243 offset:16384
    v_mfma_f32_16x16x32_bf16 v[188:191], v[212:215], v[84:87], v[188:191]
    ds_read_b64_tr_b16 v[210:211], v243 offset:16896
    s_waitcnt lgkmcnt(6)
    v_mfma_f32_16x16x32_bf16 v[176:179], v[216:219], v[88:91], v[176:179]
    ds_read_b64_tr_b16 v[212:213], v243 offset:17408
    v_mfma_f32_16x16x32_bf16 v[180:183], v[216:219], v[92:95], v[180:183]
    ds_read_b64_tr_b16 v[214:215], v243 offset:17920
    v_mfma_f32_16x16x32_bf16 v[184:187], v[220:223], v[88:91], v[184:187]
    ds_read_b64_tr_b16 v[216:217], v243 offset:24576
    v_mfma_f32_16x16x32_bf16 v[188:191], v[220:223], v[92:95], v[188:191]
    ds_read_b64_tr_b16 v[218:219], v243 offset:25088
    s_mov_b32 exec_lo, 0x7c0000
    s_mov_b32 exec_hi, 0x0
    buffer_load_dword v255, v252, s[16:19], s53 offen
    s_mov_b64 exec, -1
    s_waitcnt lgkmcnt(6)
    v_mfma_f32_16x16x32_bf16 v[192:195], v[224:227], v[64:67], v[192:195]
    ds_read_b64_tr_b16 v[220:221], v243 offset:25600
    v_mfma_f32_16x16x32_bf16 v[196:199], v[224:227], v[68:71], v[196:199]
    ds_read_b64_tr_b16 v[222:223], v243 offset:26112
    v_mfma_f32_16x16x32_bf16 v[200:203], v[228:231], v[64:67], v[200:203]
    ds_read_b64_tr_b16 v[224:225], v243 offset:32768
    v_mfma_f32_16x16x32_bf16 v[204:207], v[228:231], v[68:71], v[204:207]
    ds_read_b64_tr_b16 v[226:227], v243 offset:33280
    s_waitcnt lgkmcnt(6)
    v_mfma_f32_16x16x32_bf16 v[192:195], v[208:211], v[72:75], v[192:195]
    ds_read_b64_tr_b16 v[228:229], v243 offset:33792
    v_mfma_f32_16x16x32_bf16 v[196:199], v[208:211], v[76:79], v[196:199]
    ds_read_b64_tr_b16 v[230:231], v243 offset:34304
    v_mfma_f32_16x16x32_bf16 v[200:203], v[212:215], v[72:75], v[200:203]
    v_mfma_f32_16x16x32_bf16 v[204:207], v[212:215], v[76:79], v[204:207]
    s_waitcnt lgkmcnt(4)
    v_mfma_f32_16x16x32_bf16 v[192:195], v[216:219], v[80:83], v[192:195]
    v_mfma_f32_16x16x32_bf16 v[196:199], v[216:219], v[84:87], v[196:199]
    s_waitcnt vmcnt(14) lgkmcnt(0)
    s_barrier
    ds_read_b64_tr_b16 v[208:209], v240 offset:40960
    ds_read_b64_tr_b16 v[210:211], v240 offset:41472
    ds_read_b64_tr_b16 v[212:213], v240 offset:41984
    ds_read_b64_tr_b16 v[214:215], v240 offset:42496
    s_setprio 3
    v_mfma_f32_16x16x32_bf16 v[200:203], v[220:223], v[80:83], v[200:203]
    ds_read_b64_tr_b16 v[216:217], v240 offset:49152
    v_mfma_f32_16x16x32_bf16 v[204:207], v[220:223], v[84:87], v[204:207]
    ds_read_b64_tr_b16 v[218:219], v240 offset:49664
    v_mfma_f32_16x16x32_bf16 v[192:195], v[224:227], v[88:91], v[192:195]
    ds_read_b64_tr_b16 v[220:221], v240 offset:50176
    v_mfma_f32_16x16x32_bf16 v[196:199], v[224:227], v[92:95], v[196:199]
    ds_read_b64_tr_b16 v[222:223], v240 offset:50688
    v_mfma_f32_16x16x32_bf16 v[200:203], v[228:231], v[88:91], v[200:203]
    ds_read_b64_tr_b16 v[224:225], v240 offset:57344
    v_mfma_f32_16x16x32_bf16 v[204:207], v[228:231], v[92:95], v[204:207]
    ds_read_b64_tr_b16 v[226:227], v240 offset:57856
    s_waitcnt vmcnt(12) lgkmcnt(6)
    v_mfma_f32_16x16x32_bf16 v[144:147], v[208:211], v[96:99], v[144:147]
    ds_read_b64_tr_b16 v[228:229], v240 offset:58368
    v_mfma_f32_16x16x32_bf16 v[148:151], v[208:211], v[100:103], v[148:151]
    ds_read_b64_tr_b16 v[230:231], v240 offset:58880
    v_mfma_f32_16x16x32_bf16 v[152:155], v[212:215], v[96:99], v[152:155]
    v_add_u32 v240, 0x10000, v240
    ds_read_b64_tr_b16 v[208:209], v240 offset:0
    v_mfma_f32_16x16x32_bf16 v[156:159], v[212:215], v[100:103], v[156:159]
    ds_read_b64_tr_b16 v[210:211], v240 offset:512
    s_waitcnt vmcnt(10) lgkmcnt(6)
    v_mfma_f32_16x16x32_bf16 v[144:147], v[216:219], v[104:107], v[144:147]
    ds_read_b64_tr_b16 v[212:213], v240 offset:1024
    v_mfma_f32_16x16x32_bf16 v[148:151], v[216:219], v[108:111], v[148:151]
    ds_read_b64_tr_b16 v[214:215], v240 offset:1536
    v_mfma_f32_16x16x32_bf16 v[152:155], v[220:223], v[104:107], v[152:155]
    ds_read_b64_tr_b16 v[216:217], v240 offset:8192
    v_mfma_f32_16x16x32_bf16 v[156:159], v[220:223], v[108:111], v[156:159]
    ds_read_b64_tr_b16 v[218:219], v240 offset:8704
    s_waitcnt vmcnt(8) lgkmcnt(6)
    v_mfma_f32_16x16x32_bf16 v[144:147], v[224:227], v[112:115], v[144:147]
    ds_read_b64_tr_b16 v[220:221], v240 offset:9216
    v_mfma_f32_16x16x32_bf16 v[148:151], v[224:227], v[116:119], v[148:151]
    ds_read_b64_tr_b16 v[222:223], v240 offset:9728
    v_mfma_f32_16x16x32_bf16 v[152:155], v[228:231], v[112:115], v[152:155]
    ds_read_b64_tr_b16 v[224:225], v240 offset:16384
    v_mfma_f32_16x16x32_bf16 v[156:159], v[228:231], v[116:119], v[156:159]
    ds_read_b64_tr_b16 v[226:227], v240 offset:16896
    s_waitcnt vmcnt(6) lgkmcnt(6)
    v_mfma_f32_16x16x32_bf16 v[144:147], v[208:211], v[120:123], v[144:147]
    ds_read_b64_tr_b16 v[228:229], v240 offset:17408
    v_mfma_f32_16x16x32_bf16 v[148:151], v[208:211], v[124:127], v[148:151]
    ds_read_b64_tr_b16 v[230:231], v240 offset:17920
    s_add_u32 m0, s52, 0x0
    s_mov_b32 s50, 0
    buffer_load_dwordx4 v248, s[20:23], s50 offen lds
    v_mfma_f32_16x16x32_bf16 v[152:155], v[212:215], v[120:123], v[152:155]
    ds_read_b64_tr_b16 v[208:209], v241 offset:40960
    v_mfma_f32_16x16x32_bf16 v[156:159], v[212:215], v[124:127], v[156:159]
    ds_read_b64_tr_b16 v[210:211], v241 offset:41472
    s_waitcnt vmcnt(5) lgkmcnt(6)
    v_mfma_f32_16x16x32_bf16 v[144:147], v[216:219], v[128:131], v[144:147]
    ds_read_b64_tr_b16 v[212:213], v241 offset:41984
    v_mfma_f32_16x16x32_bf16 v[148:151], v[216:219], v[132:135], v[148:151]
    ds_read_b64_tr_b16 v[214:215], v241 offset:42496
    s_setprio 2
    v_mfma_f32_16x16x32_bf16 v[152:155], v[220:223], v[128:131], v[152:155]
    ds_read_b64_tr_b16 v[216:217], v241 offset:49152
    v_mfma_f32_16x16x32_bf16 v[156:159], v[220:223], v[132:135], v[156:159]
    ds_read_b64_tr_b16 v[218:219], v241 offset:49664
    s_add_u32 m0, s52, 0x2000
    s_add_u32 s50, s50, s51
    buffer_load_dwordx4 v248, s[20:23], s50 offen lds
    s_waitcnt vmcnt(3) lgkmcnt(6)
    v_mfma_f32_16x16x32_bf16 v[144:147], v[224:227], v[136:139], v[144:147]
    ds_read_b64_tr_b16 v[220:221], v241 offset:50176
    v_mfma_f32_16x16x32_bf16 v[148:151], v[224:227], v[140:143], v[148:151]
    ds_read_b64_tr_b16 v[222:223], v241 offset:50688
    v_mfma_f32_16x16x32_bf16 v[152:155], v[228:231], v[136:139], v[152:155]
    ds_read_b64_tr_b16 v[224:225], v241 offset:57344
    v_mfma_f32_16x16x32_bf16 v[156:159], v[228:231], v[140:143], v[156:159]
    ds_read_b64_tr_b16 v[226:227], v241 offset:57856
    s_waitcnt lgkmcnt(6)
    v_mfma_f32_16x16x32_bf16 v[160:163], v[208:211], v[96:99], v[160:163]
    ds_read_b64_tr_b16 v[228:229], v241 offset:58368
    v_mfma_f32_16x16x32_bf16 v[164:167], v[208:211], v[100:103], v[164:167]
    ds_read_b64_tr_b16 v[230:231], v241 offset:58880
    s_add_u32 m0, s52, 0x4000
    s_add_u32 s50, s50, s51
    buffer_load_dwordx4 v248, s[20:23], s50 offen lds
    v_mfma_f32_16x16x32_bf16 v[168:171], v[212:215], v[96:99], v[168:171]
    v_add_u32 v241, 0x10000, v241
    ds_read_b64_tr_b16 v[208:209], v241 offset:0
    v_mfma_f32_16x16x32_bf16 v[172:175], v[212:215], v[100:103], v[172:175]
    ds_read_b64_tr_b16 v[210:211], v241 offset:512
    s_waitcnt lgkmcnt(6)
    v_mfma_f32_16x16x32_bf16 v[160:163], v[216:219], v[104:107], v[160:163]
    ds_read_b64_tr_b16 v[212:213], v241 offset:1024
    v_mfma_f32_16x16x32_bf16 v[164:167], v[216:219], v[108:111], v[164:167]
    ds_read_b64_tr_b16 v[214:215], v241 offset:1536
    v_mfma_f32_16x16x32_bf16 v[168:171], v[220:223], v[104:107], v[168:171]
    ds_read_b64_tr_b16 v[216:217], v241 offset:8192
    v_mul_f32 v152, v144, v152
    v_mfma_f32_16x16x32_bf16 v[172:175], v[220:223], v[108:111], v[172:175]
    ds_read_b64_tr_b16 v[218:219], v241 offset:8704
    v_mul_f32 v144, v250, v144
    v_mul_f32 v153, v145, v153
    s_add_u32 m0, s52, 0x6000
    s_add_u32 s50, s50, s51
    buffer_load_dwordx4 v248, s[20:23], s50 offen lds
    s_waitcnt lgkmcnt(6)
    v_mfma_f32_16x16x32_bf16 v[160:163], v[224:227], v[112:115], v[160:163]
    ds_read_b64_tr_b16 v[220:221], v241 offset:9216
    v_exp_f32 v144, v144
    v_mfma_f32_16x16x32_bf16 v[164:167], v[224:227], v[116:119], v[164:167]
    ds_read_b64_tr_b16 v[222:223], v241 offset:9728
    v_mul_f32 v145, v250, v145
    v_mfma_f32_16x16x32_bf16 v[168:171], v[228:231], v[112:115], v[168:171]
    ds_read_b64_tr_b16 v[224:225], v241 offset:16384
    v_mul_f32 v154, v146, v154
    v_mfma_f32_16x16x32_bf16 v[172:175], v[228:231], v[116:119], v[172:175]
    ds_read_b64_tr_b16 v[226:227], v241 offset:16896
    v_add_f32 v144, 1.0, v144
    s_waitcnt lgkmcnt(6)
    v_mfma_f32_16x16x32_bf16 v[160:163], v[208:211], v[120:123], v[160:163]
    ds_read_b64_tr_b16 v[228:229], v241 offset:17408
    v_exp_f32 v145, v145
    v_mfma_f32_16x16x32_bf16 v[164:167], v[208:211], v[124:127], v[164:167]
    ds_read_b64_tr_b16 v[230:231], v241 offset:17920
    v_mul_f32 v146, v250, v146
    v_mul_f32 v155, v147, v155
    s_add_u32 m0, s52, 0x8000
    s_add_u32 s50, s50, s51
    buffer_load_dwordx4 v248, s[20:23], s50 offen lds
    v_mfma_f32_16x16x32_bf16 v[168:171], v[212:215], v[120:123], v[168:171]
    ds_read_b64_tr_b16 v[208:209], v242 offset:40960
    v_rcp_f32 v144, v144
    v_mfma_f32_16x16x32_bf16 v[172:175], v[212:215], v[124:127], v[172:175]
    ds_read_b64_tr_b16 v[210:211], v242 offset:41472
    v_add_f32 v145, 1.0, v145
    s_waitcnt lgkmcnt(6)
    v_mfma_f32_16x16x32_bf16 v[160:163], v[216:219], v[128:131], v[160:163]
    ds_read_b64_tr_b16 v[212:213], v242 offset:41984
    v_exp_f32 v146, v146
    v_mfma_f32_16x16x32_bf16 v[164:167], v[216:219], v[132:135], v[164:167]
    ds_read_b64_tr_b16 v[214:215], v242 offset:42496
    v_mul_f32 v147, v250, v147
    s_setprio 1
    v_mfma_f32_16x16x32_bf16 v[168:171], v[220:223], v[128:131], v[168:171]
    ds_read_b64_tr_b16 v[216:217], v242 offset:49152
    v_mul_f32 v156, v148, v156
    v_mfma_f32_16x16x32_bf16 v[172:175], v[220:223], v[132:135], v[172:175]
    ds_read_b64_tr_b16 v[218:219], v242 offset:49664
    v_mul_f32 v152, v144, v152
    v_rcp_f32 v145, v145
    s_add_u32 m0, s52, 0xa000
    s_add_u32 s50, s50, s51
    buffer_load_dwordx4 v248, s[20:23], s50 offen lds
    s_waitcnt lgkmcnt(6)
    v_mfma_f32_16x16x32_bf16 v[160:163], v[224:227], v[136:139], v[160:163]
    ds_read_b64_tr_b16 v[220:221], v242 offset:50176
    v_add_f32 v146, 1.0, v146
    v_mfma_f32_16x16x32_bf16 v[164:167], v[224:227], v[140:143], v[164:167]
    ds_read_b64_tr_b16 v[222:223], v242 offset:50688
    v_exp_f32 v147, v147
    v_mfma_f32_16x16x32_bf16 v[168:171], v[228:231], v[136:139], v[168:171]
    ds_read_b64_tr_b16 v[224:225], v242 offset:57344
    v_mul_f32 v148, v250, v148
    v_mfma_f32_16x16x32_bf16 v[172:175], v[228:231], v[140:143], v[172:175]
    ds_read_b64_tr_b16 v[226:227], v242 offset:57856
    v_mul_f32 v157, v149, v157
    s_waitcnt lgkmcnt(6)
    v_mfma_f32_16x16x32_bf16 v[176:179], v[208:211], v[96:99], v[176:179]
    ds_read_b64_tr_b16 v[228:229], v242 offset:58368
    v_mul_f32 v153, v145, v153
    v_mfma_f32_16x16x32_bf16 v[180:183], v[208:211], v[100:103], v[180:183]
    ds_read_b64_tr_b16 v[230:231], v242 offset:58880
    v_rcp_f32 v146, v146
    v_add_f32 v147, 1.0, v147
    s_add_u32 m0, s52, 0xc000
    s_add_u32 s50, s50, s51
    buffer_load_dwordx4 v248, s[20:23], s50 offen lds
    v_mfma_f32_16x16x32_bf16 v[184:187], v[212:215], v[96:99], v[184:187]
    v_add_u32 v242, 0x10000, v242
    ds_read_b64_tr_b16 v[208:209], v242 offset:0
    v_exp_f32 v148, v148
    v_mfma_f32_16x16x32_bf16 v[188:191], v[212:215], v[100:103], v[188:191]
    ds_read_b64_tr_b16 v[210:211], v242 offset:512
    v_mul_f32 v149, v250, v149
    s_waitcnt lgkmcnt(6)
    v_mfma_f32_16x16x32_bf16 v[176:179], v[216:219], v[104:107], v[176:179]
    ds_read_b64_tr_b16 v[212:213], v242 offset:1024
    v_mul_f32 v158, v150, v158
    v_mfma_f32_16x16x32_bf16 v[180:183], v[216:219], v[108:111], v[180:183]
    ds_read_b64_tr_b16 v[214:215], v242 offset:1536
    v_mul_f32 v154, v146, v154
    v_mfma_f32_16x16x32_bf16 v[184:187], v[220:223], v[104:107], v[184:187]
    ds_read_b64_tr_b16 v[216:217], v242 offset:8192
    v_rcp_f32 v147, v147
    v_mfma_f32_16x16x32_bf16 v[188:191], v[220:223], v[108:111], v[188:191]
    ds_read_b64_tr_b16 v[218:219], v242 offset:8704
    v_add_f32 v148, 1.0, v148
    s_add_u32 m0, s52, 0xe000
    s_add_u32 s50, s50, s51
    buffer_load_dwordx4 v248, s[20:23], s50 offen lds
    s_waitcnt lgkmcnt(6)
    v_mfma_f32_16x16x32_bf16 v[176:179], v[224:227], v[112:115], v[176:179]
    ds_read_b64_tr_b16 v[220:221], v242 offset:9216
    v_exp_f32 v149, v149
    v_mfma_f32_16x16x32_bf16 v[180:183], v[224:227], v[116:119], v[180:183]
    ds_read_b64_tr_b16 v[222:223], v242 offset:9728
    v_mul_f32 v150, v250, v150
    v_mul_f32 v159, v151, v159
    v_mfma_f32_16x16x32_bf16 v[184:187], v[228:231], v[112:115], v[184:187]
    ds_read_b64_tr_b16 v[224:225], v242 offset:16384
    v_mul_f32 v155, v147, v155
    v_mfma_f32_16x16x32_bf16 v[188:191], v[228:231], v[116:119], v[188:191]
    ds_read_b64_tr_b16 v[226:227], v242 offset:16896
    v_rcp_f32 v148, v148
    s_waitcnt lgkmcnt(6)
    v_mfma_f32_16x16x32_bf16 v[176:179], v[208:211], v[120:123], v[176:179]
    ds_read_b64_tr_b16 v[228:229], v242 offset:17408
    v_add_f32 v149, 1.0, v149
    v_mfma_f32_16x16x32_bf16 v[180:183], v[208:211], v[124:127], v[180:183]
    ds_read_b64_tr_b16 v[230:231], v242 offset:17920
    v_exp_f32 v150, v150
    s_add_u32 m0, s52, 0x10000
    s_add_u32 s50, s50, s51
    buffer_load_dwordx4 v248, s[20:23], s50 offen lds
    v_mfma_f32_16x16x32_bf16 v[184:187], v[212:215], v[120:123], v[184:187]
    ds_read_b64_tr_b16 v[208:209], v243 offset:40960
    v_mul_f32 v151, v250, v151
    v_mfma_f32_16x16x32_bf16 v[188:191], v[212:215], v[124:127], v[188:191]
    ds_read_b64_tr_b16 v[210:211], v243 offset:41472
    v_mul_f32 v156, v148, v156
    v_rcp_f32 v149, v149
    s_waitcnt lgkmcnt(6)
    v_mfma_f32_16x16x32_bf16 v[176:179], v[216:219], v[128:131], v[176:179]
    ds_read_b64_tr_b16 v[212:213], v243 offset:41984
    v_add_f32 v150, 1.0, v150
    v_mfma_f32_16x16x32_bf16 v[180:183], v[216:219], v[132:135], v[180:183]
    ds_read_b64_tr_b16 v[214:215], v243 offset:42496
    v_exp_f32 v151, v151
    s_setprio 0
    v_mfma_f32_16x16x32_bf16 v[184:187], v[220:223], v[128:131], v[184:187]
    ds_read_b64_tr_b16 v[216:217], v243 offset:49152
    v_mul_f32 v157, v149, v157
    v_mfma_f32_16x16x32_bf16 v[188:191], v[220:223], v[132:135], v[188:191]
    ds_read_b64_tr_b16 v[218:219], v243 offset:49664
    v_rcp_f32 v150, v150
    s_add_u32 m0, s52, 0x14000
    s_add_u32 s50, s50, s51
    buffer_load_dwordx4 v248, s[20:23], s50 offen lds
    s_cmp_ge_u32 s14, 24
    s_cbranch_scc1 KM_ROLEA
    s_waitcnt lgkmcnt(6)
    v_mfma_f32_16x16x32_bf16 v[176:179], v[224:227], v[136:139], v[176:179]
    ds_read_b64_tr_b16 v[220:221], v243 offset:50176
    v_add_f32 v151, 1.0, v151
    v_mfma_f32_16x16x32_bf16 v[180:183], v[224:227], v[140:143], v[180:183]
    ds_read_b64_tr_b16 v[222:223], v243 offset:50688
    v_mul_f32 v158, v150, v158
    v_rcp_f32 v151, v151
    v_mfma_f32_16x16x32_bf16 v[184:187], v[228:231], v[136:139], v[184:187]
    ds_read_b64_tr_b16 v[224:225], v243 offset:57344
    s_nop 0
    v_mfma_f32_16x16x32_bf16 v[188:191], v[228:231], v[140:143], v[188:191]
    ds_read_b64_tr_b16 v[226:227], v243 offset:57856
    v_mul_f32 v159, v151, v159
    s_waitcnt lgkmcnt(6)
    v_mfma_f32_16x16x32_bf16 v[192:195], v[208:211], v[96:99], v[192:195]
    ds_read_b64_tr_b16 v[228:229], v243 offset:58368
    v_cvt_pk_bf16_f32 v232, v152, v153
    v_mfma_f32_16x16x32_bf16 v[196:199], v[208:211], v[100:103], v[196:199]
    ds_read_b64_tr_b16 v[230:231], v243 offset:58880
    v_cvt_pk_bf16_f32 v233, v154, v155
    s_add_u32 m0, s52, 0x16000
    s_add_u32 s50, s50, s51
    buffer_load_dwordx4 v248, s[20:23], s50 offen lds
    v_mfma_f32_16x16x32_bf16 v[200:203], v[212:215], v[96:99], v[200:203]
    v_add_u32 v243, 0x10000, v243
    ds_read_b64_tr_b16 v[208:209], v243 offset:0
    v_cvt_pk_bf16_f32 v236, v156, v157
    v_mfma_f32_16x16x32_bf16 v[204:207], v[212:215], v[100:103], v[204:207]
    ds_read_b64_tr_b16 v[210:211], v243 offset:512
    v_cvt_pk_bf16_f32 v237, v158, v159
    s_waitcnt lgkmcnt(6)
    v_mfma_f32_16x16x32_bf16 v[192:195], v[216:219], v[104:107], v[192:195]
    ds_read_b64_tr_b16 v[212:213], v243 offset:1024
    v_mul_f32 v168, v160, v168
    v_mfma_f32_16x16x32_bf16 v[196:199], v[216:219], v[108:111], v[196:199]
    ds_read_b64_tr_b16 v[214:215], v243 offset:1536
    v_mul_f32 v160, v250, v160
    v_mul_f32 v169, v161, v169
    v_mfma_f32_16x16x32_bf16 v[200:203], v[220:223], v[104:107], v[200:203]
    ds_read_b64_tr_b16 v[216:217], v243 offset:8192
    v_exp_f32 v160, v160
    v_mfma_f32_16x16x32_bf16 v[204:207], v[220:223], v[108:111], v[204:207]
    ds_read_b64_tr_b16 v[218:219], v243 offset:8704
    v_mul_f32 v161, v250, v161
    s_waitcnt lgkmcnt(6)
    v_mfma_f32_16x16x32_bf16 v[192:195], v[224:227], v[112:115], v[192:195]
    ds_read_b64_tr_b16 v[220:221], v243 offset:9216
    v_mul_f32 v170, v162, v170
    v_mfma_f32_16x16x32_bf16 v[196:199], v[224:227], v[116:119], v[196:199]
    ds_read_b64_tr_b16 v[222:223], v243 offset:9728
    v_add_f32 v160, 1.0, v160
    v_exp_f32 v161, v161
    s_add_u32 m0, s52, 0x18000
    s_add_u32 s50, s50, s51
    buffer_load_dwordx4 v248, s[20:23], s50 offen lds
    v_mfma_f32_16x16x32_bf16 v[200:203], v[228:231], v[112:115], v[200:203]
    ds_read_b64_tr_b16 v[224:225], v243 offset:16384
    v_mul_f32 v162, v250, v162
    v_mfma_f32_16x16x32_bf16 v[204:207], v[228:231], v[116:119], v[204:207]
    ds_read_b64_tr_b16 v[226:227], v243 offset:16896
    v_mul_f32 v171, v163, v171
    s_waitcnt lgkmcnt(6)
    v_mfma_f32_16x16x32_bf16 v[192:195], v[208:211], v[120:123], v[192:195]
    ds_read_b64_tr_b16 v[228:229], v243 offset:17408
    v_rcp_f32 v160, v160
    v_mfma_f32_16x16x32_bf16 v[196:199], v[208:211], v[124:127], v[196:199]
    ds_read_b64_tr_b16 v[230:231], v243 offset:17920
    v_add_f32 v161, 1.0, v161
    v_exp_f32 v162, v162
    v_mfma_f32_16x16x32_bf16 v[200:203], v[212:215], v[120:123], v[200:203]
    v_mul_f32 v163, v250, v163
    v_mfma_f32_16x16x32_bf16 v[204:207], v[212:215], v[124:127], v[204:207]
    v_mul_f32 v172, v164, v172
    s_waitcnt lgkmcnt(4)
    v_mfma_f32_16x16x32_bf16 v[192:195], v[216:219], v[128:131], v[192:195]
    v_mul_f32 v168, v160, v168
    v_rcp_f32 v161, v161
    v_add_f32 v162, 1.0, v162
    v_mfma_f32_16x16x32_bf16 v[196:199], v[216:219], v[132:135], v[196:199]
    s_waitcnt vmcnt(3) lgkmcnt(0)
    s_barrier
    ds_read_b64_tr_b16 v[208:209], v244 offset:1024
    ds_read_b64_tr_b16 v[210:211], v244 offset:1152
    ds_read_b64_tr_b16 v[212:213], v244 offset:3072
    ds_read_b64_tr_b16 v[214:215], v244 offset:3200
    s_add_u32 m0, s52, 0x1a000
    s_add_u32 s50, s50, s51
    buffer_load_dwordx4 v248, s[20:23], s50 offen lds
    s_setprio 3
    v_mfma_f32_16x16x32_bf16 v[200:203], v[220:223], v[128:131], v[200:203]
    ds_read_b64_tr_b16 v[216:217], v244 offset:9216
    v_exp_f32 v163, v163
    v_mfma_f32_16x16x32_bf16 v[204:207], v[220:223], v[132:135], v[204:207]
    ds_read_b64_tr_b16 v[218:219], v244 offset:9344
    v_mul_f32 v164, v250, v164
    v_mfma_f32_16x16x32_bf16 v[192:195], v[224:227], v[136:139], v[192:195]
    ds_read_b64_tr_b16 v[220:221], v244 offset:11264
    v_mul_f32 v173, v165, v173
    v_mfma_f32_16x16x32_bf16 v[196:199], v[224:227], v[140:143], v[196:199]
    ds_read_b64_tr_b16 v[222:223], v244 offset:11392
    v_mul_f32 v169, v161, v169
    v_mfma_f32_16x16x32_bf16 v[200:203], v[228:231], v[136:139], v[200:203]
    ds_read_b64_tr_b16 v[224:225], v244 offset:17408
    v_rcp_f32 v162, v162
    v_mfma_f32_16x16x32_bf16 v[204:207], v[228:231], v[140:143], v[204:207]
    ds_read_b64_tr_b16 v[226:227], v244 offset:17536
    v_add_f32 v163, 1.0, v163
    v_exp_f32 v164, v164
    s_waitcnt lgkmcnt(6)
    v_mfma_f32_16x16x32_bf16 v[144:147], v[208:211], v[0:3], 0
    ds_read_b64_tr_b16 v[228:229], v244 offset:19456
    v_mul_f32 v165, v250, v165
    v_mfma_f32_16x16x32_bf16 v[148:151], v[208:211], v[4:7], 0
    ds_read_b64_tr_b16 v[230:231], v244 offset:19584
    v_mul_f32 v174, v166, v174
    s_add_u32 m0, s52, 0x1c000
    s_add_u32 s50, s50, s51
    buffer_load_dwordx4 v248, s[20:23], s50 offen lds
    v_mfma_f32_16x16x32_bf16 v[152:155], v[212:215], v[0:3], 0
    ds_read_b64_tr_b16 v[208:209], v244 offset:25600
    v_mul_f32 v170, v162, v170
    v_mfma_f32_16x16x32_bf16 v[156:159], v[212:215], v[4:7], 0
    ds_read_b64_tr_b16 v[210:211], v244 offset:25728
    v_rcp_f32 v163, v163
    v_add_f32 v164, 1.0, v164
    s_waitcnt lgkmcnt(6)
    v_mfma_f32_16x16x32_bf16 v[144:147], v[216:219], v[8:11], v[144:147]
    ds_read_b64_tr_b16 v[212:213], v244 offset:27648
    v_exp_f32 v165, v165
    v_mfma_f32_16x16x32_bf16 v[148:151], v[216:219], v[12:15], v[148:151]
    ds_read_b64_tr_b16 v[214:215], v244 offset:27776
    v_mul_f32 v166, v250, v166
    v_mfma_f32_16x16x32_bf16 v[152:155], v[220:223], v[8:11], v[152:155]
    ds_read_b64_tr_b16 v[216:217], v244 offset:33792
    v_mul_f32 v175, v167, v175
    v_mfma_f32_16x16x32_bf16 v[156:159], v[220:223], v[12:15], v[156:159]
    ds_read_b64_tr_b16 v[218:219], v244 offset:33920
    v_mul_f32 v171, v163, v171
    v_rcp_f32 v164, v164
    s_waitcnt lgkmcnt(6)
    v_mfma_f32_16x16x32_bf16 v[144:147], v[224:227], v[16:19], v[144:147]
    ds_read_b64_tr_b16 v[220:221], v244 offset:35840
    v_add_f32 v165, 1.0, v165
    v_mfma_f32_16x16x32_bf16 v[148:151], v[224:227], v[20:23], v[148:151]
    ds_read_b64_tr_b16 v[222:223], v244 offset:35968
    v_exp_f32 v166, v166
    s_add_u32 m0, s52, 0x1e000
    s_add_u32 s50, s50, s51
    buffer_load_dwordx4 v248, s[20:23], s50 offen lds
    v_mfma_f32_16x16x32_bf16 v[152:155], v[228:231], v[16:19], v[152:155]
    ds_read_b64_tr_b16 v[224:225], v244 offset:41984
    v_mul_f32 v167, v250, v167
    v_mfma_f32_16x16x32_bf16 v[156:159], v[228:231], v[20:23], v[156:159]
    ds_read_b64_tr_b16 v[226:227], v244 offset:42112
    v_mul_f32 v172, v164, v172
    s_waitcnt lgkmcnt(6)
    v_mfma_f32_16x16x32_bf16 v[144:147], v[208:211], v[24:27], v[144:147]
    ds_read_b64_tr_b16 v[228:229], v244 offset:44032
    v_rcp_f32 v165, v165
    v_mfma_f32_16x16x32_bf16 v[148:151], v[208:211], v[28:31], v[148:151]
    ds_read_b64_tr_b16 v[230:231], v244 offset:44160
    v_add_f32 v166, 1.0, v166
    v_exp_f32 v167, v167
    v_mfma_f32_16x16x32_bf16 v[152:155], v[212:215], v[24:27], v[152:155]
    ds_read_b64_tr_b16 v[208:209], v244 offset:50176
    v_mul_f32 v173, v165, v173
    v_mfma_f32_16x16x32_bf16 v[156:159], v[212:215], v[28:31], v[156:159]
    ds_read_b64_tr_b16 v[210:211], v244 offset:50304
    v_rcp_f32 v166, v166
    s_waitcnt lgkmcnt(6)
    v_mfma_f32_16x16x32_bf16 v[144:147], v[216:219], v[32:35], v[144:147]
    ds_read_b64_tr_b16 v[212:213], v244 offset:52224
    v_add_f32 v167, 1.0, v167
    v_mfma_f32_16x16x32_bf16 v[148:151], v[216:219], v[36:39], v[148:151]
    ds_read_b64_tr_b16 v[214:215], v244 offset:52352
    v_mul_f32 v174, v166, v174
    v_rcp_f32 v167, v167
    s_add_u32 m0, s52, 0x20000
    s_add_u32 s50, s50, s51
    buffer_load_dwordx4 v248, s[20:23], s50 offen lds
    v_mfma_f32_16x16x32_bf16 v[152:155], v[220:223], v[32:35], v[152:155]
    ds_read_b64_tr_b16 v[216:217], v244 offset:58368
    s_nop 0
    v_mfma_f32_16x16x32_bf16 v[156:159], v[220:223], v[36:39], v[156:159]
    ds_read_b64_tr_b16 v[218:219], v244 offset:58496
    v_mul_f32 v175, v167, v175
    s_waitcnt lgkmcnt(6)
    s_setprio 2
    v_mfma_f32_16x16x32_bf16 v[144:147], v[224:227], v[40:43], v[144:147]
    ds_read_b64_tr_b16 v[220:221], v244 offset:60416
    v_cvt_pk_bf16_f32 v234, v168, v169
    v_mfma_f32_16x16x32_bf16 v[148:151], v[224:227], v[44:47], v[148:151]
    ds_read_b64_tr_b16 v[222:223], v244 offset:60544
    v_cvt_pk_bf16_f32 v235, v170, v171
    v_cvt_pk_bf16_f32 v238, v172, v173
    v_mfma_f32_16x16x32_bf16 v[152:155], v[228:231], v[40:43], v[152:155]
    v_add_u32 v244, 0x10000, v244
    ds_read_b64_tr_b16 v[224:225], v244 offset:1024
    v_cvt_pk_bf16_f32 v239, v174, v175
    v_mfma_f32_16x16x32_bf16 v[156:159], v[228:231], v[44:47], v[156:159]
    ds_read_b64_tr_b16 v[226:227], v244 offset:1152
    buffer_store_dwordx4 v[232:235], v245, s[24:27], s40 offen sc1
    s_waitcnt lgkmcnt(6)
    v_mfma_f32_16x16x32_bf16 v[144:147], v[208:211], v[48:51], v[144:147]
    ds_read_b64_tr_b16 v[228:229], v244 offset:3072
    s_add_u32 s48, s40, 148480
    v_mfma_f32_16x16x32_bf16 v[148:151], v[208:211], v[52:55], v[148:151]
    ds_read_b64_tr_b16 v[230:231], v244 offset:3200
    buffer_store_dwordx4 v[236:239], v245, s[24:27], s48 offen sc1
    s_add_u32 m0, s52, 0x22000
    s_add_u32 s50, s50, s51
    buffer_load_dwordx4 v248, s[20:23], s50 offen lds
    v_mfma_f32_16x16x32_bf16 v[152:155], v[212:215], v[48:51], v[152:155]
    v_subrev_u32 v240, 0x20000, v240
    ds_read_b64_tr_b16 v[208:209], v240 offset:0
    v_mul_f32 v184, v176, v184
    v_mfma_f32_16x16x32_bf16 v[156:159], v[212:215], v[52:55], v[156:159]
    ds_read_b64_tr_b16 v[210:211], v240 offset:512
    v_mul_f32 v176, v250, v176
    v_mul_f32 v185, v177, v185
    s_waitcnt lgkmcnt(6)
    v_mfma_f32_16x16x32_bf16 v[144:147], v[216:219], v[56:59], v[144:147]
    v_subrev_u32 v241, 0x20000, v241
    ds_read_b64_tr_b16 v[212:213], v241 offset:0
    v_exp_f32 v176, v176
    v_mfma_f32_16x16x32_bf16 v[148:151], v[216:219], v[60:63], v[148:151]
    ds_read_b64_tr_b16 v[214:215], v241 offset:512
    v_mul_f32 v177, v250, v177
    v_mfma_f32_16x16x32_bf16 v[152:155], v[220:223], v[56:59], v[152:155]
    ds_read_b64_tr_b16 v[216:217], v240 offset:8192
    v_mul_f32 v186, v178, v186
    v_mfma_f32_16x16x32_bf16 v[156:159], v[220:223], v[60:63], v[156:159]
    ds_read_b64_tr_b16 v[218:219], v240 offset:8704
    v_add_f32 v176, 1.0, v176
    v_exp_f32 v177, v177
    s_waitcnt lgkmcnt(6)
    v_mfma_f32_16x16x32_bf16 v[144:147], v[224:227], v[64:67], v[144:147]
    ds_read_b64_tr_b16 v[220:221], v241 offset:8192
    v_mul_f32 v178, v250, v178
    v_mfma_f32_16x16x32_bf16 v[148:151], v[224:227], v[68:71], v[148:151]
    ds_read_b64_tr_b16 v[222:223], v241 offset:8704
    v_mul_f32 v187, v179, v187
    s_add_u32 m0, s52, 0x24000
    s_add_u32 s50, s50, s51
    buffer_load_dwordx4 v248, s[20:23], s50 offen lds
    v_mfma_f32_16x16x32_bf16 v[152:155], v[228:231], v[64:67], v[152:155]
    ds_read_b64_tr_b16 v[224:225], v240 offset:16384
    v_rcp_f32 v176, v176
    v_mfma_f32_16x16x32_bf16 v[156:159], v[228:231], v[68:71], v[156:159]
    ds_read_b64_tr_b16 v[226:227], v240 offset:16896
    v_add_f32 v177, 1.0, v177
    v_exp_f32 v178, v178
    s_waitcnt lgkmcnt(6)
    v_mfma_f32_16x16x32_bf16 v[160:163], v[208:211], v[0:3], 0
    ds_read_b64_tr_b16 v[228:229], v241 offset:16384
    v_mul_f32 v179, v250, v179
    v_mfma_f32_16x16x32_bf16 v[164:167], v[208:211], v[4:7], 0
    ds_read_b64_tr_b16 v[230:231], v241 offset:16896
    v_mul_f32 v188, v180, v188
    v_mfma_f32_16x16x32_bf16 v[168:171], v[212:215], v[0:3], 0
    ds_read_b64_tr_b16 v[208:209], v240 offset:24576
    v_mul_f32 v184, v176, v184
    v_mfma_f32_16x16x32_bf16 v[172:175], v[212:215], v[4:7], 0
    ds_read_b64_tr_b16 v[210:211], v240 offset:25088
    v_rcp_f32 v177, v177
    s_waitcnt lgkmcnt(6)
    v_mfma_f32_16x16x32_bf16 v[160:163], v[216:219], v[8:11], v[160:163]
    ds_read_b64_tr_b16 v[212:213], v241 offset:24576
    v_add_f32 v178, 1.0, v178
    v_mfma_f32_16x16x32_bf16 v[164:167], v[216:219], v[12:15], v[164:167]
    ds_read_b64_tr_b16 v[214:215], v241 offset:25088
    v_exp_f32 v179, v179
    v_mul_f32 v180, v250, v180
    v_mfma_f32_16x16x32_bf16 v[168:171], v[220:223], v[8:11], v[168:171]
    ds_read_b64_tr_b16 v[216:217], v240 offset:32768
    v_mul_f32 v189, v181, v189
    v_mfma_f32_16x16x32_bf16 v[172:175], v[220:223], v[12:15], v[172:175]
    ds_read_b64_tr_b16 v[218:219], v240 offset:33280
    v_mul_f32 v185, v177, v185
    s_waitcnt lgkmcnt(6)
    v_mfma_f32_16x16x32_bf16 v[160:163], v[224:227], v[16:19], v[160:163]
    ds_read_b64_tr_b16 v[220:221], v241 offset:32768
    v_rcp_f32 v178, v178
    v_mfma_f32_16x16x32_bf16 v[164:167], v[224:227], v[20:23], v[164:167]
    ds_read_b64_tr_b16 v[222:223], v241 offset:33280
    v_add_f32 v179, 1.0, v179
    v_exp_f32 v180, v180
    s_mov_b32 exec_lo, 0x3ffff
    s_mov_b32 exec_hi, 0x0
    buffer_load_dword v255, v252, s[16:19], s53 offen
    s_mov_b64 exec, -1
    v_mfma_f32_16x16x32_bf16 v[168:171], v[228:231], v[16:19], v[168:171]
    ds_read_b64_tr_b16 v[224:225], v240 offset:40960
    v_mul_f32 v181, v250, v181
    v_mfma_f32_16x16x32_bf16 v[172:175], v[228:231], v[20:23], v[172:175]
    ds_read_b64_tr_b16 v[226:227], v240 offset:41472
    v_mul_f32 v190, v182, v190
    s_waitcnt lgkmcnt(6)
    s_setprio 1
    v_mfma_f32_16x16x32_bf16 v[160:163], v[208:211], v[24:27], v[160:163]
    ds_read_b64_tr_b16 v[228:229], v241 offset:40960
    v_mul_f32 v186, v178, v186
    v_mfma_f32_16x16x32_bf16 v[164:167], v[208:211], v[28:31], v[164:167]
    ds_read_b64_tr_b16 v[230:231], v241 offset:41472
    v_rcp_f32 v179, v179
    v_mfma_f32_16x16x32_bf16 v[168:171], v[212:215], v[24:27], v[168:171]
    ds_read_b64_tr_b16 v[208:209], v240 offset:49152
    v_add_f32 v180, 1.0, v180
    v_mfma_f32_16x16x32_bf16 v[172:175], v[212:215], v[28:31], v[172:175]
    ds_read_b64_tr_b16 v[210:211], v240 offset:49664
    v_exp_f32 v181, v181
    v_mul_f32 v182, v250, v182
    s_waitcnt lgkmcnt(6)
    v_mfma_f32_16x16x32_bf16 v[160:163], v[216:219], v[32:35], v[160:163]
    ds_read_b64_tr_b16 v[212:213], v241 offset:49152
    v_mul_f32 v191, v183, v191
    v_mfma_f32_16x16x32_bf16 v[164:167], v[216:219], v[36:39], v[164:167]
    ds_read_b64_tr_b16 v[214:215], v241 offset:49664
    v_mul_f32 v187, v179, v187
    v_mfma_f32_16x16x32_bf16 v[168:171], v[220:223], v[32:35], v[168:171]
    ds_read_b64_tr_b16 v[216:217], v240 offset:57344
    v_rcp_f32 v180, v180
    v_mfma_f32_16x16x32_bf16 v[172:175], v[220:223], v[36:39], v[172:175]
    ds_read_b64_tr_b16 v[218:219], v240 offset:57856
    v_add_f32 v181, 1.0, v181
    v_exp_f32 v182, v182
    s_waitcnt lgkmcnt(6)
    v_mfma_f32_16x16x32_bf16 v[160:163], v[224:227], v[40:43], v[160:163]
    ds_read_b64_tr_b16 v[220:221], v241 offset:57344
    v_mul_f32 v183, v250, v183
    v_mfma_f32_16x16x32_bf16 v[164:167], v[224:227], v[44:47], v[164:167]
    ds_read_b64_tr_b16 v[222:223], v241 offset:57856
    v_mul_f32 v188, v180, v188
    v_mfma_f32_16x16x32_bf16 v[168:171], v[228:231], v[40:43], v[168:171]
    v_add_u32 v240, 0x10000, v240
    ds_read_b64_tr_b16 v[224:225], v240 offset:0
    v_rcp_f32 v181, v181
    v_mfma_f32_16x16x32_bf16 v[172:175], v[228:231], v[44:47], v[172:175]
    ds_read_b64_tr_b16 v[226:227], v240 offset:512
    v_add_f32 v182, 1.0, v182
    s_waitcnt lgkmcnt(6)
    v_mfma_f32_16x16x32_bf16 v[160:163], v[208:211], v[48:51], v[160:163]
    v_add_u32 v241, 0x10000, v241
    ds_read_b64_tr_b16 v[228:229], v241 offset:0
    v_exp_f32 v183, v183
    v_mfma_f32_16x16x32_bf16 v[164:167], v[208:211], v[52:55], v[164:167]
    ds_read_b64_tr_b16 v[230:231], v241 offset:512
    v_mul_f32 v189, v181, v189
    v_rcp_f32 v182, v182
    v_mfma_f32_16x16x32_bf16 v[168:171], v[212:215], v[48:51], v[168:171]
    v_subrev_u32 v242, 0x20000, v242
    ds_read_b64_tr_b16 v[208:209], v242 offset:0
    v_add_f32 v183, 1.0, v183
    v_mfma_f32_16x16x32_bf16 v[172:175], v[212:215], v[52:55], v[172:175]
    ds_read_b64_tr_b16 v[210:211], v242 offset:512
    v_mul_f32 v190, v182, v190
    s_waitcnt lgkmcnt(6)
    v_mfma_f32_16x16x32_bf16 v[160:163], v[216:219], v[56:59], v[160:163]
    v_subrev_u32 v243, 0x20000, v243
    ds_read_b64_tr_b16 v[212:213], v243 offset:0
    v_rcp_f32 v183, v183
    v_mfma_f32_16x16x32_bf16 v[164:167], v[216:219], v[60:63], v[164:167]
    ds_read_b64_tr_b16 v[214:215], v243 offset:512
    s_nop 0
    v_mul_f32 v191, v183, v191
    v_mfma_f32_16x16x32_bf16 v[168:171], v[220:223], v[56:59], v[168:171]
    ds_read_b64_tr_b16 v[216:217], v242 offset:8192
    v_cvt_pk_bf16_f32 v232, v184, v185
    v_mfma_f32_16x16x32_bf16 v[172:175], v[220:223], v[60:63], v[172:175]
    ds_read_b64_tr_b16 v[218:219], v242 offset:8704
    v_cvt_pk_bf16_f32 v233, v186, v187
    s_waitcnt lgkmcnt(6)
    v_mfma_f32_16x16x32_bf16 v[160:163], v[224:227], v[64:67], v[160:163]
    ds_read_b64_tr_b16 v[220:221], v243 offset:8192
    v_cvt_pk_bf16_f32 v236, v188, v189
    v_mfma_f32_16x16x32_bf16 v[164:167], v[224:227], v[68:71], v[164:167]
    ds_read_b64_tr_b16 v[222:223], v243 offset:8704
    v_cvt_pk_bf16_f32 v237, v190, v191
    v_mfma_f32_16x16x32_bf16 v[168:171], v[228:231], v[64:67], v[168:171]
    ds_read_b64_tr_b16 v[224:225], v242 offset:16384
    v_mul_f32 v200, v192, v200
    v_mfma_f32_16x16x32_bf16 v[172:175], v[228:231], v[68:71], v[172:175]
    ds_read_b64_tr_b16 v[226:227], v242 offset:16896
    v_mul_f32 v192, v250, v192
    s_waitcnt lgkmcnt(6)
    v_mfma_f32_16x16x32_bf16 v[176:179], v[208:211], v[0:3], 0
    ds_read_b64_tr_b16 v[228:229], v243 offset:16384
    v_mul_f32 v201, v193, v201
    v_mfma_f32_16x16x32_bf16 v[180:183], v[208:211], v[4:7], 0
    ds_read_b64_tr_b16 v[230:231], v243 offset:16896
    v_exp_f32 v192, v192
    s_setprio 0
    v_mfma_f32_16x16x32_bf16 v[184:187], v[212:215], v[0:3], 0
    ds_read_b64_tr_b16 v[208:209], v242 offset:24576
    v_mul_f32 v193, v250, v193
    v_mfma_f32_16x16x32_bf16 v[188:191], v[212:215], v[4:7], 0
    ds_read_b64_tr_b16 v[210:211], v242 offset:25088
    v_mul_f32 v202, v194, v202
    s_waitcnt lgkmcnt(6)
    v_mfma_f32_16x16x32_bf16 v[176:179], v[216:219], v[8:11], v[176:179]
    ds_read_b64_tr_b16 v[212:213], v243 offset:24576
    v_mfma_f32_16x16x32_bf16 v[180:183], v[216:219], v[12:15], v[180:183]
    ds_read_b64_tr_b16 v[214:215], v243 offset:25088
    v_add_f32 v192, 1.0, v192
    v_mfma_f32_16x16x32_bf16 v[184:187], v[220:223], v[8:11], v[184:187]
    ds_read_b64_tr_b16 v[216:217], v242 offset:32768
    v_exp_f32 v193, v193
    v_mfma_f32_16x16x32_bf16 v[188:191], v[220:223], v[12:15], v[188:191]
    ds_read_b64_tr_b16 v[218:219], v242 offset:33280
    v_mul_f32 v194, v250, v194
    s_waitcnt lgkmcnt(6)
    v_mfma_f32_16x16x32_bf16 v[176:179], v[224:227], v[16:19], v[176:179]
    ds_read_b64_tr_b16 v[220:221], v243 offset:32768
    v_mul_f32 v203, v195, v203
    v_mfma_f32_16x16x32_bf16 v[180:183], v[224:227], v[20:23], v[180:183]
    ds_read_b64_tr_b16 v[222:223], v243 offset:33280
    v_rcp_f32 v192, v192
    v_mfma_f32_16x16x32_bf16 v[184:187], v[228:231], v[16:19], v[184:187]
    ds_read_b64_tr_b16 v[224:225], v242 offset:40960
    v_mfma_f32_16x16x32_bf16 v[188:191], v[228:231], v[20:23], v[188:191]
    ds_read_b64_tr_b16 v[226:227], v242 offset:41472
    v_add_f32 v193, 1.0, v193
    s_waitcnt lgkmcnt(6)
    v_mfma_f32_16x16x32_bf16 v[176:179], v[208:211], v[24:27], v[176:179]
    ds_read_b64_tr_b16 v[228:229], v243 offset:40960
    v_exp_f32 v194, v194
    v_mfma_f32_16x16x32_bf16 v[180:183], v[208:211], v[28:31], v[180:183]
    ds_read_b64_tr_b16 v[230:231], v243 offset:41472
    v_mul_f32 v195, v250, v195
    v_mfma_f32_16x16x32_bf16 v[184:187], v[212:215], v[24:27], v[184:187]
    ds_read_b64_tr_b16 v[208:209], v242 offset:49152
    v_mul_f32 v204, v196, v204
    v_mfma_f32_16x16x32_bf16 v[188:191], v[212:215], v[28:31], v[188:191]
    ds_read_b64_tr_b16 v[210:211], v242 offset:49664
    v_mul_f32 v200, v192, v200
    s_waitcnt lgkmcnt(6)
    v_mfma_f32_16x16x32_bf16 v[176:179], v[216:219], v[32:35], v[176:179]
    ds_read_b64_tr_b16 v[212:213], v243 offset:49152
    v_mfma_f32_16x16x32_bf16 v[180:183], v[216:219], v[36:39], v[180:183]
    ds_read_b64_tr_b16 v[214:215], v243 offset:49664
    v_rcp_f32 v193, v193
    v_mfma_f32_16x16x32_bf16 v[184:187], v[220:223], v[32:35], v[184:187]
    ds_read_b64_tr_b16 v[216:217], v242 offset:57344
    v_add_f32 v194, 1.0, v194
    v_mfma_f32_16x16x32_bf16 v[188:191], v[220:223], v[36:39], v[188:191]
    ds_read_b64_tr_b16 v[218:219], v242 offset:57856
    v_exp_f32 v195, v195
    s_waitcnt lgkmcnt(6)
    v_mfma_f32_16x16x32_bf16 v[176:179], v[224:227], v[40:43], v[176:179]
    ds_read_b64_tr_b16 v[220:221], v243 offset:57344
    v_mul_f32 v196, v250, v196
    v_mfma_f32_16x16x32_bf16 v[180:183], v[224:227], v[44:47], v[180:183]
    ds_read_b64_tr_b16 v[222:223], v243 offset:57856
    v_mul_f32 v205, v197, v205
    v_mfma_f32_16x16x32_bf16 v[184:187], v[228:231], v[40:43], v[184:187]
    v_add_u32 v242, 0x10000, v242
    ds_read_b64_tr_b16 v[224:225], v242 offset:0
    v_mul_f32 v201, v193, v201
    v_mfma_f32_16x16x32_bf16 v[188:191], v[228:231], v[44:47], v[188:191]
    ds_read_b64_tr_b16 v[226:227], v242 offset:512
    v_rcp_f32 v194, v194
    s_waitcnt lgkmcnt(6)
    v_mfma_f32_16x16x32_bf16 v[176:179], v[208:211], v[48:51], v[176:179]
    v_add_u32 v243, 0x10000, v243
    ds_read_b64_tr_b16 v[228:229], v243 offset:0
    v_mfma_f32_16x16x32_bf16 v[180:183], v[208:211], v[52:55], v[180:183]
    ds_read_b64_tr_b16 v[230:231], v243 offset:512
    v_add_f32 v195, 1.0, v195
    v_mfma_f32_16x16x32_bf16 v[184:187], v[212:215], v[48:51], v[184:187]
    v_exp_f32 v196, v196
    v_mfma_f32_16x16x32_bf16 v[188:191], v[212:215], v[52:55], v[188:191]
    v_mul_f32 v197, v250, v197
    s_waitcnt lgkmcnt(4)
    v_mfma_f32_16x16x32_bf16 v[176:179], v[216:219], v[56:59], v[176:179]
    v_mul_f32 v206, v198, v206
    v_mul_f32 v202, v194, v202
    v_mfma_f32_16x16x32_bf16 v[180:183], v[216:219], v[60:63], v[180:183]
    s_waitcnt vmcnt(1) lgkmcnt(0)
    s_barrier
    ds_read_b64_tr_b16 v[208:209], v240 offset:16384
    ds_read_b64_tr_b16 v[210:211], v240 offset:16896
    ds_read_b64_tr_b16 v[212:213], v241 offset:16384
    ds_read_b64_tr_b16 v[214:215], v241 offset:16896
    s_setprio 3
    v_mfma_f32_16x16x32_bf16 v[184:187], v[220:223], v[56:59], v[184:187]
    ds_read_b64_tr_b16 v[216:217], v240 offset:24576
    v_mfma_f32_16x16x32_bf16 v[188:191], v[220:223], v[60:63], v[188:191]
    ds_read_b64_tr_b16 v[218:219], v240 offset:25088
    v_rcp_f32 v195, v195
    v_mfma_f32_16x16x32_bf16 v[176:179], v[224:227], v[64:67], v[176:179]
    ds_read_b64_tr_b16 v[220:221], v241 offset:24576
    v_add_f32 v196, 1.0, v196
    v_mfma_f32_16x16x32_bf16 v[180:183], v[224:227], v[68:71], v[180:183]
    ds_read_b64_tr_b16 v[222:223], v241 offset:25088
    v_exp_f32 v197, v197
    s_add_u32 m0, s52, 0x0
    s_mov_b32 s50, 0
    buffer_load_dwordx4 v247, s[16:19], s50 offen lds
    v_mfma_f32_16x16x32_bf16 v[184:187], v[228:231], v[64:67], v[184:187]
    ds_read_b64_tr_b16 v[224:225], v240 offset:32768
    v_mul_f32 v198, v250, v198
    v_mfma_f32_16x16x32_bf16 v[188:191], v[228:231], v[68:71], v[188:191]
    ds_read_b64_tr_b16 v[226:227], v240 offset:33280
    v_mul_f32 v207, v199, v207
    s_waitcnt lgkmcnt(6)
    v_mfma_f32_16x16x32_bf16 v[160:163], v[208:211], v[72:75], v[160:163]
    ds_read_b64_tr_b16 v[228:229], v241 offset:32768
    v_mfma_f32_16x16x32_bf16 v[164:167], v[208:211], v[76:79], v[164:167]
    ds_read_b64_tr_b16 v[230:231], v241 offset:33280
    v_mul_f32 v203, v195, v203
    v_mfma_f32_16x16x32_bf16 v[168:171], v[212:215], v[72:75], v[168:171]
    ds_read_b64_tr_b16 v[208:209], v240 offset:40960
    v_rcp_f32 v196, v196
    v_mfma_f32_16x16x32_bf16 v[172:175], v[212:215], v[76:79], v[172:175]
    ds_read_b64_tr_b16 v[210:211], v240 offset:41472
    v_add_f32 v197, 1.0, v197
    s_waitcnt lgkmcnt(6)
    v_mfma_f32_16x16x32_bf16 v[160:163], v[216:219], v[80:83], v[160:163]
    ds_read_b64_tr_b16 v[212:213], v241 offset:40960
    v_exp_f32 v198, v198
    v_mfma_f32_16x16x32_bf16 v[164:167], v[216:219], v[84:87], v[164:167]
    ds_read_b64_tr_b16 v[214:215], v241 offset:41472
    v_mul_f32 v199, v250, v199
    s_add_u32 m0, s52, 0x2000
    s_add_u32 s50, s50, 294912
    buffer_load_dwordx4 v247, s[16:19], s50 offen lds
    v_mfma_f32_16x16x32_bf16 v[168:171], v[220:223], v[80:83], v[168:171]
    ds_read_b64_tr_b16 v[216:217], v240 offset:49152
    v_mul_f32 v204, v196, v204
    v_mfma_f32_16x16x32_bf16 v[172:175], v[220:223], v[84:87], v[172:175]
    ds_read_b64_tr_b16 v[218:219], v240 offset:49664
    v_rcp_f32 v197, v197
    s_waitcnt lgkmcnt(6)
    v_mfma_f32_16x16x32_bf16 v[160:163], v[224:227], v[88:91], v[160:163]
    ds_read_b64_tr_b16 v[220:221], v241 offset:49152
    v_mfma_f32_16x16x32_bf16 v[164:167], v[224:227], v[92:95], v[164:167]
    ds_read_b64_tr_b16 v[222:223], v241 offset:49664
    v_add_f32 v198, 1.0, v198
    v_mfma_f32_16x16x32_bf16 v[168:171], v[228:231], v[88:91], v[168:171]
    ds_read_b64_tr_b16 v[224:225], v240 offset:57344
    v_exp_f32 v199, v199
    v_mfma_f32_16x16x32_bf16 v[172:175], v[228:231], v[92:95], v[172:175]
    ds_read_b64_tr_b16 v[226:227], v240 offset:57856
    v_mul_f32 v205, v197, v205
    s_waitcnt lgkmcnt(6)
    v_mfma_f32_16x16x32_bf16 v[160:163], v[208:211], v[96:99], v[160:163]
    ds_read_b64_tr_b16 v[228:229], v241 offset:57344
    v_rcp_f32 v198, v198
    v_mfma_f32_16x16x32_bf16 v[164:167], v[208:211], v[100:103], v[164:167]
    ds_read_b64_tr_b16 v[230:231], v241 offset:57856
    v_add_f32 v199, 1.0, v199
    s_add_u32 m0, s52, 0x4000
    s_add_u32 s50, s50, 294912
    buffer_load_dwordx4 v247, s[16:19], s50 offen lds
    v_mfma_f32_16x16x32_bf16 v[168:171], v[212:215], v[96:99], v[168:171]
    v_add_u32 v240, 0x10000, v240
    ds_read_b64_tr_b16 v[208:209], v240 offset:0
    v_mfma_f32_16x16x32_bf16 v[172:175], v[212:215], v[100:103], v[172:175]
    ds_read_b64_tr_b16 v[210:211], v240 offset:512
    v_mul_f32 v206, v198, v206
    s_waitcnt lgkmcnt(6)
    v_mfma_f32_16x16x32_bf16 v[160:163], v[216:219], v[104:107], v[160:163]
    v_add_u32 v241, 0x10000, v241
    ds_read_b64_tr_b16 v[212:213], v241 offset:0
    v_rcp_f32 v199, v199
    v_mfma_f32_16x16x32_bf16 v[164:167], v[216:219], v[108:111], v[164:167]
    ds_read_b64_tr_b16 v[214:215], v241 offset:512
    s_nop 0
    v_mfma_f32_16x16x32_bf16 v[168:171], v[220:223], v[104:107], v[168:171]
    ds_read_b64_tr_b16 v[216:217], v240 offset:8192
    v_mul_f32 v207, v199, v207
    v_mfma_f32_16x16x32_bf16 v[172:175], v[220:223], v[108:111], v[172:175]
    ds_read_b64_tr_b16 v[218:219], v240 offset:8704
    v_cvt_pk_bf16_f32 v234, v200, v201
    s_waitcnt lgkmcnt(6)
    s_setprio 2
    v_mfma_f32_16x16x32_bf16 v[160:163], v[224:227], v[112:115], v[160:163]
    ds_read_b64_tr_b16 v[220:221], v241 offset:8192
    v_mfma_f32_16x16x32_bf16 v[164:167], v[224:227], v[116:119], v[164:167]
    ds_read_b64_tr_b16 v[222:223], v241 offset:8704
    v_cvt_pk_bf16_f32 v235, v202, v203
    s_add_u32 m0, s52, 0x6000
    s_add_u32 s50, s50, 294912
    buffer_load_dwordx4 v247, s[16:19], s50 offen lds
    v_mfma_f32_16x16x32_bf16 v[168:171], v[228:231], v[112:115], v[168:171]
    ds_read_b64_tr_b16 v[224:225], v240 offset:16384
    v_cvt_pk_bf16_f32 v238, v204, v205
    v_mfma_f32_16x16x32_bf16 v[172:175], v[228:231], v[116:119], v[172:175]
    ds_read_b64_tr_b16 v[226:227], v240 offset:16896
    v_cvt_pk_bf16_f32 v239, v206, v207
    s_waitcnt lgkmcnt(6)
    v_mfma_f32_16x16x32_bf16 v[160:163], v[208:211], v[120:123], v[160:163]
    ds_read_b64_tr_b16 v[228:229], v241 offset:16384
    buffer_store_dwordx4 v[232:235], v245, s[24:27], s41 offen sc1
    v_mfma_f32_16x16x32_bf16 v[164:167], v[208:211], v[124:127], v[164:167]
    ds_read_b64_tr_b16 v[230:231], v241 offset:16896
    s_add_u32 s48, s41, 148480
    v_mfma_f32_16x16x32_bf16 v[168:171], v[212:215], v[120:123], v[168:171]
    ds_read_b64_tr_b16 v[208:209], v242 offset:16384
    v_mfma_f32_16x16x32_bf16 v[172:175], v[212:215], v[124:127], v[172:175]
    ds_read_b64_tr_b16 v[210:211], v242 offset:16896
    buffer_store_dwordx4 v[236:239], v245, s[24:27], s48 offen sc1
    s_waitcnt lgkmcnt(6)
    v_mfma_f32_16x16x32_bf16 v[160:163], v[216:219], v[128:131], v[160:163]
    ds_read_b64_tr_b16 v[212:213], v243 offset:16384
    v_mfma_f32_16x16x32_bf16 v[164:167], v[216:219], v[132:135], v[164:167]
    ds_read_b64_tr_b16 v[214:215], v243 offset:16896
    s_add_u32 m0, s52, 0x8000
    s_add_u32 s50, s50, 294912
    buffer_load_dwordx4 v247, s[16:19], s50 offen lds
    v_mfma_f32_16x16x32_bf16 v[168:171], v[220:223], v[128:131], v[168:171]
    ds_read_b64_tr_b16 v[216:217], v242 offset:24576
    v_mfma_f32_16x16x32_bf16 v[172:175], v[220:223], v[132:135], v[172:175]
    ds_read_b64_tr_b16 v[218:219], v242 offset:25088
    s_waitcnt lgkmcnt(6)
    v_mfma_f32_16x16x32_bf16 v[160:163], v[224:227], v[136:139], v[160:163]
    ds_read_b64_tr_b16 v[220:221], v243 offset:24576
    v_mfma_f32_16x16x32_bf16 v[164:167], v[224:227], v[140:143], v[164:167]
    ds_read_b64_tr_b16 v[222:223], v243 offset:25088
    v_mfma_f32_16x16x32_bf16 v[168:171], v[228:231], v[136:139], v[168:171]
    ds_read_b64_tr_b16 v[224:225], v242 offset:32768
    v_mfma_f32_16x16x32_bf16 v[172:175], v[228:231], v[140:143], v[172:175]
    ds_read_b64_tr_b16 v[226:227], v242 offset:33280
    s_waitcnt lgkmcnt(6)
    v_mfma_f32_16x16x32_bf16 v[176:179], v[208:211], v[72:75], v[176:179]
    ds_read_b64_tr_b16 v[228:229], v243 offset:32768
    v_mfma_f32_16x16x32_bf16 v[180:183], v[208:211], v[76:79], v[180:183]
    ds_read_b64_tr_b16 v[230:231], v243 offset:33280
    s_add_u32 m0, s52, 0xa000
    s_add_u32 s50, s50, 294912
    buffer_load_dwordx4 v247, s[16:19], s50 offen lds
    v_mfma_f32_16x16x32_bf16 v[184:187], v[212:215], v[72:75], v[184:187]
    ds_read_b64_tr_b16 v[208:209], v242 offset:40960
    v_mfma_f32_16x16x32_bf16 v[188:191], v[212:215], v[76:79], v[188:191]
    ds_read_b64_tr_b16 v[210:211], v242 offset:41472
    s_waitcnt lgkmcnt(6)
    v_mfma_f32_16x16x32_bf16 v[176:179], v[216:219], v[80:83], v[176:179]
    ds_read_b64_tr_b16 v[212:213], v243 offset:40960
    v_cvt_pk_bf16_f32 v160, v160, v161
    v_mfma_f32_16x16x32_bf16 v[180:183], v[216:219], v[84:87], v[180:183]
    ds_read_b64_tr_b16 v[214:215], v243 offset:41472
    v_cvt_pk_bf16_f32 v161, v162, v163
    v_mfma_f32_16x16x32_bf16 v[184:187], v[220:223], v[80:83], v[184:187]
    ds_read_b64_tr_b16 v[216:217], v242 offset:49152
    v_mfma_f32_16x16x32_bf16 v[188:191], v[220:223], v[84:87], v[188:191]
    ds_read_b64_tr_b16 v[218:219], v242 offset:49664
    v_cvt_pk_bf16_f32 v164, v164, v165
    s_waitcnt lgkmcnt(6)
    v_mfma_f32_16x16x32_bf16 v[176:179], v[224:227], v[88:91], v[176:179]
    ds_read_b64_tr_b16 v[220:221], v243 offset:49152
    v_mfma_f32_16x16x32_bf16 v[180:183], v[224:227], v[92:95], v[180:183]
    ds_read_b64_tr_b16 v[222:223], v243 offset:49664
    v_cvt_pk_bf16_f32 v165, v166, v167
    s_add_u32 m0, s52, 0xc000
    s_add_u32 s50, s50, 294912
    buffer_load_dwordx4 v247, s[16:19], s50 offen lds
    v_mfma_f32_16x16x32_bf16 v[184:187], v[228:231], v[88:91], v[184:187]
    ds_read_b64_tr_b16 v[224:225], v242 offset:57344
    v_mfma_f32_16x16x32_bf16 v[188:191], v[228:231], v[92:95], v[188:191]
    ds_read_b64_tr_b16 v[226:227], v242 offset:57856
    s_add_u32 s47, s46, 0x0
    s_waitcnt lgkmcnt(6)
    s_setprio 1
    v_mfma_f32_16x16x32_bf16 v[176:179], v[208:211], v[96:99], v[176:179]
    ds_read_b64_tr_b16 v[228:229], v243 offset:57344
    v_mfma_f32_16x16x32_bf16 v[180:183], v[208:211], v[100:103], v[180:183]
    ds_read_b64_tr_b16 v[230:231], v243 offset:57856
    buffer_store_dwordx2 v[160:161], v249, s[28:31], s47 offen offset:0 sc1
    v_mfma_f32_16x16x32_bf16 v[184:187], v[212:215], v[96:99], v[184:187]
    v_add_u32 v242, 0x10000, v242
    ds_read_b64_tr_b16 v[208:209], v242 offset:0
    v_mfma_f32_16x16x32_bf16 v[188:191], v[212:215], v[100:103], v[188:191]
    ds_read_b64_tr_b16 v[210:211], v242 offset:512
    buffer_store_dwordx2 v[164:165], v249, s[28:31], s47 offen offset:128 sc1
    s_waitcnt lgkmcnt(6)
    v_mfma_f32_16x16x32_bf16 v[176:179], v[216:219], v[104:107], v[176:179]
    v_add_u32 v243, 0x10000, v243
    ds_read_b64_tr_b16 v[212:213], v243 offset:0
    v_cvt_pk_bf16_f32 v168, v168, v169
    v_mfma_f32_16x16x32_bf16 v[180:183], v[216:219], v[108:111], v[180:183]
    ds_read_b64_tr_b16 v[214:215], v243 offset:512
    v_cvt_pk_bf16_f32 v169, v170, v171
    s_add_u32 m0, s52, 0xe000
    s_add_u32 s50, s50, 294912
    buffer_load_dwordx4 v247, s[16:19], s50 offen lds
    v_mfma_f32_16x16x32_bf16 v[184:187], v[220:223], v[104:107], v[184:187]
    ds_read_b64_tr_b16 v[216:217], v242 offset:8192
    v_mfma_f32_16x16x32_bf16 v[188:191], v[220:223], v[108:111], v[188:191]
    ds_read_b64_tr_b16 v[218:219], v242 offset:8704
    v_cvt_pk_bf16_f32 v172, v172, v173
    s_waitcnt lgkmcnt(6)
    v_mfma_f32_16x16x32_bf16 v[176:179], v[224:227], v[112:115], v[176:179]
    ds_read_b64_tr_b16 v[220:221], v243 offset:8192
    v_mfma_f32_16x16x32_bf16 v[180:183], v[224:227], v[116:119], v[180:183]
    ds_read_b64_tr_b16 v[222:223], v243 offset:8704
    v_cvt_pk_bf16_f32 v173, v174, v175
    v_mfma_f32_16x16x32_bf16 v[184:187], v[228:231], v[112:115], v[184:187]
    ds_read_b64_tr_b16 v[224:225], v242 offset:16384
    v_mfma_f32_16x16x32_bf16 v[188:191], v[228:231], v[116:119], v[188:191]
    ds_read_b64_tr_b16 v[226:227], v242 offset:16896
    s_add_u32 s47, s46, 0x10000
    s_waitcnt lgkmcnt(6)
    v_mfma_f32_16x16x32_bf16 v[176:179], v[208:211], v[120:123], v[176:179]
    ds_read_b64_tr_b16 v[228:229], v243 offset:16384
    v_mfma_f32_16x16x32_bf16 v[180:183], v[208:211], v[124:127], v[180:183]
    ds_read_b64_tr_b16 v[230:231], v243 offset:16896
    buffer_store_dwordx2 v[168:169], v249, s[28:31], s47 offen offset:0 sc1
    s_add_u32 m0, s52, 0x10000
    s_add_u32 s50, s50, 294912
    buffer_load_dwordx4 v247, s[16:19], s50 offen lds
    v_mfma_f32_16x16x32_bf16 v[184:187], v[212:215], v[120:123], v[184:187]
    ds_read_b64_tr_b16 v[208:209], v244 offset:17408
    v_mfma_f32_16x16x32_bf16 v[188:191], v[212:215], v[124:127], v[188:191]
    ds_read_b64_tr_b16 v[210:211], v244 offset:17536
    buffer_store_dwordx2 v[172:173], v249, s[28:31], s47 offen offset:128 sc1
    s_waitcnt lgkmcnt(6)
    v_mfma_f32_16x16x32_bf16 v[176:179], v[216:219], v[128:131], v[176:179]
    ds_read_b64_tr_b16 v[212:213], v244 offset:19456
    v_mfma_f32_16x16x32_bf16 v[180:183], v[216:219], v[132:135], v[180:183]
    ds_read_b64_tr_b16 v[214:215], v244 offset:19584
    v_mfma_f32_16x16x32_bf16 v[184:187], v[220:223], v[128:131], v[184:187]
    ds_read_b64_tr_b16 v[216:217], v244 offset:25600
    v_mfma_f32_16x16x32_bf16 v[188:191], v[220:223], v[132:135], v[188:191]
    ds_read_b64_tr_b16 v[218:219], v244 offset:25728
    s_waitcnt lgkmcnt(6)
    v_mfma_f32_16x16x32_bf16 v[176:179], v[224:227], v[136:139], v[176:179]
    ds_read_b64_tr_b16 v[220:221], v244 offset:27648
    v_mfma_f32_16x16x32_bf16 v[180:183], v[224:227], v[140:143], v[180:183]
    ds_read_b64_tr_b16 v[222:223], v244 offset:27776
    v_mfma_f32_16x16x32_bf16 v[184:187], v[228:231], v[136:139], v[184:187]
    ds_read_b64_tr_b16 v[224:225], v244 offset:33792
    v_mfma_f32_16x16x32_bf16 v[188:191], v[228:231], v[140:143], v[188:191]
    ds_read_b64_tr_b16 v[226:227], v244 offset:33920
    s_waitcnt lgkmcnt(6)
    v_mfma_f32_16x16x32_bf16 v[144:147], v[208:211], v[72:75], v[144:147]
    ds_read_b64_tr_b16 v[228:229], v244 offset:35840
    v_mfma_f32_16x16x32_bf16 v[148:151], v[208:211], v[76:79], v[148:151]
    ds_read_b64_tr_b16 v[230:231], v244 offset:35968
    s_setprio 0
    v_mfma_f32_16x16x32_bf16 v[152:155], v[212:215], v[72:75], v[152:155]
    ds_read_b64_tr_b16 v[208:209], v244 offset:41984
    v_cvt_pk_bf16_f32 v176, v176, v177
    v_mfma_f32_16x16x32_bf16 v[156:159], v[212:215], v[76:79], v[156:159]
    ds_read_b64_tr_b16 v[210:211], v244 offset:42112
    v_cvt_pk_bf16_f32 v177, v178, v179
    s_waitcnt lgkmcnt(6)
    v_mfma_f32_16x16x32_bf16 v[144:147], v[216:219], v[80:83], v[144:147]
    ds_read_b64_tr_b16 v[212:213], v244 offset:44032
    v_mfma_f32_16x16x32_bf16 v[148:151], v[216:219], v[84:87], v[148:151]
    ds_read_b64_tr_b16 v[214:215], v244 offset:44160
    v_cvt_pk_bf16_f32 v180, v180, v181
    v_mfma_f32_16x16x32_bf16 v[152:155], v[220:223], v[80:83], v[152:155]
    ds_read_b64_tr_b16 v[216:217], v244 offset:50176
    v_mfma_f32_16x16x32_bf16 v[156:159], v[220:223], v[84:87], v[156:159]
    ds_read_b64_tr_b16 v[218:219], v244 offset:50304
    v_cvt_pk_bf16_f32 v181, v182, v183
    s_waitcnt lgkmcnt(6)
    v_mfma_f32_16x16x32_bf16 v[144:147], v[224:227], v[88:91], v[144:147]
    ds_read_b64_tr_b16 v[220:221], v244 offset:52224
    s_add_u32 s47, s46, 0x20000
    v_mfma_f32_16x16x32_bf16 v[148:151], v[224:227], v[92:95], v[148:151]
    ds_read_b64_tr_b16 v[222:223], v244 offset:52352
    buffer_store_dwordx2 v[176:177], v249, s[28:31], s47 offen offset:0 sc1
    v_mfma_f32_16x16x32_bf16 v[152:155], v[228:231], v[88:91], v[152:155]
    ds_read_b64_tr_b16 v[224:225], v244 offset:58368
    v_mfma_f32_16x16x32_bf16 v[156:159], v[228:231], v[92:95], v[156:159]
    ds_read_b64_tr_b16 v[226:227], v244 offset:58496
    buffer_store_dwordx2 v[180:181], v249, s[28:31], s47 offen offset:128 sc1
    s_waitcnt lgkmcnt(6)
    v_mfma_f32_16x16x32_bf16 v[144:147], v[208:211], v[96:99], v[144:147]
    ds_read_b64_tr_b16 v[228:229], v244 offset:60416
    v_mfma_f32_16x16x32_bf16 v[148:151], v[208:211], v[100:103], v[148:151]
    ds_read_b64_tr_b16 v[230:231], v244 offset:60544
    v_cvt_pk_bf16_f32 v184, v184, v185
    v_mfma_f32_16x16x32_bf16 v[152:155], v[212:215], v[96:99], v[152:155]
    v_add_u32 v244, 0x10000, v244
    ds_read_b64_tr_b16 v[208:209], v244 offset:1024
    v_mfma_f32_16x16x32_bf16 v[156:159], v[212:215], v[100:103], v[156:159]
    ds_read_b64_tr_b16 v[210:211], v244 offset:1152
    v_cvt_pk_bf16_f32 v185, v186, v187
    s_waitcnt lgkmcnt(6)
    v_mfma_f32_16x16x32_bf16 v[144:147], v[216:219], v[104:107], v[144:147]
    ds_read_b64_tr_b16 v[212:213], v244 offset:3072
    v_cvt_pk_bf16_f32 v188, v188, v189
    v_mfma_f32_16x16x32_bf16 v[148:151], v[216:219], v[108:111], v[148:151]
    ds_read_b64_tr_b16 v[214:215], v244 offset:3200
    v_cvt_pk_bf16_f32 v189, v190, v191
    v_mfma_f32_16x16x32_bf16 v[152:155], v[220:223], v[104:107], v[152:155]
    ds_read_b64_tr_b16 v[216:217], v244 offset:9216
    v_mfma_f32_16x16x32_bf16 v[156:159], v[220:223], v[108:111], v[156:159]
    ds_read_b64_tr_b16 v[218:219], v244 offset:9344
    s_add_u32 s47, s46, 0x30000
    s_waitcnt lgkmcnt(6)
    v_mfma_f32_16x16x32_bf16 v[144:147], v[224:227], v[112:115], v[144:147]
    ds_read_b64_tr_b16 v[220:221], v244 offset:11264
    v_mfma_f32_16x16x32_bf16 v[148:151], v[224:227], v[116:119], v[148:151]
    ds_read_b64_tr_b16 v[222:223], v244 offset:11392
    buffer_store_dwordx2 v[184:185], v249, s[28:31], s47 offen offset:0 sc1
    v_mfma_f32_16x16x32_bf16 v[152:155], v[228:231], v[112:115], v[152:155]
    ds_read_b64_tr_b16 v[224:225], v244 offset:17408
    v_mfma_f32_16x16x32_bf16 v[156:159], v[228:231], v[116:119], v[156:159]
    ds_read_b64_tr_b16 v[226:227], v244 offset:17536
    buffer_store_dwordx2 v[188:189], v249, s[28:31], s47 offen offset:128 sc1
    s_waitcnt lgkmcnt(6)
    v_mfma_f32_16x16x32_bf16 v[144:147], v[208:211], v[120:123], v[144:147]
    ds_read_b64_tr_b16 v[228:229], v244 offset:19456
    v_mfma_f32_16x16x32_bf16 v[148:151], v[208:211], v[124:127], v[148:151]
    ds_read_b64_tr_b16 v[230:231], v244 offset:19584
    v_mfma_f32_16x16x32_bf16 v[152:155], v[212:215], v[120:123], v[152:155]
    v_mfma_f32_16x16x32_bf16 v[156:159], v[212:215], v[124:127], v[156:159]
    s_waitcnt lgkmcnt(4)
    v_mfma_f32_16x16x32_bf16 v[144:147], v[216:219], v[128:131], v[144:147]
    v_mfma_f32_16x16x32_bf16 v[148:151], v[216:219], v[132:135], v[148:151]
    s_waitcnt vmcnt(5) lgkmcnt(0)
    s_barrier
    v_subrev_u32 v243, 0x20000, v243
    ds_read_b64_tr_b16 v[208:209], v243 offset:0
    ds_read_b64_tr_b16 v[210:211], v243 offset:512
    ds_read_b64_tr_b16 v[212:213], v243 offset:1024
    ds_read_b64_tr_b16 v[214:215], v243 offset:1536
    s_add_u32 m0, s52, 0x14000
    s_add_u32 s50, s50, 294912
    buffer_load_dwordx4 v247, s[16:19], s50 offen lds
    s_setprio 3
    v_mfma_f32_16x16x32_bf16 v[152:155], v[220:223], v[128:131], v[152:155]
    ds_read_b64_tr_b16 v[216:217], v243 offset:8192
    v_mfma_f32_16x16x32_bf16 v[156:159], v[220:223], v[132:135], v[156:159]
    ds_read_b64_tr_b16 v[218:219], v243 offset:8704
    v_mfma_f32_16x16x32_bf16 v[144:147], v[224:227], v[136:139], v[144:147]
    ds_read_b64_tr_b16 v[220:221], v243 offset:9216
    v_mfma_f32_16x16x32_bf16 v[148:151], v[224:227], v[140:143], v[148:151]
    ds_read_b64_tr_b16 v[222:223], v243 offset:9728
    v_mfma_f32_16x16x32_bf16 v[152:155], v[228:231], v[136:139], v[152:155]
    ds_read_b64_tr_b16 v[224:225], v243 offset:16384
    v_mfma_f32_16x16x32_bf16 v[156:159], v[228:231], v[140:143], v[156:159]
    ds_read_b64_tr_b16 v[226:227], v243 offset:16896
    s_waitcnt lgkmcnt(6)
    v_mfma_f32_16x16x32_bf16 v[192:195], v[208:211], v[0:3], 0
    ds_read_b64_tr_b16 v[228:229], v243 offset:17408
    v_mfma_f32_16x16x32_bf16 v[196:199], v[208:211], v[4:7], 0
    ds_read_b64_tr_b16 v[230:231], v243 offset:17920
    v_lshlrev_b32 v252, 5, v245
    v_mov_b32 v253, 1
    s_mov_b64 exec, 7
    buffer_atomic_add v253, v252, s[24:27], s39 offen offset:0
    s_mov_b64 exec, -1
    s_add_u32 m0, s52, 0x16000
    s_add_u32 s50, s50, 294912
    buffer_load_dwordx4 v247, s[16:19], s50 offen lds
    v_mfma_f32_16x16x32_bf16 v[200:203], v[212:215], v[0:3], 0
    ds_read_b64_tr_b16 v[208:209], v243 offset:24576
    v_mfma_f32_16x16x32_bf16 v[204:207], v[212:215], v[4:7], 0
    ds_read_b64_tr_b16 v[210:211], v243 offset:25088
    s_waitcnt lgkmcnt(6)
    v_mfma_f32_16x16x32_bf16 v[192:195], v[216:219], v[8:11], v[192:195]
    ds_read_b64_tr_b16 v[212:213], v243 offset:25600
    v_mul_f32 v152, v144, v152
    v_mfma_f32_16x16x32_bf16 v[196:199], v[216:219], v[12:15], v[196:199]
    ds_read_b64_tr_b16 v[214:215], v243 offset:26112
    v_mul_f32 v144, v250, v144
    v_mfma_f32_16x16x32_bf16 v[200:203], v[220:223], v[8:11], v[200:203]
    ds_read_b64_tr_b16 v[216:217], v243 offset:32768
    v_mfma_f32_16x16x32_bf16 v[204:207], v[220:223], v[12:15], v[204:207]
    ds_read_b64_tr_b16 v[218:219], v243 offset:33280
    v_mul_f32 v153, v145, v153
    s_waitcnt lgkmcnt(6)
    v_mfma_f32_16x16x32_bf16 v[192:195], v[224:227], v[16:19], v[192:195]
    ds_read_b64_tr_b16 v[220:221], v243 offset:33792
    v_mfma_f32_16x16x32_bf16 v[196:199], v[224:227], v[20:23], v[196:199]
    ds_read_b64_tr_b16 v[222:223], v243 offset:34304
    v_exp_f32 v144, v144
    s_add_u32 m0, s52, 0x18000
    s_add_u32 s50, s50, 294912
    buffer_load_dwordx4 v247, s[16:19], s50 offen lds
    v_mfma_f32_16x16x32_bf16 v[200:203], v[228:231], v[16:19], v[200:203]
    ds_read_b64_tr_b16 v[224:225], v243 offset:40960
    v_mul_f32 v145, v250, v145
    v_mfma_f32_16x16x32_bf16 v[204:207], v[228:231], v[20:23], v[204:207]
    ds_read_b64_tr_b16 v[226:227], v243 offset:41472
    v_mul_f32 v154, v146, v154
    s_waitcnt lgkmcnt(6)
    v_mfma_f32_16x16x32_bf16 v[192:195], v[208:211], v[24:27], v[192:195]
    ds_read_b64_tr_b16 v[228:229], v243 offset:41984
    v_mfma_f32_16x16x32_bf16 v[196:199], v[208:211], v[28:31], v[196:199]
    ds_read_b64_tr_b16 v[230:231], v243 offset:42496
    v_add_f32 v144, 1.0, v144
    v_mfma_f32_16x16x32_bf16 v[200:203], v[212:215], v[24:27], v[200:203]
    ds_read_b64_tr_b16 v[208:209], v243 offset:49152
    v_mfma_f32_16x16x32_bf16 v[204:207], v[212:215], v[28:31], v[204:207]
    ds_read_b64_tr_b16 v[210:211], v243 offset:49664
    v_exp_f32 v145, v145
    s_waitcnt lgkmcnt(6)
    v_mfma_f32_16x16x32_bf16 v[192:195], v[216:219], v[32:35], v[192:195]
    ds_read_b64_tr_b16 v[212:213], v243 offset:50176
    v_mul_f32 v146, v250, v146
    v_mfma_f32_16x16x32_bf16 v[196:199], v[216:219], v[36:39], v[196:199]
    ds_read_b64_tr_b16 v[214:215], v243 offset:50688
    v_mul_f32 v155, v147, v155
    s_add_u32 m0, s52, 0x1a000
    s_add_u32 s50, s50, 294912
    buffer_load_dwordx4 v247, s[16:19], s50 offen lds
    v_mfma_f32_16x16x32_bf16 v[200:203], v[220:223], v[32:35], v[200:203]
    ds_read_b64_tr_b16 v[216:217], v243 offset:57344
    v_mfma_f32_16x16x32_bf16 v[204:207], v[220:223], v[36:39], v[204:207]
    ds_read_b64_tr_b16 v[218:219], v243 offset:57856
    v_rcp_f32 v144, v144
    s_waitcnt lgkmcnt(6)
    v_mfma_f32_16x16x32_bf16 v[192:195], v[224:227], v[40:43], v[192:195]
    ds_read_b64_tr_b16 v[220:221], v243 offset:58368
    v_mfma_f32_16x16x32_bf16 v[196:199], v[224:227], v[44:47], v[196:199]
    ds_read_b64_tr_b16 v[222:223], v243 offset:58880
    v_add_f32 v145, 1.0, v145
    v_mfma_f32_16x16x32_bf16 v[200:203], v[228:231], v[40:43], v[200:203]
    v_add_u32 v243, 0x10000, v243
    ds_read_b64_tr_b16 v[224:225], v243 offset:0
    v_exp_f32 v146, v146
    v_mfma_f32_16x16x32_bf16 v[204:207], v[228:231], v[44:47], v[204:207]
    ds_read_b64_tr_b16 v[226:227], v243 offset:512
    v_mul_f32 v147, v250, v147
    s_waitcnt lgkmcnt(6)
    v_mfma_f32_16x16x32_bf16 v[192:195], v[208:211], v[48:51], v[192:195]
    ds_read_b64_tr_b16 v[228:229], v243 offset:1024
    v_mfma_f32_16x16x32_bf16 v[196:199], v[208:211], v[52:55], v[196:199]
    ds_read_b64_tr_b16 v[230:231], v243 offset:1536
    v_mul_f32 v156, v148, v156
    s_add_u32 m0, s52, 0x1c000
    s_add_u32 s50, s50, 294912
    buffer_load_dwordx4 v247, s[16:19], s50 offen lds
    v_mfma_f32_16x16x32_bf16 v[200:203], v[212:215], v[48:51], v[200:203]
    v_subrev_u32 v241, 0x20000, v241
    ds_read_b64_tr_b16 v[208:209], v241 offset:0
    v_mfma_f32_16x16x32_bf16 v[204:207], v[212:215], v[52:55], v[204:207]
    ds_read_b64_tr_b16 v[210:211], v241 offset:512
    v_mul_f32 v152, v144, v152
    s_waitcnt lgkmcnt(6)
    v_mfma_f32_16x16x32_bf16 v[192:195], v[216:219], v[56:59], v[192:195]
    ds_read_b64_tr_b16 v[212:213], v241 offset:1024
    v_rcp_f32 v145, v145
    v_mfma_f32_16x16x32_bf16 v[196:199], v[216:219], v[60:63], v[196:199]
    ds_read_b64_tr_b16 v[214:215], v241 offset:1536
    v_add_f32 v146, 1.0, v146
    s_setprio 2
    v_mfma_f32_16x16x32_bf16 v[200:203], v[220:223], v[56:59], v[200:203]
    ds_read_b64_tr_b16 v[216:217], v241 offset:8192
    v_mfma_f32_16x16x32_bf16 v[204:207], v[220:223], v[60:63], v[204:207]
    ds_read_b64_tr_b16 v[218:219], v241 offset:8704
    v_exp_f32 v147, v147
    s_waitcnt lgkmcnt(6)
    v_mfma_f32_16x16x32_bf16 v[192:195], v[224:227], v[64:67], v[192:195]
    ds_read_b64_tr_b16 v[220:221], v241 offset:9216
    v_mfma_f32_16x16x32_bf16 v[196:199], v[224:227], v[68:71], v[196:199]
    ds_read_b64_tr_b16 v[222:223], v241 offset:9728
    v_mul_f32 v148, v250, v148
    s_add_u32 m0, s52, 0x1e000
    s_add_u32 s50, s50, 294912
    buffer_load_dwordx4 v247, s[16:19], s50 offen lds
    v_mfma_f32_16x16x32_bf16 v[200:203], v[228:231], v[64:67], v[200:203]
    ds_read_b64_tr_b16 v[224:225], v241 offset:16384
    v_mul_f32 v157, v149, v157
    v_mfma_f32_16x16x32_bf16 v[204:207], v[228:231], v[68:71], v[204:207]
    ds_read_b64_tr_b16 v[226:227], v241 offset:16896
    v_mul_f32 v153, v145, v153
    s_waitcnt lgkmcnt(6)
    v_mfma_f32_16x16x32_bf16 v[160:163], v[208:211], v[0:3], 0
    ds_read_b64_tr_b16 v[228:229], v241 offset:17408
    v_mfma_f32_16x16x32_bf16 v[164:167], v[208:211], v[4:7], 0
    ds_read_b64_tr_b16 v[230:231], v241 offset:17920
    v_rcp_f32 v146, v146
    v_mfma_f32_16x16x32_bf16 v[168:171], v[212:215], v[0:3], 0
    ds_read_b64_tr_b16 v[208:209], v241 offset:24576
    v_mfma_f32_16x16x32_bf16 v[172:175], v[212:215], v[4:7], 0
    ds_read_b64_tr_b16 v[210:211], v241 offset:25088
    v_add_f32 v147, 1.0, v147
    s_waitcnt lgkmcnt(6)
    v_mfma_f32_16x16x32_bf16 v[160:163], v[216:219], v[8:11], v[160:163]
    ds_read_b64_tr_b16 v[212:213], v241 offset:25600
    v_exp_f32 v148, v148
    v_mfma_f32_16x16x32_bf16 v[164:167], v[216:219], v[12:15], v[164:167]
    ds_read_b64_tr_b16 v[214:215], v241 offset:26112
    v_mul_f32 v149, v250, v149
    v_lshlrev_b32 v252, 3, v245
    v_mov_b32 v253, 1
    s_waitcnt vmcnt(7)
    s_mov_b32 exec_lo, s100
    s_mov_b32 exec_hi, 0
    buffer_atomic_add v253, v252, s[28:31], s3 offen
    s_mov_b64 exec, -1
    s_add_u32 m0, s52, 0x20000
    s_add_u32 s50, s50, 294912
    buffer_load_dwordx4 v247, s[16:19], s50 offen lds
    v_mfma_f32_16x16x32_bf16 v[168:171], v[220:223], v[8:11], v[168:171]
    ds_read_b64_tr_b16 v[216:217], v241 offset:32768
    v_mfma_f32_16x16x32_bf16 v[172:175], v[220:223], v[12:15], v[172:175]
    ds_read_b64_tr_b16 v[218:219], v241 offset:33280
    v_mul_f32 v158, v150, v158
    s_waitcnt lgkmcnt(6)
    v_mfma_f32_16x16x32_bf16 v[160:163], v[224:227], v[16:19], v[160:163]
    ds_read_b64_tr_b16 v[220:221], v241 offset:33792
    v_mfma_f32_16x16x32_bf16 v[164:167], v[224:227], v[20:23], v[164:167]
    ds_read_b64_tr_b16 v[222:223], v241 offset:34304
    v_mul_f32 v154, v146, v154
    v_mfma_f32_16x16x32_bf16 v[168:171], v[228:231], v[16:19], v[168:171]
    ds_read_b64_tr_b16 v[224:225], v241 offset:40960
    v_rcp_f32 v147, v147
    v_mfma_f32_16x16x32_bf16 v[172:175], v[228:231], v[20:23], v[172:175]
    ds_read_b64_tr_b16 v[226:227], v241 offset:41472
    v_add_f32 v148, 1.0, v148
    s_waitcnt lgkmcnt(6)
    v_mfma_f32_16x16x32_bf16 v[160:163], v[208:211], v[24:27], v[160:163]
    ds_read_b64_tr_b16 v[228:229], v241 offset:41984
    v_mfma_f32_16x16x32_bf16 v[164:167], v[208:211], v[28:31], v[164:167]
    ds_read_b64_tr_b16 v[230:231], v241 offset:42496
    v_exp_f32 v149, v149
    s_add_u32 m0, s52, 0x22000
    s_add_u32 s50, s50, 294912
    buffer_load_dwordx4 v247, s[16:19], s50 offen lds
    v_mfma_f32_16x16x32_bf16 v[168:171], v[212:215], v[24:27], v[168:171]
    ds_read_b64_tr_b16 v[208:209], v241 offset:49152
    v_mfma_f32_16x16x32_bf16 v[172:175], v[212:215], v[28:31], v[172:175]
    ds_read_b64_tr_b16 v[210:211], v241 offset:49664
    v_mul_f32 v150, v250, v150
    s_waitcnt lgkmcnt(6)
    v_mfma_f32_16x16x32_bf16 v[160:163], v[216:219], v[32:35], v[160:163]
    ds_read_b64_tr_b16 v[212:213], v241 offset:50176
    v_mul_f32 v159, v151, v159
    v_mfma_f32_16x16x32_bf16 v[164:167], v[216:219], v[36:39], v[164:167]
    ds_read_b64_tr_b16 v[214:215], v241 offset:50688
    v_mul_f32 v155, v147, v155
    v_mfma_f32_16x16x32_bf16 v[168:171], v[220:223], v[32:35], v[168:171]
    ds_read_b64_tr_b16 v[216:217], v241 offset:57344
    v_mfma_f32_16x16x32_bf16 v[172:175], v[220:223], v[36:39], v[172:175]
    ds_read_b64_tr_b16 v[218:219], v241 offset:57856
    v_rcp_f32 v148, v148
    s_waitcnt lgkmcnt(6)
    v_mfma_f32_16x16x32_bf16 v[160:163], v[224:227], v[40:43], v[160:163]
    ds_read_b64_tr_b16 v[220:221], v241 offset:58368
    v_mfma_f32_16x16x32_bf16 v[164:167], v[224:227], v[44:47], v[164:167]
    ds_read_b64_tr_b16 v[222:223], v241 offset:58880
    v_add_f32 v149, 1.0, v149
    s_add_u32 m0, s52, 0x24000
    s_add_u32 s50, s50, 294912
    buffer_load_dwordx4 v247, s[16:19], s50 offen lds
    v_mfma_f32_16x16x32_bf16 v[168:171], v[228:231], v[40:43], v[168:171]
    v_add_u32 v241, 0x10000, v241
    ds_read_b64_tr_b16 v[224:225], v241 offset:0
    v_exp_f32 v150, v150
    v_mfma_f32_16x16x32_bf16 v[172:175], v[228:231], v[44:47], v[172:175]
    ds_read_b64_tr_b16 v[226:227], v241 offset:512
    v_mul_f32 v151, v250, v151
    s_waitcnt lgkmcnt(6)
    v_mfma_f32_16x16x32_bf16 v[160:163], v[208:211], v[48:51], v[160:163]
    ds_read_b64_tr_b16 v[228:229], v241 offset:1024
    v_mfma_f32_16x16x32_bf16 v[164:167], v[208:211], v[52:55], v[164:167]
    ds_read_b64_tr_b16 v[230:231], v241 offset:1536
    v_mul_f32 v156, v148, v156
    v_mfma_f32_16x16x32_bf16 v[168:171], v[212:215], v[48:51], v[168:171]
    v_subrev_u32 v242, 0x20000, v242
    ds_read_b64_tr_b16 v[208:209], v242 offset:0
    v_mfma_f32_16x16x32_bf16 v[172:175], v[212:215], v[52:55], v[172:175]
    ds_read_b64_tr_b16 v[210:211], v242 offset:512
    v_rcp_f32 v149, v149
    s_waitcnt lgkmcnt(6)
    v_mfma_f32_16x16x32_bf16 v[160:163], v[216:219], v[56:59], v[160:163]
    ds_read_b64_tr_b16 v[212:213], v242 offset:1024
    v_add_f32 v150, 1.0, v150
    v_mfma_f32_16x16x32_bf16 v[164:167], v[216:219], v[60:63], v[164:167]
    ds_read_b64_tr_b16 v[214:215], v242 offset:1536
    v_exp_f32 v151, v151
    s_setprio 1
    v_mfma_f32_16x16x32_bf16 v[168:171], v[220:223], v[56:59], v[168:171]
    ds_read_b64_tr_b16 v[216:217], v242 offset:8192
    v_mfma_f32_16x16x32_bf16 v[172:175], v[220:223], v[60:63], v[172:175]
    ds_read_b64_tr_b16 v[218:219], v242 offset:8704
    v_mul_f32 v157, v149, v157
    s_waitcnt lgkmcnt(6)
    v_mfma_f32_16x16x32_bf16 v[160:163], v[224:227], v[64:67], v[160:163]
    ds_read_b64_tr_b16 v[220:221], v242 offset:9216
    v_mfma_f32_16x16x32_bf16 v[164:167], v[224:227], v[68:71], v[164:167]
    ds_read_b64_tr_b16 v[222:223], v242 offset:9728
    v_rcp_f32 v150, v150
    v_mfma_f32_16x16x32_bf16 v[168:171], v[228:231], v[64:67], v[168:171]
    ds_read_b64_tr_b16 v[224:225], v242 offset:16384
    v_add_f32 v151, 1.0, v151
    v_mfma_f32_16x16x32_bf16 v[172:175], v[228:231], v[68:71], v[172:175]
    ds_read_b64_tr_b16 v[226:227], v242 offset:16896
    v_mul_f32 v158, v150, v158
    s_mov_b32 exec_lo, 0x7ff
    s_mov_b32 exec_hi, 0x0
    buffer_load_dword v255, v254, s[4:7], s36 offen
    s_mov_b64 exec, -1
    s_waitcnt lgkmcnt(6)
    v_mfma_f32_16x16x32_bf16 v[176:179], v[208:211], v[0:3], 0
    ds_read_b64_tr_b16 v[228:229], v242 offset:17408
    v_mfma_f32_16x16x32_bf16 v[180:183], v[208:211], v[4:7], 0
    ds_read_b64_tr_b16 v[230:231], v242 offset:17920
    v_rcp_f32 v151, v151
    v_mfma_f32_16x16x32_bf16 v[184:187], v[212:215], v[0:3], 0
    ds_read_b64_tr_b16 v[208:209], v242 offset:24576
    v_mfma_f32_16x16x32_bf16 v[188:191], v[212:215], v[4:7], 0
    ds_read_b64_tr_b16 v[210:211], v242 offset:25088
    s_nop 0
    s_waitcnt lgkmcnt(6)
    v_mfma_f32_16x16x32_bf16 v[176:179], v[216:219], v[8:11], v[176:179]
    ds_read_b64_tr_b16 v[212:213], v242 offset:25600
    v_mul_f32 v159, v151, v159
    v_mfma_f32_16x16x32_bf16 v[180:183], v[216:219], v[12:15], v[180:183]
    ds_read_b64_tr_b16 v[214:215], v242 offset:26112
    v_cvt_pk_bf16_f32 v232, v152, v153
    v_mfma_f32_16x16x32_bf16 v[184:187], v[220:223], v[8:11], v[184:187]
    ds_read_b64_tr_b16 v[216:217], v242 offset:32768
    v_mfma_f32_16x16x32_bf16 v[188:191], v[220:223], v[12:15], v[188:191]
    ds_read_b64_tr_b16 v[218:219], v242 offset:33280
    v_cvt_pk_bf16_f32 v233, v154, v155
    s_mov_b32 exec_lo, 0x1ff800
    s_mov_b32 exec_hi, 0x0
    buffer_load_dword v255, v254, s[4:7], s36 offen
    s_mov_b64 exec, -1
    s_waitcnt lgkmcnt(6)
    v_mfma_f32_16x16x32_bf16 v[176:179], v[224:227], v[16:19], v[176:179]
    ds_read_b64_tr_b16 v[220:221], v242 offset:33792
    v_mfma_f32_16x16x32_bf16 v[180:183], v[224:227], v[20:23], v[180:183]
    ds_read_b64_tr_b16 v[222:223], v242 offset:34304
    v_cvt_pk_bf16_f32 v236, v156, v157
    v_mfma_f32_16x16x32_bf16 v[184:187], v[228:231], v[16:19], v[184:187]
    ds_read_b64_tr_b16 v[224:225], v242 offset:40960
    v_cvt_pk_bf16_f32 v237, v158, v159
    v_mfma_f32_16x16x32_bf16 v[188:191], v[228:231], v[20:23], v[188:191]
    ds_read_b64_tr_b16 v[226:227], v242 offset:41472
    buffer_store_dwordx2 v[232:233], v251, s[24:27], s44 offen sc1
    s_waitcnt lgkmcnt(6)
    v_mfma_f32_16x16x32_bf16 v[176:179], v[208:211], v[24:27], v[176:179]
    ds_read_b64_tr_b16 v[228:229], v242 offset:41984
    v_mfma_f32_16x16x32_bf16 v[180:183], v[208:211], v[28:31], v[180:183]
    ds_read_b64_tr_b16 v[230:231], v242 offset:42496
    s_add_u32 s48, s44, 148480
    v_mfma_f32_16x16x32_bf16 v[184:187], v[212:215], v[24:27], v[184:187]
    ds_read_b64_tr_b16 v[208:209], v242 offset:49152
    v_mfma_f32_16x16x32_bf16 v[188:191], v[212:215], v[28:31], v[188:191]
    ds_read_b64_tr_b16 v[210:211], v242 offset:49664
    buffer_store_dwordx2 v[236:237], v251, s[24:27], s48 offen sc1
    s_mov_b32 exec_lo, 0x7ff
    s_mov_b32 exec_hi, 0x0
    buffer_load_dword v255, v254, s[8:11], s37 offen
    s_mov_b64 exec, -1
    s_waitcnt lgkmcnt(6)
    v_mfma_f32_16x16x32_bf16 v[176:179], v[216:219], v[32:35], v[176:179]
    ds_read_b64_tr_b16 v[212:213], v242 offset:50176
    v_mfma_f32_16x16x32_bf16 v[180:183], v[216:219], v[36:39], v[180:183]
    ds_read_b64_tr_b16 v[214:215], v242 offset:50688
    v_mfma_f32_16x16x32_bf16 v[184:187], v[220:223], v[32:35], v[184:187]
    ds_read_b64_tr_b16 v[216:217], v242 offset:57344
    v_mfma_f32_16x16x32_bf16 v[188:191], v[220:223], v[36:39], v[188:191]
    ds_read_b64_tr_b16 v[218:219], v242 offset:57856
    s_waitcnt lgkmcnt(6)
    v_mfma_f32_16x16x32_bf16 v[176:179], v[224:227], v[40:43], v[176:179]
    ds_read_b64_tr_b16 v[220:221], v242 offset:58368
    v_mfma_f32_16x16x32_bf16 v[180:183], v[224:227], v[44:47], v[180:183]
    ds_read_b64_tr_b16 v[222:223], v242 offset:58880
    v_mfma_f32_16x16x32_bf16 v[184:187], v[228:231], v[40:43], v[184:187]
    v_add_u32 v242, 0x10000, v242
    ds_read_b64_tr_b16 v[224:225], v242 offset:0
    v_mfma_f32_16x16x32_bf16 v[188:191], v[228:231], v[44:47], v[188:191]
    ds_read_b64_tr_b16 v[226:227], v242 offset:512
    s_waitcnt lgkmcnt(6)
    v_mfma_f32_16x16x32_bf16 v[176:179], v[208:211], v[48:51], v[176:179]
    ds_read_b64_tr_b16 v[228:229], v242 offset:1024
    v_mfma_f32_16x16x32_bf16 v[180:183], v[208:211], v[52:55], v[180:183]
    ds_read_b64_tr_b16 v[230:231], v242 offset:1536
    s_and_b32 s15, s13, 3
    s_lshr_b32 s32, s13, 2
    s_lshl_b32 s32, s32, 3
    s_and_b32 s33, s14, 7
    s_add_u32 s32, s32, s33
    s_lshr_b32 s33, s14, 3
    s_add_u32 s45, s12, s15
    s_add_u32 s45, s45, 1
    s_and_b32 s45, s45, 3
    s_and_b32 s47, s12, 4
    s_add_u32 s45, s45, s47
    s_lshl_b32 s47, s32, 3
    s_add_u32 s45, s45, s47
    s_mul_i32 s45, s45, 145
    s_mul_i32 s47, s15, 36
    s_add_u32 s45, s45, s47
    s_lshl_b32 s54, s45, 10
    s_mul_i32 s55, s15, 1152
    s_lshl_b32 s45, s12, 3
    s_add_u32 s55, s55, s45
    s_mul_i32 s55, s55, 1152
    s_mul_i32 s45, s33, 384
    s_add_u32 s55, s55, s45
    s_mul_i32 s101, s32, 3
    s_add_u32 s101, s101, s33
    s_lshl_b32 s101, s101, 2
    s_add_u32 s101, s101, s15
    s_lshl_b32 s101, s101, 7
    s_add_u32 s101, s101, 0x2798000
    s_mov_b32 s49, 32
    s_lshl_b32 s53, s12, 11
    v_mfma_f32_16x16x32_bf16 v[184:187], v[212:215], v[48:51], v[184:187]
    v_subrev_u32 v240, 0x20000, v240
    ds_read_b64_tr_b16 v[208:209], v240 offset:0
    v_mfma_f32_16x16x32_bf16 v[188:191], v[212:215], v[52:55], v[188:191]
    ds_read_b64_tr_b16 v[210:211], v240 offset:512
    s_waitcnt lgkmcnt(6)
    v_mfma_f32_16x16x32_bf16 v[176:179], v[216:219], v[56:59], v[176:179]
    ds_read_b64_tr_b16 v[212:213], v240 offset:1024
    v_lshrrev_b32 v249, 4, v245
    v_mfma_f32_16x16x32_bf16 v[180:183], v[216:219], v[60:63], v[180:183]
    ds_read_b64_tr_b16 v[214:215], v240 offset:1536
    v_lshrrev_b32 v252, 3, v249
    s_setprio 0
    v_mfma_f32_16x16x32_bf16 v[184:187], v[220:223], v[56:59], v[184:187]
    ds_read_b64_tr_b16 v[216:217], v240 offset:8192
    v_mfma_f32_16x16x32_bf16 v[188:191], v[220:223], v[60:63], v[188:191]
    ds_read_b64_tr_b16 v[218:219], v240 offset:8704
    v_bfe_u32 v253, v249, 1, 2
    s_waitcnt lgkmcnt(6)
    v_mfma_f32_16x16x32_bf16 v[176:179], v[224:227], v[64:67], v[176:179]
    ds_read_b64_tr_b16 v[220:221], v240 offset:9216
    v_mfma_f32_16x16x32_bf16 v[180:183], v[224:227], v[68:71], v[180:183]
    ds_read_b64_tr_b16 v[222:223], v240 offset:9728
    v_mul_u32_u24 v246, 1152, v252
    v_mfma_f32_16x16x32_bf16 v[184:187], v[228:231], v[64:67], v[184:187]
    ds_read_b64_tr_b16 v[224:225], v240 offset:16384
    v_mfma_f32_16x16x32_bf16 v[188:191], v[228:231], v[68:71], v[188:191]
    ds_read_b64_tr_b16 v[226:227], v240 offset:16896
    v_lshrrev_b32 v252, 4, v249
    s_waitcnt lgkmcnt(6)
    v_mfma_f32_16x16x32_bf16 v[144:147], v[208:211], v[0:3], 0
    ds_read_b64_tr_b16 v[228:229], v240 offset:17408
    v_mfma_f32_16x16x32_bf16 v[148:151], v[208:211], v[4:7], 0
    ds_read_b64_tr_b16 v[230:231], v240 offset:17920
    v_xor_b32 v253, v253, v252
    v_mfma_f32_16x16x32_bf16 v[152:155], v[212:215], v[0:3], 0
    ds_read_b64_tr_b16 v[208:209], v240 offset:24576
    v_mfma_f32_16x16x32_bf16 v[156:159], v[212:215], v[4:7], 0
    ds_read_b64_tr_b16 v[210:211], v240 offset:25088
    v_lshl_add_u32 v246, v253, 5, v246
    s_waitcnt lgkmcnt(6)
    v_mfma_f32_16x16x32_bf16 v[144:147], v[216:219], v[8:11], v[144:147]
    ds_read_b64_tr_b16 v[212:213], v240 offset:25600
    v_mfma_f32_16x16x32_bf16 v[148:151], v[216:219], v[12:15], v[148:151]
    ds_read_b64_tr_b16 v[214:215], v240 offset:26112
    v_and_b32 v252, 16, v245
    v_mfma_f32_16x16x32_bf16 v[152:155], v[220:223], v[8:11], v[152:155]
    ds_read_b64_tr_b16 v[216:217], v240 offset:32768
    v_mfma_f32_16x16x32_bf16 v[156:159], v[220:223], v[12:15], v[156:159]
    ds_read_b64_tr_b16 v[218:219], v240 offset:33280
    v_add_u32 v246, v252, v246
    s_waitcnt lgkmcnt(6)
    v_mfma_f32_16x16x32_bf16 v[144:147], v[224:227], v[16:19], v[144:147]
    ds_read_b64_tr_b16 v[220:221], v240 offset:33792
    v_lshrrev_b32 v252, 2, v249
    v_mfma_f32_16x16x32_bf16 v[148:151], v[224:227], v[20:23], v[148:151]
    ds_read_b64_tr_b16 v[222:223], v240 offset:34304
    v_and_b32 v253, 3, v249
    v_mfma_f32_16x16x32_bf16 v[152:155], v[228:231], v[16:19], v[152:155]
    ds_read_b64_tr_b16 v[224:225], v240 offset:40960
    v_mfma_f32_16x16x32_bf16 v[156:159], v[228:231], v[20:23], v[156:159]
    ds_read_b64_tr_b16 v[226:227], v240 offset:41472
    v_lshlrev_b32 v253, 3, v253
    s_waitcnt lgkmcnt(6)
    v_mfma_f32_16x16x32_bf16 v[144:147], v[208:211], v[24:27], v[144:147]
    ds_read_b64_tr_b16 v[228:229], v240 offset:41984
    v_mfma_f32_16x16x32_bf16 v[148:151], v[208:211], v[28:31], v[148:151]
    ds_read_b64_tr_b16 v[230:231], v240 offset:42496
    v_lshl_add_u32 v248, v252, 7, v253
    v_mfma_f32_16x16x32_bf16 v[152:155], v[212:215], v[24:27], v[152:155]
    ds_read_b64_tr_b16 v[208:209], v240 offset:49152
    v_mfma_f32_16x16x32_bf16 v[156:159], v[212:215], v[28:31], v[156:159]
    ds_read_b64_tr_b16 v[210:211], v240 offset:49664
    v_bfe_u32 v253, v249, 3, 2
    s_waitcnt lgkmcnt(6)
    v_mfma_f32_16x16x32_bf16 v[144:147], v[216:219], v[32:35], v[144:147]
    ds_read_b64_tr_b16 v[212:213], v240 offset:50176
    v_mfma_f32_16x16x32_bf16 v[148:151], v[216:219], v[36:39], v[148:151]
    ds_read_b64_tr_b16 v[214:215], v240 offset:50688
    v_lshl_add_u32 v248, v253, 5, v248
    v_mfma_f32_16x16x32_bf16 v[152:155], v[220:223], v[32:35], v[152:155]
    ds_read_b64_tr_b16 v[216:217], v240 offset:57344
    v_mfma_f32_16x16x32_bf16 v[156:159], v[220:223], v[36:39], v[156:159]
    ds_read_b64_tr_b16 v[218:219], v240 offset:57856
    v_lshrrev_b32 v252, 5, v249
    s_waitcnt lgkmcnt(6)
    v_mfma_f32_16x16x32_bf16 v[144:147], v[224:227], v[40:43], v[144:147]
    ds_read_b64_tr_b16 v[220:221], v240 offset:58368
    v_mfma_f32_16x16x32_bf16 v[148:151], v[224:227], v[44:47], v[148:151]
    ds_read_b64_tr_b16 v[222:223], v240 offset:58880
    v_and_b32 v244, 0x1ff, v245
    v_mfma_f32_16x16x32_bf16 v[152:155], v[228:231], v[40:43], v[152:155]
    v_add_u32 v240, 0x10000, v240
    ds_read_b64_tr_b16 v[224:225], v240 offset:0
    v_mfma_f32_16x16x32_bf16 v[156:159], v[228:231], v[44:47], v[156:159]
    ds_read_b64_tr_b16 v[226:227], v240 offset:512
    v_lshl_add_u32 v244, v252, 14, v244
    s_waitcnt lgkmcnt(6)
    v_mfma_f32_16x16x32_bf16 v[144:147], v[208:211], v[48:51], v[144:147]
    ds_read_b64_tr_b16 v[228:229], v240 offset:1024
    v_mfma_f32_16x16x32_bf16 v[148:151], v[208:211], v[52:55], v[148:151]
    ds_read_b64_tr_b16 v[230:231], v240 offset:1536
    v_mfma_f32_16x16x32_bf16 v[152:155], v[212:215], v[48:51], v[152:155]
    v_mfma_f32_16x16x32_bf16 v[156:159], v[212:215], v[52:55], v[156:159]
    s_waitcnt lgkmcnt(4)
    v_mfma_f32_16x16x32_bf16 v[144:147], v[216:219], v[56:59], v[144:147]
    v_mfma_f32_16x16x32_bf16 v[148:151], v[216:219], v[60:63], v[148:151]
    s_waitcnt vmcnt(5) lgkmcnt(0)
    s_barrier
    ds_read_b64_tr_b16 v[208:209], v240 offset:16384
    ds_read_b64_tr_b16 v[210:211], v240 offset:16896
    ds_read_b64_tr_b16 v[212:213], v240 offset:17408
    ds_read_b64_tr_b16 v[214:215], v240 offset:17920
    s_setprio 3
    v_mfma_f32_16x16x32_bf16 v[152:155], v[220:223], v[56:59], v[152:155]
    ds_read_b64_tr_b16 v[216:217], v240 offset:24576
    v_mfma_f32_16x16x32_bf16 v[156:159], v[220:223], v[60:63], v[156:159]
    ds_read_b64_tr_b16 v[218:219], v240 offset:25088
    v_mfma_f32_16x16x32_bf16 v[144:147], v[224:227], v[64:67], v[144:147]
    ds_read_b64_tr_b16 v[220:221], v240 offset:25600
    v_mfma_f32_16x16x32_bf16 v[148:151], v[224:227], v[68:71], v[148:151]
    ds_read_b64_tr_b16 v[222:223], v240 offset:26112
    v_mov_b32 v252, 0
    v_mov_b32 v253, 0
    s_mov_b64 exec, 1
    buffer_atomic_add v252, v253, s[24:27], s101 offen offset:0 sc0
    s_mov_b64 exec, -1
    v_mfma_f32_16x16x32_bf16 v[152:155], v[228:231], v[64:67], v[152:155]
    ds_read_b64_tr_b16 v[224:225], v240 offset:32768
    v_mfma_f32_16x16x32_bf16 v[156:159], v[228:231], v[68:71], v[156:159]
    ds_read_b64_tr_b16 v[226:227], v240 offset:33280
    s_waitcnt lgkmcnt(6)
    v_mfma_f32_16x16x32_bf16 v[144:147], v[208:211], v[72:75], v[144:147]
    ds_read_b64_tr_b16 v[228:229], v240 offset:33792
    v_mfma_f32_16x16x32_bf16 v[148:151], v[208:211], v[76:79], v[148:151]
    ds_read_b64_tr_b16 v[230:231], v240 offset:34304
    v_mfma_f32_16x16x32_bf16 v[152:155], v[212:215], v[72:75], v[152:155]
    ds_read_b64_tr_b16 v[208:209], v240 offset:40960
    v_mfma_f32_16x16x32_bf16 v[156:159], v[212:215], v[76:79], v[156:159]
    ds_read_b64_tr_b16 v[210:211], v240 offset:41472
    s_waitcnt lgkmcnt(6)
    v_mfma_f32_16x16x32_bf16 v[144:147], v[216:219], v[80:83], v[144:147]
    ds_read_b64_tr_b16 v[212:213], v240 offset:41984
    v_mfma_f32_16x16x32_bf16 v[148:151], v[216:219], v[84:87], v[148:151]
    ds_read_b64_tr_b16 v[214:215], v240 offset:42496
    v_mfma_f32_16x16x32_bf16 v[152:155], v[220:223], v[80:83], v[152:155]
    ds_read_b64_tr_b16 v[216:217], v240 offset:49152
    v_mfma_f32_16x16x32_bf16 v[156:159], v[220:223], v[84:87], v[156:159]
    ds_read_b64_tr_b16 v[218:219], v240 offset:49664
    s_waitcnt lgkmcnt(6)
    v_mfma_f32_16x16x32_bf16 v[144:147], v[224:227], v[88:91], v[144:147]
    ds_read_b64_tr_b16 v[220:221], v240 offset:50176
    v_mfma_f32_16x16x32_bf16 v[148:151], v[224:227], v[92:95], v[148:151]
    ds_read_b64_tr_b16 v[222:223], v240 offset:50688
    v_mfma_f32_16x16x32_bf16 v[152:155], v[228:231], v[88:91], v[152:155]
    ds_read_b64_tr_b16 v[224:225], v240 offset:57344
    v_mfma_f32_16x16x32_bf16 v[156:159], v[228:231], v[92:95], v[156:159]
    ds_read_b64_tr_b16 v[226:227], v240 offset:57856
    s_waitcnt lgkmcnt(6)
    v_mfma_f32_16x16x32_bf16 v[144:147], v[208:211], v[96:99], v[144:147]
    ds_read_b64_tr_b16 v[228:229], v240 offset:58368
    v_mfma_f32_16x16x32_bf16 v[148:151], v[208:211], v[100:103], v[148:151]
    ds_read_b64_tr_b16 v[230:231], v240 offset:58880
    v_mfma_f32_16x16x32_bf16 v[152:155], v[212:215], v[96:99], v[152:155]
    v_add_u32 v240, 0x10000, v240
    ds_read_b64_tr_b16 v[208:209], v240 offset:0
    v_mfma_f32_16x16x32_bf16 v[156:159], v[212:215], v[100:103], v[156:159]
    ds_read_b64_tr_b16 v[210:211], v240 offset:512
    s_waitcnt lgkmcnt(6)
    v_mfma_f32_16x16x32_bf16 v[144:147], v[216:219], v[104:107], v[144:147]
    ds_read_b64_tr_b16 v[212:213], v240 offset:1024
    v_mfma_f32_16x16x32_bf16 v[148:151], v[216:219], v[108:111], v[148:151]
    ds_read_b64_tr_b16 v[214:215], v240 offset:1536
    v_mfma_f32_16x16x32_bf16 v[152:155], v[220:223], v[104:107], v[152:155]
    ds_read_b64_tr_b16 v[216:217], v240 offset:8192
    v_mfma_f32_16x16x32_bf16 v[156:159], v[220:223], v[108:111], v[156:159]
    ds_read_b64_tr_b16 v[218:219], v240 offset:8704
    s_waitcnt lgkmcnt(6)
    v_mfma_f32_16x16x32_bf16 v[144:147], v[224:227], v[112:115], v[144:147]
    ds_read_b64_tr_b16 v[220:221], v240 offset:9216
    v_mfma_f32_16x16x32_bf16 v[148:151], v[224:227], v[116:119], v[148:151]
    ds_read_b64_tr_b16 v[222:223], v240 offset:9728
    v_mfma_f32_16x16x32_bf16 v[152:155], v[228:231], v[112:115], v[152:155]
    ds_read_b64_tr_b16 v[224:225], v240 offset:16384
    v_mfma_f32_16x16x32_bf16 v[156:159], v[228:231], v[116:119], v[156:159]
    ds_read_b64_tr_b16 v[226:227], v240 offset:16896
    s_waitcnt lgkmcnt(6)
    v_mfma_f32_16x16x32_bf16 v[144:147], v[208:211], v[120:123], v[144:147]
    ds_read_b64_tr_b16 v[228:229], v240 offset:17408
    v_mfma_f32_16x16x32_bf16 v[148:151], v[208:211], v[124:127], v[148:151]
    ds_read_b64_tr_b16 v[230:231], v240 offset:17920
    v_mfma_f32_16x16x32_bf16 v[152:155], v[212:215], v[120:123], v[152:155]
    ds_read_b64_tr_b16 v[208:209], v241 offset:16384
    v_mfma_f32_16x16x32_bf16 v[156:159], v[212:215], v[124:127], v[156:159]
    ds_read_b64_tr_b16 v[210:211], v241 offset:16896
    s_waitcnt lgkmcnt(6)
    v_mfma_f32_16x16x32_bf16 v[144:147], v[216:219], v[128:131], v[144:147]
    ds_read_b64_tr_b16 v[212:213], v241 offset:17408
    v_mfma_f32_16x16x32_bf16 v[148:151], v[216:219], v[132:135], v[148:151]
    ds_read_b64_tr_b16 v[214:215], v241 offset:17920
    s_setprio 2
    v_mfma_f32_16x16x32_bf16 v[152:155], v[220:223], v[128:131], v[152:155]
    ds_read_b64_tr_b16 v[216:217], v241 offset:24576
    v_mfma_f32_16x16x32_bf16 v[156:159], v[220:223], v[132:135], v[156:159]
    ds_read_b64_tr_b16 v[218:219], v241 offset:25088
    s_waitcnt lgkmcnt(6)
    v_mfma_f32_16x16x32_bf16 v[144:147], v[224:227], v[136:139], v[144:147]
    ds_read_b64_tr_b16 v[220:221], v241 offset:25600
    v_mfma_f32_16x16x32_bf16 v[148:151], v[224:227], v[140:143], v[148:151]
    ds_read_b64_tr_b16 v[222:223], v241 offset:26112
    v_mfma_f32_16x16x32_bf16 v[152:155], v[228:231], v[136:139], v[152:155]
    ds_read_b64_tr_b16 v[224:225], v241 offset:32768
    v_mfma_f32_16x16x32_bf16 v[156:159], v[228:231], v[140:143], v[156:159]
    ds_read_b64_tr_b16 v[226:227], v241 offset:33280
    s_waitcnt lgkmcnt(6)
    v_mfma_f32_16x16x32_bf16 v[160:163], v[208:211], v[72:75], v[160:163]
    ds_read_b64_tr_b16 v[228:229], v241 offset:33792
    v_mfma_f32_16x16x32_bf16 v[164:167], v[208:211], v[76:79], v[164:167]
    ds_read_b64_tr_b16 v[230:231], v241 offset:34304
    v_mfma_f32_16x16x32_bf16 v[168:171], v[212:215], v[72:75], v[168:171]
    ds_read_b64_tr_b16 v[208:209], v241 offset:40960
    v_mfma_f32_16x16x32_bf16 v[172:175], v[212:215], v[76:79], v[172:175]
    ds_read_b64_tr_b16 v[210:211], v241 offset:41472
    s_waitcnt lgkmcnt(6)
    v_mfma_f32_16x16x32_bf16 v[160:163], v[216:219], v[80:83], v[160:163]
    ds_read_b64_tr_b16 v[212:213], v241 offset:41984
    v_mul_f32 v152, v144, v152
    v_mul_f32 v144, v250, v144
    v_mfma_f32_16x16x32_bf16 v[164:167], v[216:219], v[84:87], v[164:167]
    ds_read_b64_tr_b16 v[214:215], v241 offset:42496
    v_mul_f32 v153, v145, v153
    s_waitcnt vmcnt(0)
    v_readfirstlane_b32 s45, v252
    s_nop 1
    s_cmp_lt_u32 s45, s49
    s_cbranch_scc1 KM_P0F_S
KM_P0F_X:
    v_mfma_f32_16x16x32_bf16 v[168:171], v[220:223], v[80:83], v[168:171]
    ds_read_b64_tr_b16 v[216:217], v241 offset:49152
    v_exp_f32 v144, v144
    v_mul_f32 v145, v250, v145
    v_mfma_f32_16x16x32_bf16 v[172:175], v[220:223], v[84:87], v[172:175]
    ds_read_b64_tr_b16 v[218:219], v241 offset:49664
    v_mul_f32 v154, v146, v154
    v_lshlrev_b32 v252, 5, v245
    v_mov_b32 v253, 1
    s_mov_b64 exec, 7
    buffer_atomic_add v253, v252, s[24:27], s39 offen offset:4
    s_mov_b64 exec, -1
    s_waitcnt lgkmcnt(6)
    v_mfma_f32_16x16x32_bf16 v[160:163], v[224:227], v[88:91], v[160:163]
    ds_read_b64_tr_b16 v[220:221], v241 offset:50176
    v_add_f32 v144, 1.0, v144
    v_exp_f32 v145, v145
    v_mfma_f32_16x16x32_bf16 v[164:167], v[224:227], v[92:95], v[164:167]
    ds_read_b64_tr_b16 v[222:223], v241 offset:50688
    v_mul_f32 v146, v250, v146
    s_mov_b32 s50, 0
    s_mov_b32 s51, 0
    s_add_u32 s51, s51, s55
    s_add_u32 m0, s53, 0x0
    s_add_u32 s45, s54, s50
    buffer_load_dwordx4 v245, s[24:27], s45 offen offset:0 sc1 lds
    v_mfma_f32_16x16x32_bf16 v[168:171], v[228:231], v[88:91], v[168:171]
    ds_read_b64_tr_b16 v[224:225], v241 offset:57344
    v_mul_f32 v155, v147, v155
    v_mfma_f32_16x16x32_bf16 v[172:175], v[228:231], v[92:95], v[172:175]
    ds_read_b64_tr_b16 v[226:227], v241 offset:57856
    v_rcp_f32 v144, v144
    v_add_f32 v145, 1.0, v145
    s_waitcnt lgkmcnt(6)
    v_mfma_f32_16x16x32_bf16 v[160:163], v[208:211], v[96:99], v[160:163]
    ds_read_b64_tr_b16 v[228:229], v241 offset:58368
    v_exp_f32 v146, v146
    v_mfma_f32_16x16x32_bf16 v[164:167], v[208:211], v[100:103], v[164:167]
    ds_read_b64_tr_b16 v[230:231], v241 offset:58880
    v_mul_f32 v147, v250, v147
    v_mul_f32 v156, v148, v156
    v_mfma_f32_16x16x32_bf16 v[168:171], v[212:215], v[96:99], v[168:171]
    v_add_u32 v241, 0x10000, v241
    ds_read_b64_tr_b16 v[208:209], v241 offset:0
    v_mul_f32 v152, v144, v152
    v_rcp_f32 v145, v145
    v_mfma_f32_16x16x32_bf16 v[172:175], v[212:215], v[100:103], v[172:175]
    ds_read_b64_tr_b16 v[210:211], v241 offset:512
    v_add_f32 v146, 1.0, v146
    s_add_u32 m0, s53, 0x0
    s_add_u32 s45, s54, s50
    buffer_load_dwordx4 v245, s[24:27], s45 offen offset:1024 sc1 lds
    s_waitcnt lgkmcnt(6)
    v_mfma_f32_16x16x32_bf16 v[160:163], v[216:219], v[104:107], v[160:163]
    ds_read_b64_tr_b16 v[212:213], v241 offset:1024
    v_exp_f32 v147, v147
    v_mfma_f32_16x16x32_bf16 v[164:167], v[216:219], v[108:111], v[164:167]
    ds_read_b64_tr_b16 v[214:215], v241 offset:1536
    v_mul_f32 v148, v250, v148
    v_mul_f32 v157, v149, v157
    v_mfma_f32_16x16x32_bf16 v[168:171], v[220:223], v[104:107], v[168:171]
    ds_read_b64_tr_b16 v[216:217], v241 offset:8192
    v_mul_f32 v153, v145, v153
    v_mfma_f32_16x16x32_bf16 v[172:175], v[220:223], v[108:111], v[172:175]
    ds_read_b64_tr_b16 v[218:219], v241 offset:8704
    v_rcp_f32 v146, v146
    v_add_f32 v147, 1.0, v147
    s_waitcnt lgkmcnt(6)
    v_mfma_f32_16x16x32_bf16 v[160:163], v[224:227], v[112:115], v[160:163]
    ds_read_b64_tr_b16 v[220:221], v241 offset:9216
    v_exp_f32 v148, v148
    v_mfma_f32_16x16x32_bf16 v[164:167], v[224:227], v[116:119], v[164:167]
    ds_read_b64_tr_b16 v[222:223], v241 offset:9728
    v_mul_f32 v149, v250, v149
    v_mul_f32 v158, v150, v158
    v_mfma_f32_16x16x32_bf16 v[168:171], v[228:231], v[112:115], v[168:171]
    ds_read_b64_tr_b16 v[224:225], v241 offset:16384
    v_mul_f32 v154, v146, v154
    v_rcp_f32 v147, v147
    v_mfma_f32_16x16x32_bf16 v[172:175], v[228:231], v[116:119], v[172:175]
    ds_read_b64_tr_b16 v[226:227], v241 offset:16896
    v_add_f32 v148, 1.0, v148
    s_add_u32 m0, s52, 0x4000
    s_add_u32 s45, s51, 0
    buffer_load_dwordx4 v246, s[4:7], s45 offen lds
    s_waitcnt lgkmcnt(6)
    v_mfma_f32_16x16x32_bf16 v[160:163], v[208:211], v[120:123], v[160:163]
    ds_read_b64_tr_b16 v[228:229], v241 offset:17408
    v_exp_f32 v149, v149
    v_mfma_f32_16x16x32_bf16 v[164:167], v[208:211], v[124:127], v[164:167]
    ds_read_b64_tr_b16 v[230:231], v241 offset:17920
    v_mul_f32 v150, v250, v150
    v_mul_f32 v159, v151, v159
    v_mfma_f32_16x16x32_bf16 v[168:171], v[212:215], v[120:123], v[168:171]
    ds_read_b64_tr_b16 v[208:209], v242 offset:16384
    v_mul_f32 v155, v147, v155
    v_mfma_f32_16x16x32_bf16 v[172:175], v[212:215], v[124:127], v[172:175]
    ds_read_b64_tr_b16 v[210:211], v242 offset:16896
    v_rcp_f32 v148, v148
    v_add_f32 v149, 1.0, v149
    s_waitcnt lgkmcnt(6)
    v_mfma_f32_16x16x32_bf16 v[160:163], v[216:219], v[128:131], v[160:163]
    ds_read_b64_tr_b16 v[212:213], v242 offset:17408
    v_exp_f32 v150, v150
    v_mul_f32 v151, v250, v151
    v_mfma_f32_16x16x32_bf16 v[164:167], v[216:219], v[132:135], v[164:167]
    ds_read_b64_tr_b16 v[214:215], v242 offset:17920
    v_mul_f32 v156, v148, v156
    s_add_u32 m0, s52, 0x6000
    s_add_u32 s45, s51, 128
    buffer_load_dwordx4 v246, s[4:7], s45 offen lds
    v_mfma_f32_16x16x32_bf16 v[168:171], v[220:223], v[128:131], v[168:171]
    ds_read_b64_tr_b16 v[216:217], v242 offset:24576
    v_rcp_f32 v149, v149
    v_mfma_f32_16x16x32_bf16 v[172:175], v[220:223], v[132:135], v[172:175]
    ds_read_b64_tr_b16 v[218:219], v242 offset:25088
    v_add_f32 v150, 1.0, v150
    v_exp_f32 v151, v151
    s_waitcnt lgkmcnt(6)
    s_setprio 1
    v_mfma_f32_16x16x32_bf16 v[160:163], v[224:227], v[136:139], v[160:163]
    ds_read_b64_tr_b16 v[220:221], v242 offset:25600
    v_mul_f32 v157, v149, v157
    v_mfma_f32_16x16x32_bf16 v[164:167], v[224:227], v[140:143], v[164:167]
    ds_read_b64_tr_b16 v[222:223], v242 offset:26112
    v_rcp_f32 v150, v150
    v_add_f32 v151, 1.0, v151
    v_mfma_f32_16x16x32_bf16 v[168:171], v[228:231], v[136:139], v[168:171]
    ds_read_b64_tr_b16 v[224:225], v242 offset:32768
    v_mul_f32 v158, v150, v158
    v_mfma_f32_16x16x32_bf16 v[172:175], v[228:231], v[140:143], v[172:175]
    ds_read_b64_tr_b16 v[226:227], v242 offset:33280
    v_rcp_f32 v151, v151
    s_nop 0
    s_waitcnt lgkmcnt(6)
    v_mfma_f32_16x16x32_bf16 v[176:179], v[208:211], v[72:75], v[176:179]
    ds_read_b64_tr_b16 v[228:229], v242 offset:33792
    v_mul_f32 v159, v151, v159
    v_cvt_pk_bf16_f32 v232, v152, v153
    v_mfma_f32_16x16x32_bf16 v[180:183], v[208:211], v[76:79], v[180:183]
    ds_read_b64_tr_b16 v[230:231], v242 offset:34304
    v_cvt_pk_bf16_f32 v233, v154, v155
    s_add_u32 m0, s52, 0x8000
    s_add_u32 s45, s51, 256
    buffer_load_dwordx4 v246, s[4:7], s45 offen lds
    v_mfma_f32_16x16x32_bf16 v[184:187], v[212:215], v[72:75], v[184:187]
    ds_read_b64_tr_b16 v[208:209], v242 offset:40960
    v_cvt_pk_bf16_f32 v236, v156, v157
    v_mfma_f32_16x16x32_bf16 v[188:191], v[212:215], v[76:79], v[188:191]
    ds_read_b64_tr_b16 v[210:211], v242 offset:41472
    v_cvt_pk_bf16_f32 v237, v158, v159
    s_waitcnt lgkmcnt(6)
    v_mfma_f32_16x16x32_bf16 v[176:179], v[216:219], v[80:83], v[176:179]
    ds_read_b64_tr_b16 v[212:213], v242 offset:41984
    v_mul_f32 v168, v160, v168
    v_mul_f32 v160, v250, v160
    v_mfma_f32_16x16x32_bf16 v[180:183], v[216:219], v[84:87], v[180:183]
    ds_read_b64_tr_b16 v[214:215], v242 offset:42496
    v_mul_f32 v169, v161, v169
    v_exp_f32 v160, v160
    v_mfma_f32_16x16x32_bf16 v[184:187], v[220:223], v[80:83], v[184:187]
    ds_read_b64_tr_b16 v[216:217], v242 offset:49152
    v_mul_f32 v161, v250, v161
    v_mfma_f32_16x16x32_bf16 v[188:191], v[220:223], v[84:87], v[188:191]
    ds_read_b64_tr_b16 v[218:219], v242 offset:49664
    v_mul_f32 v170, v162, v170
    v_add_f32 v160, 1.0, v160
    s_waitcnt lgkmcnt(6)
    v_mfma_f32_16x16x32_bf16 v[176:179], v[224:227], v[88:91], v[176:179]
    ds_read_b64_tr_b16 v[220:221], v242 offset:50176
    v_exp_f32 v161, v161
    v_mul_f32 v162, v250, v162
    v_mfma_f32_16x16x32_bf16 v[180:183], v[224:227], v[92:95], v[180:183]
    ds_read_b64_tr_b16 v[222:223], v242 offset:50688
    v_mul_f32 v171, v163, v171
    s_lshr_b32 s36, s12, 1
    s_mul_i32 s36, s36, 6
    s_add_u32 s36, s36, 0
    s_and_b32 s37, s36, 3
    s_lshl_b32 s37, s37, 5
    v_xor_b32 v152, s37, v248
    s_mov_b32 s50, 4096
    s_mov_b32 s51, 147456
    s_add_u32 s51, s51, s55
    s_add_u32 m0, s53, 0xa000
    s_add_u32 s45, s54, s50
    buffer_load_dwordx4 v245, s[24:27], s45 offen offset:0 sc1 lds
    v_mfma_f32_16x16x32_bf16 v[184:187], v[228:231], v[88:91], v[184:187]
    ds_read_b64_tr_b16 v[224:225], v242 offset:57344
    v_rcp_f32 v160, v160
    v_mfma_f32_16x16x32_bf16 v[188:191], v[228:231], v[92:95], v[188:191]
    ds_read_b64_tr_b16 v[226:227], v242 offset:57856
    v_add_f32 v161, 1.0, v161
    v_exp_f32 v162, v162
    s_waitcnt lgkmcnt(6)
    v_mfma_f32_16x16x32_bf16 v[176:179], v[208:211], v[96:99], v[176:179]
    ds_read_b64_tr_b16 v[228:229], v242 offset:58368
    v_mul_f32 v163, v250, v163
    v_mul_f32 v172, v164, v172
    v_mfma_f32_16x16x32_bf16 v[180:183], v[208:211], v[100:103], v[180:183]
    ds_read_b64_tr_b16 v[230:231], v242 offset:58880
    v_mul_f32 v168, v160, v168
    s_lshr_b32 s36, s36, 2
    s_lshl_b32 s36, s36, 13
    s_add_u32 s36, s36, 16384
    v_add_u32 v152, s36, v152
    v_mfma_f32_16x16x32_bf16 v[184:187], v[212:215], v[96:99], v[184:187]
    v_add_u32 v242, 0x10000, v242
    ds_read_b64_tr_b16 v[208:209], v242 offset:0
    v_rcp_f32 v161, v161
    v_add_f32 v162, 1.0, v162
    v_mfma_f32_16x16x32_bf16 v[188:191], v[212:215], v[100:103], v[188:191]
    ds_read_b64_tr_b16 v[210:211], v242 offset:512
    v_exp_f32 v163, v163
    s_add_u32 m0, s53, 0xa000
    s_add_u32 s45, s54, s50
    buffer_load_dwordx4 v245, s[24:27], s45 offen offset:1024 sc1 lds
    s_waitcnt lgkmcnt(6)
    v_mfma_f32_16x16x32_bf16 v[176:179], v[216:219], v[104:107], v[176:179]
    ds_read_b64_tr_b16 v[212:213], v242 offset:1024
    v_mul_f32 v164, v250, v164
    v_mul_f32 v173, v165, v173
    v_mfma_f32_16x16x32_bf16 v[180:183], v[216:219], v[108:111], v[180:183]
    ds_read_b64_tr_b16 v[214:215], v242 offset:1536
    v_mul_f32 v169, v161, v169
    s_lshr_b32 s36, s12, 1
    s_mul_i32 s36, s36, 6
    s_add_u32 s36, s36, 1
    s_and_b32 s37, s36, 3
    s_lshl_b32 s37, s37, 5
    v_xor_b32 v153, s37, v248
    v_mfma_f32_16x16x32_bf16 v[184:187], v[220:223], v[104:107], v[184:187]
    ds_read_b64_tr_b16 v[216:217], v242 offset:8192
    v_rcp_f32 v162, v162
    v_mfma_f32_16x16x32_bf16 v[188:191], v[220:223], v[108:111], v[188:191]
    ds_read_b64_tr_b16 v[218:219], v242 offset:8704
    v_add_f32 v163, 1.0, v163
    v_exp_f32 v164, v164
    s_waitcnt lgkmcnt(6)
    v_mfma_f32_16x16x32_bf16 v[176:179], v[224:227], v[112:115], v[176:179]
    ds_read_b64_tr_b16 v[220:221], v242 offset:9216
    v_mul_f32 v165, v250, v165
    v_mul_f32 v174, v166, v174
    v_mfma_f32_16x16x32_bf16 v[180:183], v[224:227], v[116:119], v[180:183]
    ds_read_b64_tr_b16 v[222:223], v242 offset:9728
    v_mul_f32 v170, v162, v170
    s_lshr_b32 s36, s36, 2
    s_lshl_b32 s36, s36, 13
    s_add_u32 s36, s36, 16384
    v_add_u32 v153, s36, v153
    v_mfma_f32_16x16x32_bf16 v[184:187], v[228:231], v[112:115], v[184:187]
    ds_read_b64_tr_b16 v[224:225], v242 offset:16384
    v_rcp_f32 v163, v163
    v_add_f32 v164, 1.0, v164
    v_mfma_f32_16x16x32_bf16 v[188:191], v[228:231], v[116:119], v[188:191]
    ds_read_b64_tr_b16 v[226:227], v242 offset:16896
    v_exp_f32 v165, v165
    v_mul_f32 v166, v250, v166
    s_add_u32 m0, s52, 0xe000
    s_add_u32 s45, s51, 0
    buffer_load_dwordx4 v246, s[4:7], s45 offen lds
    s_waitcnt lgkmcnt(6)
    s_setprio 0
    s_cmp_lt_u32 s12, 4
    s_cbranch_scc1 KM_LP
    s_setprio 3
KM_LP:
    v_mfma_f32_16x16x32_bf16 v[176:179], v[208:211], v[120:123], v[176:179]
    ds_read_b64_tr_b16 v[228:229], v242 offset:17408
    v_mul_f32 v175, v167, v175
    v_mfma_f32_16x16x32_bf16 v[180:183], v[208:211], v[124:127], v[180:183]
    ds_read_b64_tr_b16 v[230:231], v242 offset:17920
    v_mul_f32 v171, v163, v171
    v_rcp_f32 v164, v164
    v_mfma_f32_16x16x32_bf16 v[184:187], v[212:215], v[120:123], v[184:187]
    ds_read_b64_tr_b16 v[208:209], v243 offset:16384
    v_add_f32 v165, 1.0, v165
    v_exp_f32 v166, v166
    v_mfma_f32_16x16x32_bf16 v[188:191], v[212:215], v[124:127], v[188:191]
    ds_read_b64_tr_b16 v[210:211], v243 offset:16896
    v_mul_f32 v167, v250, v167
    s_lshr_b32 s36, s12, 1
    s_mul_i32 s36, s36, 6
    s_add_u32 s36, s36, 2
    s_and_b32 s37, s36, 3
    s_lshl_b32 s37, s37, 5
    v_xor_b32 v154, s37, v248
    s_waitcnt lgkmcnt(6)
    v_mfma_f32_16x16x32_bf16 v[176:179], v[216:219], v[128:131], v[176:179]
    ds_read_b64_tr_b16 v[212:213], v243 offset:17408
    v_mul_f32 v172, v164, v172
    v_rcp_f32 v165, v165
    v_mfma_f32_16x16x32_bf16 v[180:183], v[216:219], v[132:135], v[180:183]
    ds_read_b64_tr_b16 v[214:215], v243 offset:17920
    v_add_f32 v166, 1.0, v166
    s_add_u32 m0, s52, 0x10000
    s_add_u32 s45, s51, 128
    buffer_load_dwordx4 v246, s[4:7], s45 offen lds
    v_mfma_f32_16x16x32_bf16 v[184:187], v[220:223], v[128:131], v[184:187]
    ds_read_b64_tr_b16 v[216:217], v243 offset:24576
    v_exp_f32 v167, v167
    v_mul_f32 v173, v165, v173
    v_mfma_f32_16x16x32_bf16 v[188:191], v[220:223], v[132:135], v[188:191]
    ds_read_b64_tr_b16 v[218:219], v243 offset:25088
    v_rcp_f32 v166, v166
    s_lshr_b32 s36, s36, 2
    s_lshl_b32 s36, s36, 13
    s_add_u32 s36, s36, 16384
    v_add_u32 v154, s36, v154
    s_waitcnt lgkmcnt(6)
    v_mfma_f32_16x16x32_bf16 v[176:179], v[224:227], v[136:139], v[176:179]
    ds_read_b64_tr_b16 v[220:221], v243 offset:25600
    v_add_f32 v167, 1.0, v167
    v_mfma_f32_16x16x32_bf16 v[180:183], v[224:227], v[140:143], v[180:183]
    ds_read_b64_tr_b16 v[222:223], v243 offset:26112
    v_mul_f32 v174, v166, v174
    v_rcp_f32 v167, v167
    v_mfma_f32_16x16x32_bf16 v[184:187], v[228:231], v[136:139], v[184:187]
    ds_read_b64_tr_b16 v[224:225], v243 offset:32768
    s_nop 0
    v_mul_f32 v175, v167, v175
    v_mfma_f32_16x16x32_bf16 v[188:191], v[228:231], v[140:143], v[188:191]
    ds_read_b64_tr_b16 v[226:227], v243 offset:33280
    v_cvt_pk_bf16_f32 v234, v168, v169
    s_lshr_b32 s36, s12, 1
    s_mul_i32 s36, s36, 6
    s_add_u32 s36, s36, 3
    s_and_b32 s37, s36, 3
    s_lshl_b32 s37, s37, 5
    v_xor_b32 v155, s37, v248
    s_waitcnt lgkmcnt(6)
    v_mfma_f32_16x16x32_bf16 v[192:195], v[208:211], v[72:75], v[192:195]
    ds_read_b64_tr_b16 v[228:229], v243 offset:33792
    v_cvt_pk_bf16_f32 v235, v170, v171
    v_cvt_pk_bf16_f32 v238, v172, v173
    v_mfma_f32_16x16x32_bf16 v[196:199], v[208:211], v[76:79], v[196:199]
    ds_read_b64_tr_b16 v[230:231], v243 offset:34304
    v_cvt_pk_bf16_f32 v239, v174, v175
    s_add_u32 m0, s52, 0x12000
    s_add_u32 s45, s51, 256
    buffer_load_dwordx4 v246, s[4:7], s45 offen lds
    v_mfma_f32_16x16x32_bf16 v[200:203], v[212:215], v[72:75], v[200:203]
    ds_read_b64_tr_b16 v[208:209], v243 offset:40960
    buffer_store_dwordx4 v[232:235], v245, s[24:27], s42 offen sc1
    v_mfma_f32_16x16x32_bf16 v[204:207], v[212:215], v[76:79], v[204:207]
    ds_read_b64_tr_b16 v[210:211], v243 offset:41472
    s_add_u32 s48, s42, 148480
    buffer_store_dwordx4 v[236:239], v245, s[24:27], s48 offen sc1
    s_waitcnt lgkmcnt(6)
    v_mfma_f32_16x16x32_bf16 v[192:195], v[216:219], v[80:83], v[192:195]
    ds_read_b64_tr_b16 v[212:213], v243 offset:41984
    v_mul_f32 v184, v176, v184
    v_mul_f32 v176, v250, v176
    v_mfma_f32_16x16x32_bf16 v[196:199], v[216:219], v[84:87], v[196:199]
    ds_read_b64_tr_b16 v[214:215], v243 offset:42496
    v_mul_f32 v185, v177, v185
    v_exp_f32 v176, v176
    s_lshr_b32 s36, s36, 2
    s_lshl_b32 s36, s36, 13
    s_add_u32 s36, s36, 16384
    v_add_u32 v155, s36, v155
    v_mfma_f32_16x16x32_bf16 v[200:203], v[220:223], v[80:83], v[200:203]
    ds_read_b64_tr_b16 v[216:217], v243 offset:49152
    v_mul_f32 v177, v250, v177
    v_mfma_f32_16x16x32_bf16 v[204:207], v[220:223], v[84:87], v[204:207]
    ds_read_b64_tr_b16 v[218:219], v243 offset:49664
    v_mul_f32 v186, v178, v186
    v_add_f32 v176, 1.0, v176
    s_waitcnt lgkmcnt(6)
    v_mfma_f32_16x16x32_bf16 v[192:195], v[224:227], v[88:91], v[192:195]
    ds_read_b64_tr_b16 v[220:221], v243 offset:50176
    v_exp_f32 v177, v177
    v_mul_f32 v178, v250, v178
    v_mfma_f32_16x16x32_bf16 v[196:199], v[224:227], v[92:95], v[196:199]
    ds_read_b64_tr_b16 v[222:223], v243 offset:50688
    v_mul_f32 v187, v179, v187
    s_lshr_b32 s36, s12, 1
    s_mul_i32 s36, s36, 6
    s_add_u32 s36, s36, 4
    s_and_b32 s37, s36, 3
    s_lshl_b32 s37, s37, 5
    v_xor_b32 v156, s37, v248
    v_mfma_f32_16x16x32_bf16 v[200:203], v[228:231], v[88:91], v[200:203]
    ds_read_b64_tr_b16 v[224:225], v243 offset:57344
    v_rcp_f32 v176, v176
    v_add_f32 v177, 1.0, v177
    v_mfma_f32_16x16x32_bf16 v[204:207], v[228:231], v[92:95], v[204:207]
    ds_read_b64_tr_b16 v[226:227], v243 offset:57856
    v_exp_f32 v178, v178
    v_mul_f32 v179, v250, v179
    s_waitcnt lgkmcnt(6)
    v_mfma_f32_16x16x32_bf16 v[192:195], v[208:211], v[96:99], v[192:195]
    ds_read_b64_tr_b16 v[228:229], v243 offset:58368
    v_mul_f32 v188, v180, v188
    v_mul_f32 v184, v176, v184
    v_mfma_f32_16x16x32_bf16 v[196:199], v[208:211], v[100:103], v[196:199]
    ds_read_b64_tr_b16 v[230:231], v243 offset:58880
    v_rcp_f32 v177, v177
    s_lshr_b32 s36, s36, 2
    s_lshl_b32 s36, s36, 13
    s_add_u32 s36, s36, 16384
    v_add_u32 v156, s36, v156
    v_mfma_f32_16x16x32_bf16 v[200:203], v[212:215], v[96:99], v[200:203]
    v_add_u32 v243, 0x10000, v243
    ds_read_b64_tr_b16 v[208:209], v243 offset:0
    v_add_f32 v178, 1.0, v178
    v_mfma_f32_16x16x32_bf16 v[204:207], v[212:215], v[100:103], v[204:207]
    ds_read_b64_tr_b16 v[210:211], v243 offset:512
    v_exp_f32 v179, v179
    v_mul_f32 v180, v250, v180
    s_waitcnt lgkmcnt(6)
    v_mfma_f32_16x16x32_bf16 v[192:195], v[216:219], v[104:107], v[192:195]
    ds_read_b64_tr_b16 v[212:213], v243 offset:1024
    v_mul_f32 v189, v181, v189
    v_mul_f32 v185, v177, v185
    v_mfma_f32_16x16x32_bf16 v[196:199], v[216:219], v[108:111], v[196:199]
    ds_read_b64_tr_b16 v[214:215], v243 offset:1536
    v_rcp_f32 v178, v178
    v_add_f32 v179, 1.0, v179
    v_mfma_f32_16x16x32_bf16 v[200:203], v[220:223], v[104:107], v[200:203]
    ds_read_b64_tr_b16 v[216:217], v243 offset:8192
    v_exp_f32 v180, v180
    v_mul_f32 v181, v250, v181
    v_mfma_f32_16x16x32_bf16 v[204:207], v[220:223], v[108:111], v[204:207]
    ds_read_b64_tr_b16 v[218:219], v243 offset:8704
    v_mul_f32 v190, v182, v190
    s_lshr_b32 s36, s12, 1
    s_mul_i32 s36, s36, 6
    s_add_u32 s36, s36, 5
    s_and_b32 s37, s36, 3
    s_lshl_b32 s37, s37, 5
    v_xor_b32 v157, s37, v248
    s_waitcnt lgkmcnt(6)
    v_mfma_f32_16x16x32_bf16 v[192:195], v[224:227], v[112:115], v[192:195]
    ds_read_b64_tr_b16 v[220:221], v243 offset:9216
    v_mul_f32 v186, v178, v186
    v_mfma_f32_16x16x32_bf16 v[196:199], v[224:227], v[116:119], v[196:199]
    ds_read_b64_tr_b16 v[222:223], v243 offset:9728
    v_rcp_f32 v179, v179
    v_add_f32 v180, 1.0, v180
    v_mfma_f32_16x16x32_bf16 v[200:203], v[228:231], v[112:115], v[200:203]
    ds_read_b64_tr_b16 v[224:225], v243 offset:16384
    v_exp_f32 v181, v181
    v_mul_f32 v182, v250, v182
    v_mfma_f32_16x16x32_bf16 v[204:207], v[228:231], v[116:119], v[204:207]
    ds_read_b64_tr_b16 v[226:227], v243 offset:16896
    v_mul_f32 v191, v183, v191
    v_mul_f32 v187, v179, v187
    s_lshr_b32 s36, s36, 2
    s_lshl_b32 s36, s36, 13
    s_add_u32 s36, s36, 16384
    v_add_u32 v157, s36, v157
    s_waitcnt lgkmcnt(6)
    v_mfma_f32_16x16x32_bf16 v[192:195], v[208:211], v[120:123], v[192:195]
    ds_read_b64_tr_b16 v[228:229], v243 offset:17408
    v_rcp_f32 v180, v180
    v_mfma_f32_16x16x32_bf16 v[196:199], v[208:211], v[124:127], v[196:199]
    ds_read_b64_tr_b16 v[230:231], v243 offset:17920
    v_add_f32 v181, 1.0, v181
    v_exp_f32 v182, v182
    v_mfma_f32_16x16x32_bf16 v[200:203], v[212:215], v[120:123], v[200:203]
    v_mul_f32 v183, v250, v183
    v_mul_f32 v188, v180, v188
    v_mfma_f32_16x16x32_bf16 v[204:207], v[212:215], v[124:127], v[204:207]
    v_rcp_f32 v181, v181
    s_and_b32 s36, s12, 1
    s_lshl_b32 s36, s36, 13
    v_add_u32 v158, s36, v245
    v_add_u32 v159, s36, v251
    s_waitcnt lgkmcnt(4)
    v_mfma_f32_16x16x32_bf16 v[192:195], v[216:219], v[128:131], v[192:195]
    v_add_f32 v182, 1.0, v182
    v_exp_f32 v183, v183
    v_mfma_f32_16x16x32_bf16 v[196:199], v[216:219], v[132:135], v[196:199]
    v_mul_f32 v189, v181, v189
    v_rcp_f32 v182, v182
    v_mfma_f32_16x16x32_bf16 v[200:203], v[220:223], v[128:131], v[200:203]
    v_add_f32 v183, 1.0, v183
    v_mfma_f32_16x16x32_bf16 v[204:207], v[220:223], v[132:135], v[204:207]
    v_mul_f32 v190, v182, v190
    v_rcp_f32 v183, v183
    s_waitcnt lgkmcnt(0)
    v_mfma_f32_16x16x32_bf16 v[192:195], v[224:227], v[136:139], v[192:195]
    s_nop 0
    v_mfma_f32_16x16x32_bf16 v[196:199], v[224:227], v[140:143], v[196:199]
    v_mul_f32 v191, v183, v191
    v_cvt_pk_bf16_f32 v232, v184, v185
    v_mfma_f32_16x16x32_bf16 v[200:203], v[228:231], v[136:139], v[200:203]
    v_cvt_pk_bf16_f32 v233, v186, v187
    v_mfma_f32_16x16x32_bf16 v[204:207], v[228:231], v[140:143], v[204:207]
    v_cvt_pk_bf16_f32 v236, v188, v189
    v_cvt_pk_bf16_f32 v237, v190, v191
    s_cmp_ge_u32 s12, 4
    s_cbranch_scc1 KM_FLOAD
    s_waitcnt vmcnt(2)
    s_barrier
    ds_read_b64_tr_b16 v[128:129], v152 offset:0
    ds_read_b64_tr_b16 v[130:131], v152 offset:2048
    ds_read_b128 v[96:99], v158 offset:0
    ds_read_b128 v[100:103], v158 offset:2048
    ds_read_b128 v[104:107], v158 offset:4096
    ds_read_b128 v[108:111], v158 offset:6144
    ds_read_b64_tr_b16 v[132:133], v153 offset:0
    ds_read_b64_tr_b16 v[134:135], v153 offset:2048
    ds_read_b64_tr_b16 v[136:137], v154 offset:0
    ds_read_b64_tr_b16 v[138:139], v154 offset:2048
    ds_read_b64_tr_b16 v[140:141], v155 offset:0
    ds_read_b64_tr_b16 v[142:143], v155 offset:2048
    s_waitcnt lgkmcnt(9)
    v_mfma_f32_16x16x32_bf16 v[0:3], v[128:131], v[96:99], 0
    ds_read_b64_tr_b16 v[144:145], v156 offset:0
    s_waitcnt lgkmcnt(9)
    v_mfma_f32_16x16x32_bf16 v[24:27], v[128:131], v[100:103], 0
    ds_read_b64_tr_b16 v[146:147], v156 offset:2048
    s_waitcnt lgkmcnt(9)
    v_mfma_f32_16x16x32_bf16 v[48:51], v[128:131], v[104:107], 0
    s_waitcnt lgkmcnt(8)
    v_mfma_f32_16x16x32_bf16 v[72:75], v[128:131], v[108:111], 0
    s_waitcnt lgkmcnt(6)
    v_mfma_f32_16x16x32_bf16 v[4:7], v[132:135], v[96:99], 0
    ds_read_b64_tr_b16 v[128:129], v157 offset:0
    v_mfma_f32_16x16x32_bf16 v[28:31], v[132:135], v[100:103], 0
    ds_read_b64_tr_b16 v[130:131], v157 offset:2048
    v_mfma_f32_16x16x32_bf16 v[52:55], v[132:135], v[104:107], 0
    v_mfma_f32_16x16x32_bf16 v[76:79], v[132:135], v[108:111], 0
    s_waitcnt lgkmcnt(6)
    v_mfma_f32_16x16x32_bf16 v[8:11], v[136:139], v[96:99], 0
    ds_read_b64_tr_b16 v[132:133], v152 offset:4096
    v_mfma_f32_16x16x32_bf16 v[32:35], v[136:139], v[100:103], 0
    ds_read_b64_tr_b16 v[134:135], v152 offset:6144
    v_mul_f32 v200, v192, v200
    v_mfma_f32_16x16x32_bf16 v[56:59], v[136:139], v[104:107], 0
    ds_read_b128 v[112:115], v158 offset:1024
    v_mfma_f32_16x16x32_bf16 v[80:83], v[136:139], v[108:111], 0
    v_mul_f32 v192, v250, v192
    v_mul_f32 v201, v193, v201
    s_waitcnt lgkmcnt(7)
    v_mfma_f32_16x16x32_bf16 v[12:15], v[140:143], v[96:99], 0
    ds_read_b64_tr_b16 v[136:137], v153 offset:4096
    v_mfma_f32_16x16x32_bf16 v[36:39], v[140:143], v[100:103], 0
    ds_read_b64_tr_b16 v[138:139], v153 offset:6144
    v_exp_f32 v192, v192
    v_mfma_f32_16x16x32_bf16 v[60:63], v[140:143], v[104:107], 0
    ds_read_b128 v[116:119], v158 offset:3072
    v_mfma_f32_16x16x32_bf16 v[84:87], v[140:143], v[108:111], 0
    v_mul_f32 v193, v250, v193
    v_mul_f32 v202, v194, v202
    s_waitcnt lgkmcnt(8)
    v_mfma_f32_16x16x32_bf16 v[16:19], v[144:147], v[96:99], 0
    ds_read_b64_tr_b16 v[140:141], v154 offset:4096
    v_mfma_f32_16x16x32_bf16 v[40:43], v[144:147], v[100:103], 0
    ds_read_b64_tr_b16 v[142:143], v154 offset:6144
    v_add_f32 v192, 1.0, v192
    v_mfma_f32_16x16x32_bf16 v[64:67], v[144:147], v[104:107], 0
    ds_read_b128 v[120:123], v158 offset:5120
    v_mfma_f32_16x16x32_bf16 v[88:91], v[144:147], v[108:111], 0
    v_exp_f32 v193, v193
    v_mul_f32 v194, v250, v194
    s_waitcnt lgkmcnt(9)
    v_mfma_f32_16x16x32_bf16 v[20:23], v[128:131], v[96:99], 0
    ds_read_b64_tr_b16 v[144:145], v155 offset:4096
    v_mfma_f32_16x16x32_bf16 v[44:47], v[128:131], v[100:103], 0
    ds_read_b64_tr_b16 v[146:147], v155 offset:6144
    v_mul_f32 v203, v195, v203
    v_mfma_f32_16x16x32_bf16 v[68:71], v[128:131], v[104:107], 0
    ds_read_b128 v[124:127], v158 offset:7168
    v_mfma_f32_16x16x32_bf16 v[92:95], v[128:131], v[108:111], 0
    v_rcp_f32 v192, v192
    v_add_f32 v193, 1.0, v193
    s_waitcnt lgkmcnt(9)
    v_mfma_f32_16x16x32_bf16 v[0:3], v[132:135], v[112:115], v[0:3]
    ds_read_b64_tr_b16 v[128:129], v156 offset:4096
    s_waitcnt lgkmcnt(7)
    v_mfma_f32_16x16x32_bf16 v[24:27], v[132:135], v[116:119], v[24:27]
    ds_read_b64_tr_b16 v[130:131], v156 offset:6144
    v_exp_f32 v194, v194
    s_waitcnt lgkmcnt(5)
    v_mfma_f32_16x16x32_bf16 v[48:51], v[132:135], v[120:123], v[48:51]
    v_mul_f32 v195, v250, v195
    v_mul_f32 v204, v196, v204
    s_waitcnt lgkmcnt(2)
    v_mfma_f32_16x16x32_bf16 v[72:75], v[132:135], v[124:127], v[72:75]
    v_mul_f32 v200, v192, v200
    v_rcp_f32 v193, v193
    v_mfma_f32_16x16x32_bf16 v[4:7], v[136:139], v[112:115], v[4:7]
    ds_read_b64_tr_b16 v[132:133], v157 offset:4096
    v_mfma_f32_16x16x32_bf16 v[28:31], v[136:139], v[116:119], v[28:31]
    ds_read_b64_tr_b16 v[134:135], v157 offset:6144
    v_add_f32 v194, 1.0, v194
    v_mfma_f32_16x16x32_bf16 v[52:55], v[136:139], v[120:123], v[52:55]
    v_exp_f32 v195, v195
    v_mul_f32 v196, v250, v196
    v_mfma_f32_16x16x32_bf16 v[76:79], v[136:139], v[124:127], v[76:79]
    v_mul_f32 v205, v197, v205
    v_mul_f32 v201, v193, v201
    v_mfma_f32_16x16x32_bf16 v[8:11], v[140:143], v[112:115], v[8:11]
    s_waitcnt lgkmcnt(0)
    s_barrier
    v_mfma_f32_16x16x32_bf16 v[32:35], v[140:143], v[116:119], v[32:35]
    ds_read_b64_tr_b16 v[136:137], v152 offset:40960
    v_rcp_f32 v194, v194
    v_mfma_f32_16x16x32_bf16 v[56:59], v[140:143], v[120:123], v[56:59]
    ds_read_b64_tr_b16 v[138:139], v152 offset:43008
    v_mfma_f32_16x16x32_bf16 v[80:83], v[140:143], v[124:127], v[80:83]
    ds_read_b128 v[96:99], v158 offset:40960
    v_add_f32 v195, 1.0, v195
    v_mfma_f32_16x16x32_bf16 v[12:15], v[144:147], v[112:115], v[12:15]
    ds_read_b64_tr_b16 v[140:141], v153 offset:40960
    v_mfma_f32_16x16x32_bf16 v[36:39], v[144:147], v[116:119], v[36:39]
    ds_read_b64_tr_b16 v[142:143], v153 offset:43008
    v_exp_f32 v196, v196
    v_mfma_f32_16x16x32_bf16 v[60:63], v[144:147], v[120:123], v[60:63]
    ds_read_b128 v[100:103], v158 offset:43008
    v_mfma_f32_16x16x32_bf16 v[84:87], v[144:147], v[124:127], v[84:87]
    v_mul_f32 v197, v250, v197
    v_mul_f32 v206, v198, v206
    v_mfma_f32_16x16x32_bf16 v[16:19], v[128:131], v[112:115], v[16:19]
    ds_read_b64_tr_b16 v[144:145], v154 offset:40960
    v_mfma_f32_16x16x32_bf16 v[40:43], v[128:131], v[116:119], v[40:43]
    ds_read_b64_tr_b16 v[146:147], v154 offset:43008
    v_mul_f32 v202, v194, v202
    v_mfma_f32_16x16x32_bf16 v[64:67], v[128:131], v[120:123], v[64:67]
    ds_read_b128 v[104:107], v158 offset:45056
    v_mfma_f32_16x16x32_bf16 v[88:91], v[128:131], v[124:127], v[88:91]
    v_rcp_f32 v195, v195
    v_add_f32 v196, 1.0, v196
    v_mfma_f32_16x16x32_bf16 v[20:23], v[132:135], v[112:115], v[20:23]
    ds_read_b64_tr_b16 v[128:129], v155 offset:40960
    v_mfma_f32_16x16x32_bf16 v[44:47], v[132:135], v[116:119], v[44:47]
    ds_read_b64_tr_b16 v[130:131], v155 offset:43008
    v_exp_f32 v197, v197
    v_mfma_f32_16x16x32_bf16 v[68:71], v[132:135], v[120:123], v[68:71]
    ds_read_b128 v[108:111], v158 offset:47104
    v_mfma_f32_16x16x32_bf16 v[92:95], v[132:135], v[124:127], v[92:95]
    v_mul_f32 v198, v250, v198
    v_mul_f32 v207, v199, v207
    s_waitcnt lgkmcnt(9)
    v_mfma_f32_16x16x32_bf16 v[0:3], v[136:139], v[96:99], v[0:3]
    ds_read_b64_tr_b16 v[132:133], v156 offset:40960
    s_waitcnt lgkmcnt(7)
    v_mfma_f32_16x16x32_bf16 v[24:27], v[136:139], v[100:103], v[24:27]
    ds_read_b64_tr_b16 v[134:135], v156 offset:43008
    v_mul_f32 v203, v195, v203
    s_waitcnt lgkmcnt(5)
    v_mfma_f32_16x16x32_bf16 v[48:51], v[136:139], v[104:107], v[48:51]
    v_rcp_f32 v196, v196
    v_add_f32 v197, 1.0, v197
    s_waitcnt lgkmcnt(2)
    v_mfma_f32_16x16x32_bf16 v[72:75], v[136:139], v[108:111], v[72:75]
    v_exp_f32 v198, v198
    v_mul_f32 v199, v250, v199
    v_mfma_f32_16x16x32_bf16 v[4:7], v[140:143], v[96:99], v[4:7]
    ds_read_b64_tr_b16 v[136:137], v157 offset:40960
    v_mfma_f32_16x16x32_bf16 v[28:31], v[140:143], v[100:103], v[28:31]
    ds_read_b64_tr_b16 v[138:139], v157 offset:43008
    v_mul_f32 v204, v196, v204
    v_mfma_f32_16x16x32_bf16 v[52:55], v[140:143], v[104:107], v[52:55]
    v_rcp_f32 v197, v197
    v_add_f32 v198, 1.0, v198
    v_mfma_f32_16x16x32_bf16 v[76:79], v[140:143], v[108:111], v[76:79]
    v_exp_f32 v199, v199
    v_mul_f32 v205, v197, v205
    v_mfma_f32_16x16x32_bf16 v[8:11], v[144:147], v[96:99], v[8:11]
    ds_read_b64_tr_b16 v[140:141], v152 offset:45056
    v_mfma_f32_16x16x32_bf16 v[32:35], v[144:147], v[100:103], v[32:35]
    ds_read_b64_tr_b16 v[142:143], v152 offset:47104
    v_rcp_f32 v198, v198
    v_mfma_f32_16x16x32_bf16 v[56:59], v[144:147], v[104:107], v[56:59]
    ds_read_b128 v[112:115], v158 offset:41984
    v_mfma_f32_16x16x32_bf16 v[80:83], v[144:147], v[108:111], v[80:83]
    v_add_f32 v199, 1.0, v199
    v_mul_f32 v206, v198, v206
    v_mfma_f32_16x16x32_bf16 v[12:15], v[128:131], v[96:99], v[12:15]
    ds_read_b64_tr_b16 v[144:145], v153 offset:45056
    v_mfma_f32_16x16x32_bf16 v[36:39], v[128:131], v[100:103], v[36:39]
    ds_read_b64_tr_b16 v[146:147], v153 offset:47104
    v_rcp_f32 v199, v199
    v_mfma_f32_16x16x32_bf16 v[60:63], v[128:131], v[104:107], v[60:63]
    ds_read_b128 v[116:119], v158 offset:44032
    v_mfma_f32_16x16x32_bf16 v[84:87], v[128:131], v[108:111], v[84:87]
    s_nop 0
    v_mul_f32 v207, v199, v207
    s_waitcnt lgkmcnt(8)
    v_mfma_f32_16x16x32_bf16 v[16:19], v[132:135], v[96:99], v[16:19]
    ds_read_b64_tr_b16 v[128:129], v154 offset:45056
    v_mfma_f32_16x16x32_bf16 v[40:43], v[132:135], v[100:103], v[40:43]
    ds_read_b64_tr_b16 v[130:131], v154 offset:47104
    v_cvt_pk_bf16_f32 v234, v200, v201
    v_mfma_f32_16x16x32_bf16 v[64:67], v[132:135], v[104:107], v[64:67]
    ds_read_b128 v[120:123], v158 offset:46080
    v_mfma_f32_16x16x32_bf16 v[88:91], v[132:135], v[108:111], v[88:91]
    v_cvt_pk_bf16_f32 v235, v202, v203
    v_cvt_pk_bf16_f32 v238, v204, v205
    s_waitcnt lgkmcnt(9)
    v_mfma_f32_16x16x32_bf16 v[20:23], v[136:139], v[96:99], v[20:23]
    ds_read_b64_tr_b16 v[132:133], v155 offset:45056
    v_mfma_f32_16x16x32_bf16 v[44:47], v[136:139], v[100:103], v[44:47]
    ds_read_b64_tr_b16 v[134:135], v155 offset:47104
    v_cvt_pk_bf16_f32 v239, v206, v207
    v_mfma_f32_16x16x32_bf16 v[68:71], v[136:139], v[104:107], v[68:71]
    ds_read_b128 v[124:127], v158 offset:48128
    v_mfma_f32_16x16x32_bf16 v[92:95], v[136:139], v[108:111], v[92:95]
    buffer_store_dwordx4 v[232:235], v245, s[24:27], s43 offen sc1
    s_add_u32 s48, s43, 148480
    s_waitcnt lgkmcnt(9)
    v_mfma_f32_16x16x32_bf16 v[0:3], v[140:143], v[112:115], v[0:3]
    ds_read_b64_tr_b16 v[136:137], v156 offset:45056
    s_waitcnt lgkmcnt(7)
    v_mfma_f32_16x16x32_bf16 v[24:27], v[140:143], v[116:119], v[24:27]
    ds_read_b64_tr_b16 v[138:139], v156 offset:47104
    buffer_store_dwordx4 v[236:239], v245, s[24:27], s48 offen sc1
    s_waitcnt lgkmcnt(5)
    v_mfma_f32_16x16x32_bf16 v[48:51], v[140:143], v[120:123], v[48:51]
    s_and_b32 s34, s12, 1
    s_lshr_b32 s35, s12, 1
    s_waitcnt lgkmcnt(2)
    v_mfma_f32_16x16x32_bf16 v[72:75], v[140:143], v[124:127], v[72:75]
    s_lshl_b32 s36, s32, 3
    s_lshl_b32 s37, s34, 2
    v_mfma_f32_16x16x32_bf16 v[4:7], v[144:147], v[112:115], v[4:7]
    ds_read_b64_tr_b16 v[140:141], v157 offset:45056
    v_mfma_f32_16x16x32_bf16 v[28:31], v[144:147], v[116:119], v[28:31]
    ds_read_b64_tr_b16 v[142:143], v157 offset:47104
    s_add_u32 s36, s36, s37
    v_mfma_f32_16x16x32_bf16 v[52:55], v[144:147], v[120:123], v[52:55]
    s_mul_i32 s36, s36, 18
    s_mul_i32 s37, s33, 6
    v_mfma_f32_16x16x32_bf16 v[76:79], v[144:147], v[124:127], v[76:79]
    s_add_u32 s36, s36, s37
    s_mul_i32 s37, s35, 3
    v_mfma_f32_16x16x32_bf16 v[8:11], v[128:131], v[112:115], v[8:11]
    s_waitcnt lgkmcnt(0)
    s_barrier
    v_mfma_f32_16x16x32_bf16 v[32:35], v[128:131], v[116:119], v[32:35]
    v_add_u32 v152, 0xa000, v152
    ds_read_b64_tr_b16 v[144:145], v152 offset:40960
    s_add_u32 s36, s36, s37
    v_mfma_f32_16x16x32_bf16 v[56:59], v[128:131], v[120:123], v[56:59]
    ds_read_b64_tr_b16 v[146:147], v152 offset:43008
    v_mfma_f32_16x16x32_bf16 v[80:83], v[128:131], v[124:127], v[80:83]
    v_add_u32 v158, 0xa000, v158
    ds_read_b128 v[96:99], v158 offset:40960
    s_lshl_b32 s36, s36, 10
    v_mfma_f32_16x16x32_bf16 v[12:15], v[132:135], v[112:115], v[12:15]
    v_add_u32 v153, 0xa000, v153
    ds_read_b64_tr_b16 v[128:129], v153 offset:40960
    v_mfma_f32_16x16x32_bf16 v[36:39], v[132:135], v[116:119], v[36:39]
    ds_read_b64_tr_b16 v[130:131], v153 offset:43008
    s_mul_i32 s37, s15, 2359296
    v_mfma_f32_16x16x32_bf16 v[60:63], v[132:135], v[120:123], v[60:63]
    ds_read_b128 v[100:103], v158 offset:43008
    v_mfma_f32_16x16x32_bf16 v[84:87], v[132:135], v[124:127], v[84:87]
    s_add_u32 s36, s36, s37
    s_add_u32 s36, s36, 0x1a00000
    v_mfma_f32_16x16x32_bf16 v[16:19], v[136:139], v[112:115], v[16:19]
    v_add_u32 v154, 0xa000, v154
    ds_read_b64_tr_b16 v[132:133], v154 offset:40960
    v_mfma_f32_16x16x32_bf16 v[40:43], v[136:139], v[116:119], v[40:43]
    ds_read_b64_tr_b16 v[134:135], v154 offset:43008
    s_mul_i32 s38, s32, 3
    v_mfma_f32_16x16x32_bf16 v[64:67], v[136:139], v[120:123], v[64:67]
    ds_read_b128 v[104:107], v158 offset:45056
    v_mfma_f32_16x16x32_bf16 v[88:91], v[136:139], v[124:127], v[88:91]
    s_add_u32 s38, s38, s33
    s_lshl_b32 s38, s38, 4
    v_mfma_f32_16x16x32_bf16 v[20:23], v[140:143], v[112:115], v[20:23]
    v_add_u32 v155, 0xa000, v155
    ds_read_b64_tr_b16 v[136:137], v155 offset:40960
    v_mfma_f32_16x16x32_bf16 v[44:47], v[140:143], v[116:119], v[44:47]
    ds_read_b64_tr_b16 v[138:139], v155 offset:43008
    s_add_u32 s38, s38, s12
    v_mfma_f32_16x16x32_bf16 v[68:71], v[140:143], v[120:123], v[68:71]
    ds_read_b128 v[108:111], v158 offset:47104
    v_mfma_f32_16x16x32_bf16 v[92:95], v[140:143], v[124:127], v[92:95]
    s_lshl_b32 s38, s38, 7
    s_add_u32 s38, s38, 0x2780000
    s_waitcnt lgkmcnt(9)
    v_mfma_f32_16x16x32_bf16 v[0:3], v[144:147], v[96:99], v[0:3]
    v_add_u32 v156, 0xa000, v156
    ds_read_b64_tr_b16 v[140:141], v156 offset:40960
    s_waitcnt lgkmcnt(7)
    v_mfma_f32_16x16x32_bf16 v[24:27], v[144:147], v[100:103], v[24:27]
    ds_read_b64_tr_b16 v[142:143], v156 offset:43008
    s_add_u32 s46, s15, 1
    s_waitcnt lgkmcnt(5)
    v_mfma_f32_16x16x32_bf16 v[48:51], v[144:147], v[104:107], v[48:51]
    s_and_b32 s46, s46, 3
    s_mul_i32 s40, s46, 18432
    s_waitcnt lgkmcnt(2)
    v_mfma_f32_16x16x32_bf16 v[72:75], v[144:147], v[108:111], v[72:75]
    s_add_u32 s40, s40, s36
    s_lshl_b32 s56, s46, 9
    v_mfma_f32_16x16x32_bf16 v[4:7], v[128:131], v[96:99], v[4:7]
    v_add_u32 v157, 0xa000, v157
    ds_read_b64_tr_b16 v[144:145], v157 offset:40960
    v_mfma_f32_16x16x32_bf16 v[28:31], v[128:131], v[100:103], v[28:31]
    ds_read_b64_tr_b16 v[146:147], v157 offset:43008
    s_add_u32 s56, s56, s38
    v_mfma_f32_16x16x32_bf16 v[52:55], v[128:131], v[104:107], v[52:55]
    s_add_u32 s46, s15, 2
    s_and_b32 s46, s46, 3
    v_mfma_f32_16x16x32_bf16 v[76:79], v[128:131], v[108:111], v[76:79]
    s_mul_i32 s41, s46, 18432
    s_add_u32 s41, s41, s36
    v_mfma_f32_16x16x32_bf16 v[8:11], v[132:135], v[96:99], v[8:11]
    ds_read_b64_tr_b16 v[128:129], v152 offset:45056
    v_mfma_f32_16x16x32_bf16 v[32:35], v[132:135], v[100:103], v[32:35]
    ds_read_b64_tr_b16 v[130:131], v152 offset:47104
    s_lshl_b32 s57, s46, 9
    v_mfma_f32_16x16x32_bf16 v[56:59], v[132:135], v[104:107], v[56:59]
    ds_read_b128 v[112:115], v158 offset:41984
    v_mfma_f32_16x16x32_bf16 v[80:83], v[132:135], v[108:111], v[80:83]
    s_add_u32 s57, s57, s38
    s_add_u32 s46, s15, 3
    v_mfma_f32_16x16x32_bf16 v[12:15], v[136:139], v[96:99], v[12:15]
    ds_read_b64_tr_b16 v[132:133], v153 offset:45056
    v_mfma_f32_16x16x32_bf16 v[36:39], v[136:139], v[100:103], v[36:39]
    ds_read_b64_tr_b16 v[134:135], v153 offset:47104
    s_and_b32 s46, s46, 3
    v_mfma_f32_16x16x32_bf16 v[60:63], v[136:139], v[104:107], v[60:63]
    ds_read_b128 v[116:119], v158 offset:44032
    v_mfma_f32_16x16x32_bf16 v[84:87], v[136:139], v[108:111], v[84:87]
    s_mul_i32 s42, s46, 18432
    s_add_u32 s42, s42, s36
    s_waitcnt lgkmcnt(8)
    v_mfma_f32_16x16x32_bf16 v[16:19], v[140:143], v[96:99], v[16:19]
    ds_read_b64_tr_b16 v[136:137], v154 offset:45056
    v_mfma_f32_16x16x32_bf16 v[40:43], v[140:143], v[100:103], v[40:43]
    ds_read_b64_tr_b16 v[138:139], v154 offset:47104
    s_lshl_b32 s58, s46, 9
    v_mfma_f32_16x16x32_bf16 v[64:67], v[140:143], v[104:107], v[64:67]
    ds_read_b128 v[120:123], v158 offset:46080
    v_mfma_f32_16x16x32_bf16 v[88:91], v[140:143], v[108:111], v[88:91]
    s_add_u32 s58, s58, s38
    s_lshl_b32 s19, s15, 7
    s_waitcnt lgkmcnt(9)
    v_mfma_f32_16x16x32_bf16 v[20:23], v[144:147], v[96:99], v[20:23]
    ds_read_b64_tr_b16 v[140:141], v155 offset:45056
    v_mfma_f32_16x16x32_bf16 v[44:47], v[144:147], v[100:103], v[44:47]
    ds_read_b64_tr_b16 v[142:143], v155 offset:47104
    s_sub_u32 s19, s101, s19
    v_mfma_f32_16x16x32_bf16 v[68:71], v[144:147], v[104:107], v[68:71]
    ds_read_b128 v[124:127], v158 offset:48128
    v_mfma_f32_16x16x32_bf16 v[92:95], v[144:147], v[108:111], v[92:95]
    s_cmp_eq_u32 s12, 0
    s_cselect_b32 s20, 1, 0
    s_lshl_b32 s21, s12, 7
    s_waitcnt lgkmcnt(9)
    v_mfma_f32_16x16x32_bf16 v[0:3], v[128:131], v[112:115], v[0:3]
    ds_read_b64_tr_b16 v[144:145], v156 offset:45056
    s_waitcnt lgkmcnt(7)
    v_mfma_f32_16x16x32_bf16 v[24:27], v[128:131], v[116:119], v[24:27]
    ds_read_b64_tr_b16 v[146:147], v156 offset:47104
    s_add_u32 s21, s21, 159744
    s_waitcnt lgkmcnt(5)
    v_mfma_f32_16x16x32_bf16 v[48:51], v[128:131], v[120:123], v[48:51]
    v_mov_b32 v165, s21
    v_mov_b32 v166, 159744
    s_waitcnt lgkmcnt(2)
    v_mfma_f32_16x16x32_bf16 v[72:75], v[128:131], v[124:127], v[72:75]
    v_lshlrev_b32 v167, 3, v245
    v_mfma_f32_16x16x32_bf16 v[4:7], v[132:135], v[112:115], v[4:7]
    ds_read_b64_tr_b16 v[128:129], v157 offset:45056
    v_mfma_f32_16x16x32_bf16 v[28:31], v[132:135], v[116:119], v[28:31]
    ds_read_b64_tr_b16 v[130:131], v157 offset:47104
    v_mfma_f32_16x16x32_bf16 v[52:55], v[132:135], v[120:123], v[52:55]
    v_mfma_f32_16x16x32_bf16 v[76:79], v[132:135], v[124:127], v[76:79]
    v_mfma_f32_16x16x32_bf16 v[8:11], v[136:139], v[112:115], v[8:11]
    s_waitcnt lgkmcnt(0)
    s_barrier
    v_mfma_f32_16x16x32_bf16 v[32:35], v[136:139], v[116:119], v[32:35]
    v_subrev_u32 v152, 0xa000, v152
    ds_read_b64_tr_b16 v[132:133], v152 offset:0
    v_mfma_f32_16x16x32_bf16 v[56:59], v[136:139], v[120:123], v[56:59]
    ds_read_b64_tr_b16 v[134:135], v152 offset:2048
    v_mfma_f32_16x16x32_bf16 v[80:83], v[136:139], v[124:127], v[80:83]
    v_subrev_u32 v158, 0xa000, v158
    ds_read_b128 v[96:99], v158 offset:0
    v_mfma_f32_16x16x32_bf16 v[12:15], v[140:143], v[112:115], v[12:15]
    v_subrev_u32 v153, 0xa000, v153
    ds_read_b64_tr_b16 v[136:137], v153 offset:0
    v_mfma_f32_16x16x32_bf16 v[36:39], v[140:143], v[116:119], v[36:39]
    ds_read_b64_tr_b16 v[138:139], v153 offset:2048
    v_mfma_f32_16x16x32_bf16 v[60:63], v[140:143], v[120:123], v[60:63]
    ds_read_b128 v[100:103], v158 offset:2048
    v_mfma_f32_16x16x32_bf16 v[84:87], v[140:143], v[124:127], v[84:87]
    v_mfma_f32_16x16x32_bf16 v[16:19], v[144:147], v[112:115], v[16:19]
    v_subrev_u32 v154, 0xa000, v154
    ds_read_b64_tr_b16 v[140:141], v154 offset:0
    v_mfma_f32_16x16x32_bf16 v[40:43], v[144:147], v[116:119], v[40:43]
    ds_read_b64_tr_b16 v[142:143], v154 offset:2048
    v_mfma_f32_16x16x32_bf16 v[64:67], v[144:147], v[120:123], v[64:67]
    ds_read_b128 v[104:107], v158 offset:4096
    v_mfma_f32_16x16x32_bf16 v[88:91], v[144:147], v[124:127], v[88:91]
    v_mfma_f32_16x16x32_bf16 v[20:23], v[128:131], v[112:115], v[20:23]
    v_subrev_u32 v155, 0xa000, v155
    ds_read_b64_tr_b16 v[144:145], v155 offset:0
    v_mfma_f32_16x16x32_bf16 v[44:47], v[128:131], v[116:119], v[44:47]
    ds_read_b64_tr_b16 v[146:147], v155 offset:2048
    v_mfma_f32_16x16x32_bf16 v[68:71], v[128:131], v[120:123], v[68:71]
    ds_read_b128 v[108:111], v158 offset:6144
    v_mfma_f32_16x16x32_bf16 v[92:95], v[128:131], v[124:127], v[92:95]
    s_waitcnt lgkmcnt(9)
    v_mfma_f32_16x16x32_bf16 v[0:3], v[132:135], v[96:99], v[0:3]
    v_subrev_u32 v156, 0xa000, v156
    ds_read_b64_tr_b16 v[128:129], v156 offset:0
    s_waitcnt lgkmcnt(7)
    v_mfma_f32_16x16x32_bf16 v[24:27], v[132:135], v[100:103], v[24:27]
    ds_read_b64_tr_b16 v[130:131], v156 offset:2048
    s_waitcnt lgkmcnt(5)
    v_mfma_f32_16x16x32_bf16 v[48:51], v[132:135], v[104:107], v[48:51]
    s_waitcnt lgkmcnt(2)
    v_mfma_f32_16x16x32_bf16 v[72:75], v[132:135], v[108:111], v[72:75]
    v_mfma_f32_16x16x32_bf16 v[4:7], v[136:139], v[96:99], v[4:7]
    v_subrev_u32 v157, 0xa000, v157
    ds_read_b64_tr_b16 v[132:133], v157 offset:0
    v_mfma_f32_16x16x32_bf16 v[28:31], v[136:139], v[100:103], v[28:31]
    ds_read_b64_tr_b16 v[134:135], v157 offset:2048
    v_mfma_f32_16x16x32_bf16 v[52:55], v[136:139], v[104:107], v[52:55]
    v_mfma_f32_16x16x32_bf16 v[76:79], v[136:139], v[108:111], v[76:79]
    v_mfma_f32_16x16x32_bf16 v[8:11], v[140:143], v[96:99], v[8:11]
    ds_read_b64_tr_b16 v[136:137], v152 offset:4096
    v_mfma_f32_16x16x32_bf16 v[32:35], v[140:143], v[100:103], v[32:35]
    ds_read_b64_tr_b16 v[138:139], v152 offset:6144
    v_mfma_f32_16x16x32_bf16 v[56:59], v[140:143], v[104:107], v[56:59]
    ds_read_b128 v[112:115], v158 offset:1024
    v_mfma_f32_16x16x32_bf16 v[80:83], v[140:143], v[108:111], v[80:83]
    v_mfma_f32_16x16x32_bf16 v[12:15], v[144:147], v[96:99], v[12:15]
    ds_read_b64_tr_b16 v[140:141], v153 offset:4096
    v_mfma_f32_16x16x32_bf16 v[36:39], v[144:147], v[100:103], v[36:39]
    ds_read_b64_tr_b16 v[142:143], v153 offset:6144
    v_mfma_f32_16x16x32_bf16 v[60:63], v[144:147], v[104:107], v[60:63]
    ds_read_b128 v[116:119], v158 offset:3072
    v_mfma_f32_16x16x32_bf16 v[84:87], v[144:147], v[108:111], v[84:87]
    v_mov_b32 v160, 0
    v_mov_b32 v161, 0
    s_mov_b64 exec, 1
    buffer_atomic_add v160, v161, s[24:27], s101 offen offset:4 sc0
    s_mov_b64 exec, -1
    s_waitcnt lgkmcnt(8)
    v_mfma_f32_16x16x32_bf16 v[16:19], v[128:131], v[96:99], v[16:19]
    ds_read_b64_tr_b16 v[144:145], v154 offset:4096
    v_mfma_f32_16x16x32_bf16 v[40:43], v[128:131], v[100:103], v[40:43]
    ds_read_b64_tr_b16 v[146:147], v154 offset:6144
    v_mfma_f32_16x16x32_bf16 v[64:67], v[128:131], v[104:107], v[64:67]
    ds_read_b128 v[120:123], v158 offset:5120
    v_mfma_f32_16x16x32_bf16 v[88:91], v[128:131], v[108:111], v[88:91]
    s_waitcnt lgkmcnt(9)
    v_mfma_f32_16x16x32_bf16 v[20:23], v[132:135], v[96:99], v[20:23]
    ds_read_b64_tr_b16 v[128:129], v155 offset:4096
    v_mfma_f32_16x16x32_bf16 v[44:47], v[132:135], v[100:103], v[44:47]
    ds_read_b64_tr_b16 v[130:131], v155 offset:6144
    v_mfma_f32_16x16x32_bf16 v[68:71], v[132:135], v[104:107], v[68:71]
    ds_read_b128 v[124:127], v158 offset:7168
    v_mfma_f32_16x16x32_bf16 v[92:95], v[132:135], v[108:111], v[92:95]
    s_waitcnt lgkmcnt(9)
    v_mfma_f32_16x16x32_bf16 v[0:3], v[136:139], v[112:115], v[0:3]
    ds_read_b64_tr_b16 v[132:133], v156 offset:4096
    s_waitcnt lgkmcnt(7)
    v_mfma_f32_16x16x32_bf16 v[24:27], v[136:139], v[116:119], v[24:27]
    ds_read_b64_tr_b16 v[134:135], v156 offset:6144
    s_waitcnt lgkmcnt(5)
    v_mfma_f32_16x16x32_bf16 v[48:51], v[136:139], v[120:123], v[48:51]
    s_waitcnt lgkmcnt(2)
    v_mfma_f32_16x16x32_bf16 v[72:75], v[136:139], v[124:127], v[72:75]
    v_mfma_f32_16x16x32_bf16 v[4:7], v[140:143], v[112:115], v[4:7]
    ds_read_b64_tr_b16 v[136:137], v157 offset:4096
    v_mfma_f32_16x16x32_bf16 v[28:31], v[140:143], v[116:119], v[28:31]
    ds_read_b64_tr_b16 v[138:139], v157 offset:6144
    v_mfma_f32_16x16x32_bf16 v[52:55], v[140:143], v[120:123], v[52:55]
    v_mfma_f32_16x16x32_bf16 v[76:79], v[140:143], v[124:127], v[76:79]
    v_mfma_f32_16x16x32_bf16 v[8:11], v[144:147], v[112:115], v[8:11]
    s_waitcnt lgkmcnt(0)
    s_barrier
    v_mfma_f32_16x16x32_bf16 v[32:35], v[144:147], v[116:119], v[32:35]
    ds_read_b64_tr_b16 v[140:141], v152 offset:40960
    v_mfma_f32_16x16x32_bf16 v[56:59], v[144:147], v[120:123], v[56:59]
    ds_read_b64_tr_b16 v[142:143], v152 offset:43008
    v_mfma_f32_16x16x32_bf16 v[80:83], v[144:147], v[124:127], v[80:83]
    ds_read_b128 v[96:99], v158 offset:40960
    v_mfma_f32_16x16x32_bf16 v[12:15], v[128:131], v[112:115], v[12:15]
    ds_read_b64_tr_b16 v[144:145], v153 offset:40960
    v_mfma_f32_16x16x32_bf16 v[36:39], v[128:131], v[116:119], v[36:39]
    ds_read_b64_tr_b16 v[146:147], v153 offset:43008
    v_mfma_f32_16x16x32_bf16 v[60:63], v[128:131], v[120:123], v[60:63]
    ds_read_b128 v[100:103], v158 offset:43008
    v_mfma_f32_16x16x32_bf16 v[84:87], v[128:131], v[124:127], v[84:87]
    v_lshlrev_b32 v252, 5, v245
    v_mov_b32 v253, 1
    s_waitcnt vmcnt(1)
    s_mov_b64 exec, 63
    buffer_atomic_add v253, v252, s[24:27], s39 offen offset:8
    s_mov_b64 exec, -1
    v_mfma_f32_16x16x32_bf16 v[16:19], v[132:135], v[112:115], v[16:19]
    ds_read_b64_tr_b16 v[128:129], v154 offset:40960
    v_mfma_f32_16x16x32_bf16 v[40:43], v[132:135], v[116:119], v[40:43]
    ds_read_b64_tr_b16 v[130:131], v154 offset:43008
    v_mfma_f32_16x16x32_bf16 v[64:67], v[132:135], v[120:123], v[64:67]
    ds_read_b128 v[104:107], v158 offset:45056
    v_mfma_f32_16x16x32_bf16 v[88:91], v[132:135], v[124:127], v[88:91]
    v_mfma_f32_16x16x32_bf16 v[20:23], v[136:139], v[112:115], v[20:23]
    ds_read_b64_tr_b16 v[132:133], v155 offset:40960
    v_mfma_f32_16x16x32_bf16 v[44:47], v[136:139], v[116:119], v[44:47]
    ds_read_b64_tr_b16 v[134:135], v155 offset:43008
    v_mfma_f32_16x16x32_bf16 v[68:71], v[136:139], v[120:123], v[68:71]
    ds_read_b128 v[108:111], v158 offset:47104
    v_mfma_f32_16x16x32_bf16 v[92:95], v[136:139], v[124:127], v[92:95]
    s_waitcnt lgkmcnt(9)
    v_mfma_f32_16x16x32_bf16 v[0:3], v[140:143], v[96:99], v[0:3]
    ds_read_b64_tr_b16 v[136:137], v156 offset:40960
    s_waitcnt lgkmcnt(7)
    v_mfma_f32_16x16x32_bf16 v[24:27], v[140:143], v[100:103], v[24:27]
    ds_read_b64_tr_b16 v[138:139], v156 offset:43008
    s_waitcnt lgkmcnt(5)
    v_mfma_f32_16x16x32_bf16 v[48:51], v[140:143], v[104:107], v[48:51]
    s_waitcnt lgkmcnt(2)
    v_mfma_f32_16x16x32_bf16 v[72:75], v[140:143], v[108:111], v[72:75]
    v_mfma_f32_16x16x32_bf16 v[4:7], v[144:147], v[96:99], v[4:7]
    ds_read_b64_tr_b16 v[140:141], v157 offset:40960
    v_mfma_f32_16x16x32_bf16 v[28:31], v[144:147], v[100:103], v[28:31]
    ds_read_b64_tr_b16 v[142:143], v157 offset:43008
    v_mfma_f32_16x16x32_bf16 v[52:55], v[144:147], v[104:107], v[52:55]
    v_mfma_f32_16x16x32_bf16 v[76:79], v[144:147], v[108:111], v[76:79]
    v_mfma_f32_16x16x32_bf16 v[8:11], v[128:131], v[96:99], v[8:11]
    ds_read_b64_tr_b16 v[144:145], v152 offset:45056
    v_mfma_f32_16x16x32_bf16 v[32:35], v[128:131], v[100:103], v[32:35]
    ds_read_b64_tr_b16 v[146:147], v152 offset:47104
    v_mfma_f32_16x16x32_bf16 v[56:59], v[128:131], v[104:107], v[56:59]
    ds_read_b128 v[112:115], v158 offset:41984
    v_mfma_f32_16x16x32_bf16 v[80:83], v[128:131], v[108:111], v[80:83]
    v_mfma_f32_16x16x32_bf16 v[12:15], v[132:135], v[96:99], v[12:15]
    ds_read_b64_tr_b16 v[128:129], v153 offset:45056
    v_mfma_f32_16x16x32_bf16 v[36:39], v[132:135], v[100:103], v[36:39]
    ds_read_b64_tr_b16 v[130:131], v153 offset:47104
    v_mfma_f32_16x16x32_bf16 v[60:63], v[132:135], v[104:107], v[60:63]
    ds_read_b128 v[116:119], v158 offset:44032
    v_mfma_f32_16x16x32_bf16 v[84:87], v[132:135], v[108:111], v[84:87]
    s_waitcnt lgkmcnt(8)
    v_mfma_f32_16x16x32_bf16 v[16:19], v[136:139], v[96:99], v[16:19]
    ds_read_b64_tr_b16 v[132:133], v154 offset:45056
    v_mfma_f32_16x16x32_bf16 v[40:43], v[136:139], v[100:103], v[40:43]
    ds_read_b64_tr_b16 v[134:135], v154 offset:47104
    v_mfma_f32_16x16x32_bf16 v[64:67], v[136:139], v[104:107], v[64:67]
    ds_read_b128 v[120:123], v158 offset:46080
    v_mfma_f32_16x16x32_bf16 v[88:91], v[136:139], v[108:111], v[88:91]
    s_waitcnt lgkmcnt(9)
    v_mfma_f32_16x16x32_bf16 v[20:23], v[140:143], v[96:99], v[20:23]
    ds_read_b64_tr_b16 v[136:137], v155 offset:45056
    v_mfma_f32_16x16x32_bf16 v[44:47], v[140:143], v[100:103], v[44:47]
    ds_read_b64_tr_b16 v[138:139], v155 offset:47104
    v_mfma_f32_16x16x32_bf16 v[68:71], v[140:143], v[104:107], v[68:71]
    ds_read_b128 v[124:127], v158 offset:48128
    v_mfma_f32_16x16x32_bf16 v[92:95], v[140:143], v[108:111], v[92:95]
    s_waitcnt lgkmcnt(9)
    v_mfma_f32_16x16x32_bf16 v[0:3], v[144:147], v[112:115], v[0:3]
    ds_read_b64_tr_b16 v[140:141], v156 offset:45056
    s_waitcnt lgkmcnt(7)
    v_mfma_f32_16x16x32_bf16 v[24:27], v[144:147], v[116:119], v[24:27]
    ds_read_b64_tr_b16 v[142:143], v156 offset:47104
    s_waitcnt lgkmcnt(5)
    v_mfma_f32_16x16x32_bf16 v[48:51], v[144:147], v[120:123], v[48:51]
    s_waitcnt lgkmcnt(2)
    v_mfma_f32_16x16x32_bf16 v[72:75], v[144:147], v[124:127], v[72:75]
    v_mfma_f32_16x16x32_bf16 v[4:7], v[128:131], v[112:115], v[4:7]
    ds_read_b64_tr_b16 v[144:145], v157 offset:45056
    v_mfma_f32_16x16x32_bf16 v[28:31], v[128:131], v[116:119], v[28:31]
    ds_read_b64_tr_b16 v[146:147], v157 offset:47104
    v_mfma_f32_16x16x32_bf16 v[52:55], v[128:131], v[120:123], v[52:55]
    v_mfma_f32_16x16x32_bf16 v[76:79], v[128:131], v[124:127], v[76:79]
    v_mfma_f32_16x16x32_bf16 v[8:11], v[132:135], v[112:115], v[8:11]
    s_waitcnt lgkmcnt(0)
    s_barrier
    v_mfma_f32_16x16x32_bf16 v[32:35], v[132:135], v[116:119], v[32:35]
    v_add_u32 v152, 0xa000, v152
    ds_read_b64_tr_b16 v[128:129], v152 offset:40960
    v_mfma_f32_16x16x32_bf16 v[56:59], v[132:135], v[120:123], v[56:59]
    ds_read_b64_tr_b16 v[130:131], v152 offset:43008
    v_mfma_f32_16x16x32_bf16 v[80:83], v[132:135], v[124:127], v[80:83]
    v_add_u32 v158, 0xa000, v158
    ds_read_b128 v[96:99], v158 offset:40960
    v_mfma_f32_16x16x32_bf16 v[12:15], v[136:139], v[112:115], v[12:15]
    v_add_u32 v153, 0xa000, v153
    ds_read_b64_tr_b16 v[132:133], v153 offset:40960
    v_mfma_f32_16x16x32_bf16 v[36:39], v[136:139], v[116:119], v[36:39]
    ds_read_b64_tr_b16 v[134:135], v153 offset:43008
    v_mfma_f32_16x16x32_bf16 v[60:63], v[136:139], v[120:123], v[60:63]
    ds_read_b128 v[100:103], v158 offset:43008
    v_mfma_f32_16x16x32_bf16 v[84:87], v[136:139], v[124:127], v[84:87]
    v_mfma_f32_16x16x32_bf16 v[16:19], v[140:143], v[112:115], v[16:19]
    v_add_u32 v154, 0xa000, v154
    ds_read_b64_tr_b16 v[136:137], v154 offset:40960
    v_mfma_f32_16x16x32_bf16 v[40:43], v[140:143], v[116:119], v[40:43]
    ds_read_b64_tr_b16 v[138:139], v154 offset:43008
    v_mfma_f32_16x16x32_bf16 v[64:67], v[140:143], v[120:123], v[64:67]
    ds_read_b128 v[104:107], v158 offset:45056
    v_mfma_f32_16x16x32_bf16 v[88:91], v[140:143], v[124:127], v[88:91]
    v_mfma_f32_16x16x32_bf16 v[20:23], v[144:147], v[112:115], v[20:23]
    v_add_u32 v155, 0xa000, v155
    ds_read_b64_tr_b16 v[140:141], v155 offset:40960
    v_mfma_f32_16x16x32_bf16 v[44:47], v[144:147], v[116:119], v[44:47]
    ds_read_b64_tr_b16 v[142:143], v155 offset:43008
    v_mfma_f32_16x16x32_bf16 v[68:71], v[144:147], v[120:123], v[68:71]
    ds_read_b128 v[108:111], v158 offset:47104
    v_mfma_f32_16x16x32_bf16 v[92:95], v[144:147], v[124:127], v[92:95]
    s_waitcnt lgkmcnt(9)
    v_mfma_f32_16x16x32_bf16 v[0:3], v[128:131], v[96:99], v[0:3]
    v_add_u32 v156, 0xa000, v156
    ds_read_b64_tr_b16 v[144:145], v156 offset:40960
    s_waitcnt lgkmcnt(7)
    v_mfma_f32_16x16x32_bf16 v[24:27], v[128:131], v[100:103], v[24:27]
    ds_read_b64_tr_b16 v[146:147], v156 offset:43008
    s_waitcnt lgkmcnt(5)
    v_mfma_f32_16x16x32_bf16 v[48:51], v[128:131], v[104:107], v[48:51]
    s_waitcnt lgkmcnt(2)
    v_mfma_f32_16x16x32_bf16 v[72:75], v[128:131], v[108:111], v[72:75]
    v_mfma_f32_16x16x32_bf16 v[4:7], v[132:135], v[96:99], v[4:7]
    v_add_u32 v157, 0xa000, v157
    ds_read_b64_tr_b16 v[128:129], v157 offset:40960
    v_mfma_f32_16x16x32_bf16 v[28:31], v[132:135], v[100:103], v[28:31]
    ds_read_b64_tr_b16 v[130:131], v157 offset:43008
    v_mfma_f32_16x16x32_bf16 v[52:55], v[132:135], v[104:107], v[52:55]
    v_mfma_f32_16x16x32_bf16 v[76:79], v[132:135], v[108:111], v[76:79]
    v_mfma_f32_16x16x32_bf16 v[8:11], v[136:139], v[96:99], v[8:11]
    ds_read_b64_tr_b16 v[132:133], v152 offset:45056
    v_mfma_f32_16x16x32_bf16 v[32:35], v[136:139], v[100:103], v[32:35]
    ds_read_b64_tr_b16 v[134:135], v152 offset:47104
    v_mfma_f32_16x16x32_bf16 v[56:59], v[136:139], v[104:107], v[56:59]
    ds_read_b128 v[112:115], v158 offset:41984
    v_mfma_f32_16x16x32_bf16 v[80:83], v[136:139], v[108:111], v[80:83]
    v_mfma_f32_16x16x32_bf16 v[12:15], v[140:143], v[96:99], v[12:15]
    ds_read_b64_tr_b16 v[136:137], v153 offset:45056
    v_mfma_f32_16x16x32_bf16 v[36:39], v[140:143], v[100:103], v[36:39]
    ds_read_b64_tr_b16 v[138:139], v153 offset:47104
    v_mfma_f32_16x16x32_bf16 v[60:63], v[140:143], v[104:107], v[60:63]
    ds_read_b128 v[116:119], v158 offset:44032
    v_mfma_f32_16x16x32_bf16 v[84:87], v[140:143], v[108:111], v[84:87]
    s_waitcnt lgkmcnt(8)
    v_mfma_f32_16x16x32_bf16 v[16:19], v[144:147], v[96:99], v[16:19]
    ds_read_b64_tr_b16 v[140:141], v154 offset:45056
    v_mfma_f32_16x16x32_bf16 v[40:43], v[144:147], v[100:103], v[40:43]
    ds_read_b64_tr_b16 v[142:143], v154 offset:47104
    v_mfma_f32_16x16x32_bf16 v[64:67], v[144:147], v[104:107], v[64:67]
    ds_read_b128 v[120:123], v158 offset:46080
    v_mfma_f32_16x16x32_bf16 v[88:91], v[144:147], v[108:111], v[88:91]
    s_waitcnt lgkmcnt(9)
    v_mfma_f32_16x16x32_bf16 v[20:23], v[128:131], v[96:99], v[20:23]
    ds_read_b64_tr_b16 v[144:145], v155 offset:45056
    v_mfma_f32_16x16x32_bf16 v[44:47], v[128:131], v[100:103], v[44:47]
    ds_read_b64_tr_b16 v[146:147], v155 offset:47104
    v_mfma_f32_16x16x32_bf16 v[68:71], v[128:131], v[104:107], v[68:71]
    ds_read_b128 v[124:127], v158 offset:48128
    v_mfma_f32_16x16x32_bf16 v[92:95], v[128:131], v[108:111], v[92:95]
    s_waitcnt lgkmcnt(9)
    v_mfma_f32_16x16x32_bf16 v[0:3], v[132:135], v[112:115], v[0:3]
    ds_read_b64_tr_b16 v[128:129], v156 offset:45056
    s_waitcnt lgkmcnt(7)
    v_mfma_f32_16x16x32_bf16 v[24:27], v[132:135], v[116:119], v[24:27]
    ds_read_b64_tr_b16 v[130:131], v156 offset:47104
    s_waitcnt lgkmcnt(5)
    v_mfma_f32_16x16x32_bf16 v[48:51], v[132:135], v[120:123], v[48:51]
    s_waitcnt lgkmcnt(2)
    v_mfma_f32_16x16x32_bf16 v[72:75], v[132:135], v[124:127], v[72:75]
    s_waitcnt vmcnt(1)
    v_readfirstlane_b32 s45, v160
    s_nop 1
    s_cmp_lt_u32 s45, s49
    s_cbranch_scc1 KM_P1_S
KM_P1_X:
    v_mfma_f32_16x16x32_bf16 v[4:7], v[136:139], v[112:115], v[4:7]
    ds_read_b64_tr_b16 v[132:133], v157 offset:45056
    v_mfma_f32_16x16x32_bf16 v[28:31], v[136:139], v[116:119], v[28:31]
    ds_read_b64_tr_b16 v[134:135], v157 offset:47104
    v_mfma_f32_16x16x32_bf16 v[52:55], v[136:139], v[120:123], v[52:55]
    v_mfma_f32_16x16x32_bf16 v[76:79], v[136:139], v[124:127], v[76:79]
    v_mfma_f32_16x16x32_bf16 v[8:11], v[140:143], v[112:115], v[8:11]
    s_waitcnt lgkmcnt(0)
    s_barrier
    v_mfma_f32_16x16x32_bf16 v[32:35], v[140:143], v[116:119], v[32:35]
    v_subrev_u32 v152, 0xa000, v152
    ds_read_b64_tr_b16 v[136:137], v152 offset:0
    v_mfma_f32_16x16x32_bf16 v[56:59], v[140:143], v[120:123], v[56:59]
    ds_read_b64_tr_b16 v[138:139], v152 offset:2048
    v_mfma_f32_16x16x32_bf16 v[80:83], v[140:143], v[124:127], v[80:83]
    v_subrev_u32 v158, 0xa000, v158
    ds_read_b128 v[96:99], v158 offset:0
    v_mfma_f32_16x16x32_bf16 v[12:15], v[144:147], v[112:115], v[12:15]
    v_subrev_u32 v153, 0xa000, v153
    ds_read_b64_tr_b16 v[140:141], v153 offset:0
    v_mfma_f32_16x16x32_bf16 v[36:39], v[144:147], v[116:119], v[36:39]
    ds_read_b64_tr_b16 v[142:143], v153 offset:2048
    v_mfma_f32_16x16x32_bf16 v[60:63], v[144:147], v[120:123], v[60:63]
    ds_read_b128 v[100:103], v158 offset:2048
    v_mfma_f32_16x16x32_bf16 v[84:87], v[144:147], v[124:127], v[84:87]
    v_mfma_f32_16x16x32_bf16 v[16:19], v[128:131], v[112:115], v[16:19]
    v_subrev_u32 v154, 0xa000, v154
    ds_read_b64_tr_b16 v[144:145], v154 offset:0
    v_mfma_f32_16x16x32_bf16 v[40:43], v[128:131], v[116:119], v[40:43]
    ds_read_b64_tr_b16 v[146:147], v154 offset:2048
    v_mfma_f32_16x16x32_bf16 v[64:67], v[128:131], v[120:123], v[64:67]
    ds_read_b128 v[104:107], v158 offset:4096
    v_mfma_f32_16x16x32_bf16 v[88:91], v[128:131], v[124:127], v[88:91]
    v_mfma_f32_16x16x32_bf16 v[20:23], v[132:135], v[112:115], v[20:23]
    v_subrev_u32 v155, 0xa000, v155
    ds_read_b64_tr_b16 v[128:129], v155 offset:0
    v_mfma_f32_16x16x32_bf16 v[44:47], v[132:135], v[116:119], v[44:47]
    ds_read_b64_tr_b16 v[130:131], v155 offset:2048
    v_mfma_f32_16x16x32_bf16 v[68:71], v[132:135], v[120:123], v[68:71]
    ds_read_b128 v[108:111], v158 offset:6144
    v_mfma_f32_16x16x32_bf16 v[92:95], v[132:135], v[124:127], v[92:95]
    s_waitcnt lgkmcnt(9)
    v_mfma_f32_16x16x32_bf16 v[0:3], v[136:139], v[96:99], v[0:3]
    v_subrev_u32 v156, 0xa000, v156
    ds_read_b64_tr_b16 v[132:133], v156 offset:0
    s_waitcnt lgkmcnt(7)
    v_mfma_f32_16x16x32_bf16 v[24:27], v[136:139], v[100:103], v[24:27]
    ds_read_b64_tr_b16 v[134:135], v156 offset:2048
    s_waitcnt lgkmcnt(5)
    v_mfma_f32_16x16x32_bf16 v[48:51], v[136:139], v[104:107], v[48:51]
    s_waitcnt lgkmcnt(2)
    v_mfma_f32_16x16x32_bf16 v[72:75], v[136:139], v[108:111], v[72:75]
    v_mfma_f32_16x16x32_bf16 v[4:7], v[140:143], v[96:99], v[4:7]
    v_subrev_u32 v157, 0xa000, v157
    ds_read_b64_tr_b16 v[136:137], v157 offset:0
    v_mfma_f32_16x16x32_bf16 v[28:31], v[140:143], v[100:103], v[28:31]
    ds_read_b64_tr_b16 v[138:139], v157 offset:2048
    v_mfma_f32_16x16x32_bf16 v[52:55], v[140:143], v[104:107], v[52:55]
    v_mfma_f32_16x16x32_bf16 v[76:79], v[140:143], v[108:111], v[76:79]
    v_mfma_f32_16x16x32_bf16 v[8:11], v[144:147], v[96:99], v[8:11]
    ds_read_b64_tr_b16 v[140:141], v152 offset:4096
    v_mfma_f32_16x16x32_bf16 v[32:35], v[144:147], v[100:103], v[32:35]
    ds_read_b64_tr_b16 v[142:143], v152 offset:6144
    v_mfma_f32_16x16x32_bf16 v[56:59], v[144:147], v[104:107], v[56:59]
    ds_read_b128 v[112:115], v158 offset:1024
    v_mfma_f32_16x16x32_bf16 v[80:83], v[144:147], v[108:111], v[80:83]
    v_mfma_f32_16x16x32_bf16 v[12:15], v[128:131], v[96:99], v[12:15]
    ds_read_b64_tr_b16 v[144:145], v153 offset:4096
    v_mfma_f32_16x16x32_bf16 v[36:39], v[128:131], v[100:103], v[36:39]
    ds_read_b64_tr_b16 v[146:147], v153 offset:6144
    v_mfma_f32_16x16x32_bf16 v[60:63], v[128:131], v[104:107], v[60:63]
    ds_read_b128 v[116:119], v158 offset:3072
    v_mfma_f32_16x16x32_bf16 v[84:87], v[128:131], v[108:111], v[84:87]
    s_waitcnt lgkmcnt(8)
    v_mfma_f32_16x16x32_bf16 v[16:19], v[132:135], v[96:99], v[16:19]
    ds_read_b64_tr_b16 v[128:129], v154 offset:4096
    v_mfma_f32_16x16x32_bf16 v[40:43], v[132:135], v[100:103], v[40:43]
    ds_read_b64_tr_b16 v[130:131], v154 offset:6144
    v_mfma_f32_16x16x32_bf16 v[64:67], v[132:135], v[104:107], v[64:67]
    ds_read_b128 v[120:123], v158 offset:5120
    v_mfma_f32_16x16x32_bf16 v[88:91], v[132:135], v[108:111], v[88:91]
    s_waitcnt lgkmcnt(9)
    v_mfma_f32_16x16x32_bf16 v[20:23], v[136:139], v[96:99], v[20:23]
    ds_read_b64_tr_b16 v[132:133], v155 offset:4096
    v_mfma_f32_16x16x32_bf16 v[44:47], v[136:139], v[100:103], v[44:47]
    ds_read_b64_tr_b16 v[134:135], v155 offset:6144
    v_mfma_f32_16x16x32_bf16 v[68:71], v[136:139], v[104:107], v[68:71]
    ds_read_b128 v[124:127], v158 offset:7168
    v_mfma_f32_16x16x32_bf16 v[92:95], v[136:139], v[108:111], v[92:95]
    v_mov_b32 v160, 0
    v_mov_b32 v161, 0
    s_mov_b64 exec, 1
    buffer_atomic_add v160, v161, s[24:27], s101 offen offset:8 sc0
    s_mov_b64 exec, -1
    s_waitcnt lgkmcnt(9)
    v_mfma_f32_16x16x32_bf16 v[0:3], v[140:143], v[112:115], v[0:3]
    ds_read_b64_tr_b16 v[136:137], v156 offset:4096
    s_waitcnt lgkmcnt(7)
    v_mfma_f32_16x16x32_bf16 v[24:27], v[140:143], v[116:119], v[24:27]
    ds_read_b64_tr_b16 v[138:139], v156 offset:6144
    s_waitcnt lgkmcnt(5)
    v_mfma_f32_16x16x32_bf16 v[48:51], v[140:143], v[120:123], v[48:51]
    s_waitcnt lgkmcnt(2)
    v_mfma_f32_16x16x32_bf16 v[72:75], v[140:143], v[124:127], v[72:75]
    v_mfma_f32_16x16x32_bf16 v[4:7], v[144:147], v[112:115], v[4:7]
    ds_read_b64_tr_b16 v[140:141], v157 offset:4096
    v_mfma_f32_16x16x32_bf16 v[28:31], v[144:147], v[116:119], v[28:31]
    ds_read_b64_tr_b16 v[142:143], v157 offset:6144
    v_mfma_f32_16x16x32_bf16 v[52:55], v[144:147], v[120:123], v[52:55]
    v_mfma_f32_16x16x32_bf16 v[76:79], v[144:147], v[124:127], v[76:79]
    v_mfma_f32_16x16x32_bf16 v[8:11], v[128:131], v[112:115], v[8:11]
    s_waitcnt lgkmcnt(0)
    s_barrier
    v_mfma_f32_16x16x32_bf16 v[32:35], v[128:131], v[116:119], v[32:35]
    ds_read_b64_tr_b16 v[144:145], v152 offset:40960
    v_mfma_f32_16x16x32_bf16 v[56:59], v[128:131], v[120:123], v[56:59]
    ds_read_b64_tr_b16 v[146:147], v152 offset:43008
    v_mfma_f32_16x16x32_bf16 v[80:83], v[128:131], v[124:127], v[80:83]
    ds_read_b128 v[96:99], v158 offset:40960
    v_mfma_f32_16x16x32_bf16 v[12:15], v[132:135], v[112:115], v[12:15]
    ds_read_b64_tr_b16 v[128:129], v153 offset:40960
    v_mfma_f32_16x16x32_bf16 v[36:39], v[132:135], v[116:119], v[36:39]
    ds_read_b64_tr_b16 v[130:131], v153 offset:43008
    v_mfma_f32_16x16x32_bf16 v[60:63], v[132:135], v[120:123], v[60:63]
    ds_read_b128 v[100:103], v158 offset:43008
    v_mfma_f32_16x16x32_bf16 v[84:87], v[132:135], v[124:127], v[84:87]
    v_mfma_f32_16x16x32_bf16 v[16:19], v[136:139], v[112:115], v[16:19]
    ds_read_b64_tr_b16 v[132:133], v154 offset:40960
    v_mfma_f32_16x16x32_bf16 v[40:43], v[136:139], v[116:119], v[40:43]
    ds_read_b64_tr_b16 v[134:135], v154 offset:43008
    v_mfma_f32_16x16x32_bf16 v[64:67], v[136:139], v[120:123], v[64:67]
    ds_read_b128 v[104:107], v158 offset:45056
    v_mfma_f32_16x16x32_bf16 v[88:91], v[136:139], v[124:127], v[88:91]
    v_mfma_f32_16x16x32_bf16 v[20:23], v[140:143], v[112:115], v[20:23]
    ds_read_b64_tr_b16 v[136:137], v155 offset:40960
    v_mfma_f32_16x16x32_bf16 v[44:47], v[140:143], v[116:119], v[44:47]
    ds_read_b64_tr_b16 v[138:139], v155 offset:43008
    v_mfma_f32_16x16x32_bf16 v[68:71], v[140:143], v[120:123], v[68:71]
    ds_read_b128 v[108:111], v158 offset:47104
    v_mfma_f32_16x16x32_bf16 v[92:95], v[140:143], v[124:127], v[92:95]
    s_waitcnt lgkmcnt(9)
    v_mfma_f32_16x16x32_bf16 v[0:3], v[144:147], v[96:99], v[0:3]
    ds_read_b64_tr_b16 v[140:141], v156 offset:40960
    s_waitcnt lgkmcnt(7)
    v_mfma_f32_16x16x32_bf16 v[24:27], v[144:147], v[100:103], v[24:27]
    ds_read_b64_tr_b16 v[142:143], v156 offset:43008
    s_waitcnt lgkmcnt(5)
    v_mfma_f32_16x16x32_bf16 v[48:51], v[144:147], v[104:107], v[48:51]
    s_waitcnt lgkmcnt(2)
    v_mfma_f32_16x16x32_bf16 v[72:75], v[144:147], v[108:111], v[72:75]
    v_mfma_f32_16x16x32_bf16 v[4:7], v[128:131], v[96:99], v[4:7]
    ds_read_b64_tr_b16 v[144:145], v157 offset:40960
    v_mfma_f32_16x16x32_bf16 v[28:31], v[128:131], v[100:103], v[28:31]
    ds_read_b64_tr_b16 v[146:147], v157 offset:43008
    v_mfma_f32_16x16x32_bf16 v[52:55], v[128:131], v[104:107], v[52:55]
    v_mfma_f32_16x16x32_bf16 v[76:79], v[128:131], v[108:111], v[76:79]
    v_mfma_f32_16x16x32_bf16 v[8:11], v[132:135], v[96:99], v[8:11]
    ds_read_b64_tr_b16 v[128:129], v152 offset:45056
    v_mfma_f32_16x16x32_bf16 v[32:35], v[132:135], v[100:103], v[32:35]
    ds_read_b64_tr_b16 v[130:131], v152 offset:47104
    v_mfma_f32_16x16x32_bf16 v[56:59], v[132:135], v[104:107], v[56:59]
    ds_read_b128 v[112:115], v158 offset:41984
    v_mfma_f32_16x16x32_bf16 v[80:83], v[132:135], v[108:111], v[80:83]
    v_mfma_f32_16x16x32_bf16 v[12:15], v[136:139], v[96:99], v[12:15]
    ds_read_b64_tr_b16 v[132:133], v153 offset:45056
    v_mfma_f32_16x16x32_bf16 v[36:39], v[136:139], v[100:103], v[36:39]
    ds_read_b64_tr_b16 v[134:135], v153 offset:47104
    v_mfma_f32_16x16x32_bf16 v[60:63], v[136:139], v[104:107], v[60:63]
    ds_read_b128 v[116:119], v158 offset:44032
    v_mfma_f32_16x16x32_bf16 v[84:87], v[136:139], v[108:111], v[84:87]
    s_waitcnt lgkmcnt(8)
    v_mfma_f32_16x16x32_bf16 v[16:19], v[140:143], v[96:99], v[16:19]
    ds_read_b64_tr_b16 v[136:137], v154 offset:45056
    v_mfma_f32_16x16x32_bf16 v[40:43], v[140:143], v[100:103], v[40:43]
    ds_read_b64_tr_b16 v[138:139], v154 offset:47104
    v_mfma_f32_16x16x32_bf16 v[64:67], v[140:143], v[104:107], v[64:67]
    ds_read_b128 v[120:123], v158 offset:46080
    v_mfma_f32_16x16x32_bf16 v[88:91], v[140:143], v[108:111], v[88:91]
    s_waitcnt lgkmcnt(9)
    v_mfma_f32_16x16x32_bf16 v[20:23], v[144:147], v[96:99], v[20:23]
    ds_read_b64_tr_b16 v[140:141], v155 offset:45056
    v_mfma_f32_16x16x32_bf16 v[44:47], v[144:147], v[100:103], v[44:47]
    ds_read_b64_tr_b16 v[142:143], v155 offset:47104
    v_mfma_f32_16x16x32_bf16 v[68:71], v[144:147], v[104:107], v[68:71]
    ds_read_b128 v[124:127], v158 offset:48128
    v_mfma_f32_16x16x32_bf16 v[92:95], v[144:147], v[108:111], v[92:95]
    s_waitcnt lgkmcnt(9)
    v_mfma_f32_16x16x32_bf16 v[0:3], v[128:131], v[112:115], v[0:3]
    ds_read_b64_tr_b16 v[144:145], v156 offset:45056
    s_waitcnt lgkmcnt(7)
    v_mfma_f32_16x16x32_bf16 v[24:27], v[128:131], v[116:119], v[24:27]
    ds_read_b64_tr_b16 v[146:147], v156 offset:47104
    s_waitcnt lgkmcnt(5)
    v_mfma_f32_16x16x32_bf16 v[48:51], v[128:131], v[120:123], v[48:51]
    s_waitcnt lgkmcnt(2)
    v_mfma_f32_16x16x32_bf16 v[72:75], v[128:131], v[124:127], v[72:75]
    s_waitcnt vmcnt(0)
    v_readfirstlane_b32 s45, v160
    s_nop 1
    s_cmp_lt_u32 s45, s49
    s_cbranch_scc1 KM_P2_S
KM_P2_X:
    v_mfma_f32_16x16x32_bf16 v[4:7], v[132:135], v[112:115], v[4:7]
    ds_read_b64_tr_b16 v[128:129], v157 offset:45056
    v_mfma_f32_16x16x32_bf16 v[28:31], v[132:135], v[116:119], v[28:31]
    ds_read_b64_tr_b16 v[130:131], v157 offset:47104
    v_mfma_f32_16x16x32_bf16 v[52:55], v[132:135], v[120:123], v[52:55]
    v_mfma_f32_16x16x32_bf16 v[76:79], v[132:135], v[124:127], v[76:79]
    v_mfma_f32_16x16x32_bf16 v[8:11], v[136:139], v[112:115], v[8:11]
    s_waitcnt lgkmcnt(0)
    s_barrier
    v_mfma_f32_16x16x32_bf16 v[32:35], v[136:139], v[116:119], v[32:35]
    v_add_u32 v152, 0xa000, v152
    ds_read_b64_tr_b16 v[132:133], v152 offset:40960
    v_mfma_f32_16x16x32_bf16 v[56:59], v[136:139], v[120:123], v[56:59]
    ds_read_b64_tr_b16 v[134:135], v152 offset:43008
    v_mfma_f32_16x16x32_bf16 v[80:83], v[136:139], v[124:127], v[80:83]
    v_add_u32 v158, 0xa000, v158
    v_add_u32 v159, 0xa000, v159
    ds_read_b64 v[96:97], v159 offset:40960
    ds_read_b64 v[98:99], v159 offset:41472
    v_mfma_f32_16x16x32_bf16 v[12:15], v[140:143], v[112:115], v[12:15]
    v_add_u32 v153, 0xa000, v153
    ds_read_b64_tr_b16 v[136:137], v153 offset:40960
    v_mfma_f32_16x16x32_bf16 v[36:39], v[140:143], v[116:119], v[36:39]
    ds_read_b64_tr_b16 v[138:139], v153 offset:43008
    v_mfma_f32_16x16x32_bf16 v[60:63], v[140:143], v[120:123], v[60:63]
    ds_read_b64 v[100:101], v159 offset:43008
    ds_read_b64 v[102:103], v159 offset:43520
    v_mfma_f32_16x16x32_bf16 v[84:87], v[140:143], v[124:127], v[84:87]
    v_mfma_f32_16x16x32_bf16 v[16:19], v[144:147], v[112:115], v[16:19]
    v_add_u32 v154, 0xa000, v154
    ds_read_b64_tr_b16 v[140:141], v154 offset:40960
    v_mfma_f32_16x16x32_bf16 v[40:43], v[144:147], v[116:119], v[40:43]
    ds_read_b64_tr_b16 v[142:143], v154 offset:43008
    v_mfma_f32_16x16x32_bf16 v[64:67], v[144:147], v[120:123], v[64:67]
    ds_read_b64 v[104:105], v159 offset:45056
    ds_read_b64 v[106:107], v159 offset:45568
    v_mfma_f32_16x16x32_bf16 v[88:91], v[144:147], v[124:127], v[88:91]
    v_mfma_f32_16x16x32_bf16 v[20:23], v[128:131], v[112:115], v[20:23]
    v_add_u32 v155, 0xa000, v155
    ds_read_b64_tr_b16 v[144:145], v155 offset:40960
    v_mfma_f32_16x16x32_bf16 v[44:47], v[128:131], v[116:119], v[44:47]
    ds_read_b64_tr_b16 v[146:147], v155 offset:43008
    v_mfma_f32_16x16x32_bf16 v[68:71], v[128:131], v[120:123], v[68:71]
    ds_read_b64 v[108:109], v159 offset:47104
    s_waitcnt lgkmcnt(13)
    ds_read_b64 v[110:111], v159 offset:47616
    v_mfma_f32_16x16x32_bf16 v[92:95], v[128:131], v[124:127], v[92:95]
    s_waitcnt lgkmcnt(12)
    v_mfma_f32_16x16x32_bf16 v[0:3], v[132:135], v[96:99], v[0:3]
    v_add_u32 v156, 0xa000, v156
    ds_read_b64_tr_b16 v[128:129], v156 offset:40960
    s_waitcnt lgkmcnt(9)
    v_mfma_f32_16x16x32_bf16 v[24:27], v[132:135], v[100:103], v[24:27]
    ds_read_b64_tr_b16 v[130:131], v156 offset:43008
    s_waitcnt lgkmcnt(6)
    v_mfma_f32_16x16x32_bf16 v[48:51], v[132:135], v[104:107], v[48:51]
    s_waitcnt lgkmcnt(2)
    v_mfma_f32_16x16x32_bf16 v[72:75], v[132:135], v[108:111], v[72:75]
    v_mfma_f32_16x16x32_bf16 v[4:7], v[136:139], v[96:99], v[4:7]
    v_add_u32 v157, 0xa000, v157
    ds_read_b64_tr_b16 v[132:133], v157 offset:40960
    v_mfma_f32_16x16x32_bf16 v[28:31], v[136:139], v[100:103], v[28:31]
    ds_read_b64_tr_b16 v[134:135], v157 offset:43008
    v_mfma_f32_16x16x32_bf16 v[52:55], v[136:139], v[104:107], v[52:55]
    v_mfma_f32_16x16x32_bf16 v[76:79], v[136:139], v[108:111], v[76:79]
    v_mfma_f32_16x16x32_bf16 v[8:11], v[140:143], v[96:99], v[8:11]
    ds_read_b64_tr_b16 v[136:137], v152 offset:45056
    v_mfma_f32_16x16x32_bf16 v[32:35], v[140:143], v[100:103], v[32:35]
    ds_read_b64_tr_b16 v[138:139], v152 offset:47104
    v_mfma_f32_16x16x32_bf16 v[56:59], v[140:143], v[104:107], v[56:59]
    ds_read_b64 v[112:113], v159 offset:41984
    ds_read_b64 v[114:115], v159 offset:42496
    v_mfma_f32_16x16x32_bf16 v[80:83], v[140:143], v[108:111], v[80:83]
    v_mfma_f32_16x16x32_bf16 v[12:15], v[144:147], v[96:99], v[12:15]
    ds_read_b64_tr_b16 v[140:141], v153 offset:45056
    v_mfma_f32_16x16x32_bf16 v[36:39], v[144:147], v[100:103], v[36:39]
    ds_read_b64_tr_b16 v[142:143], v153 offset:47104
    v_mfma_f32_16x16x32_bf16 v[60:63], v[144:147], v[104:107], v[60:63]
    ds_read_b64 v[116:117], v159 offset:44032
    ds_read_b64 v[118:119], v159 offset:44544
    v_mfma_f32_16x16x32_bf16 v[84:87], v[144:147], v[108:111], v[84:87]
    s_waitcnt lgkmcnt(10)
    v_mfma_f32_16x16x32_bf16 v[16:19], v[128:131], v[96:99], v[16:19]
    ds_read_b64_tr_b16 v[144:145], v154 offset:45056
    v_mfma_f32_16x16x32_bf16 v[40:43], v[128:131], v[100:103], v[40:43]
    ds_read_b64_tr_b16 v[146:147], v154 offset:47104
    v_mfma_f32_16x16x32_bf16 v[64:67], v[128:131], v[104:107], v[64:67]
    ds_read_b64 v[120:121], v159 offset:46080
    ds_read_b64 v[122:123], v159 offset:46592
    v_mfma_f32_16x16x32_bf16 v[88:91], v[128:131], v[108:111], v[88:91]
    s_waitcnt lgkmcnt(12)
    v_mfma_f32_16x16x32_bf16 v[20:23], v[132:135], v[96:99], v[20:23]
    ds_read_b64_tr_b16 v[128:129], v155 offset:45056
    v_mfma_f32_16x16x32_bf16 v[44:47], v[132:135], v[100:103], v[44:47]
    ds_read_b64_tr_b16 v[130:131], v155 offset:47104
    v_mfma_f32_16x16x32_bf16 v[68:71], v[132:135], v[104:107], v[68:71]
    ds_read_b64 v[124:125], v159 offset:48128
    s_waitcnt lgkmcnt(13)
    ds_read_b64 v[126:127], v159 offset:48640
    v_mfma_f32_16x16x32_bf16 v[92:95], v[132:135], v[108:111], v[92:95]
    s_waitcnt lgkmcnt(12)
    v_mfma_f32_16x16x32_bf16 v[0:3], v[136:139], v[112:115], v[0:3]
    ds_read_b64_tr_b16 v[132:133], v156 offset:45056
    s_waitcnt lgkmcnt(9)
    v_mfma_f32_16x16x32_bf16 v[24:27], v[136:139], v[116:119], v[24:27]
    ds_read_b64_tr_b16 v[134:135], v156 offset:47104
    s_waitcnt lgkmcnt(6)
    v_mfma_f32_16x16x32_bf16 v[48:51], v[136:139], v[120:123], v[48:51]
    s_waitcnt lgkmcnt(2)
    v_mfma_f32_16x16x32_bf16 v[72:75], v[136:139], v[124:127], v[72:75]
    v_mfma_f32_16x16x32_bf16 v[4:7], v[140:143], v[112:115], v[4:7]
    ds_read_b64_tr_b16 v[136:137], v157 offset:45056
    v_mfma_f32_16x16x32_bf16 v[28:31], v[140:143], v[116:119], v[28:31]
    ds_read_b64_tr_b16 v[138:139], v157 offset:47104
    v_mfma_f32_16x16x32_bf16 v[52:55], v[140:143], v[120:123], v[52:55]
    v_mfma_f32_16x16x32_bf16 v[76:79], v[140:143], v[124:127], v[76:79]
    v_mfma_f32_16x16x32_bf16 v[8:11], v[144:147], v[112:115], v[8:11]
    s_waitcnt lgkmcnt(0)
    s_barrier
    v_mfma_f32_16x16x32_bf16 v[32:35], v[144:147], v[116:119], v[32:35]
    v_subrev_u32 v152, 0xa000, v152
    ds_read_b64_tr_b16 v[140:141], v152 offset:0
    v_mfma_f32_16x16x32_bf16 v[56:59], v[144:147], v[120:123], v[56:59]
    ds_read_b64_tr_b16 v[142:143], v152 offset:2048
    v_mfma_f32_16x16x32_bf16 v[80:83], v[144:147], v[124:127], v[80:83]
    v_subrev_u32 v158, 0xa000, v158
    v_subrev_u32 v159, 0xa000, v159
    ds_read_b64 v[96:97], v159 offset:0
    ds_read_b64 v[98:99], v159 offset:512
    v_mfma_f32_16x16x32_bf16 v[12:15], v[128:131], v[112:115], v[12:15]
    v_subrev_u32 v153, 0xa000, v153
    ds_read_b64_tr_b16 v[144:145], v153 offset:0
    v_mfma_f32_16x16x32_bf16 v[36:39], v[128:131], v[116:119], v[36:39]
    ds_read_b64_tr_b16 v[146:147], v153 offset:2048
    v_mfma_f32_16x16x32_bf16 v[60:63], v[128:131], v[120:123], v[60:63]
    ds_read_b64 v[100:101], v159 offset:2048
    ds_read_b64 v[102:103], v159 offset:2560
    v_mfma_f32_16x16x32_bf16 v[84:87], v[128:131], v[124:127], v[84:87]
    v_mfma_f32_16x16x32_bf16 v[16:19], v[132:135], v[112:115], v[16:19]
    v_subrev_u32 v154, 0xa000, v154
    ds_read_b64_tr_b16 v[128:129], v154 offset:0
    v_mfma_f32_16x16x32_bf16 v[40:43], v[132:135], v[116:119], v[40:43]
    ds_read_b64_tr_b16 v[130:131], v154 offset:2048
    v_mfma_f32_16x16x32_bf16 v[64:67], v[132:135], v[120:123], v[64:67]
    ds_read_b64 v[104:105], v159 offset:4096
    ds_read_b64 v[106:107], v159 offset:4608
    v_mfma_f32_16x16x32_bf16 v[88:91], v[132:135], v[124:127], v[88:91]
    v_mfma_f32_16x16x32_bf16 v[20:23], v[136:139], v[112:115], v[20:23]
    v_subrev_u32 v155, 0xa000, v155
    ds_read_b64_tr_b16 v[132:133], v155 offset:0
    v_mfma_f32_16x16x32_bf16 v[44:47], v[136:139], v[116:119], v[44:47]
    ds_read_b64_tr_b16 v[134:135], v155 offset:2048
    v_mfma_f32_16x16x32_bf16 v[68:71], v[136:139], v[120:123], v[68:71]
    ds_read_b64 v[108:109], v159 offset:6144
    s_waitcnt lgkmcnt(13)
    ds_read_b64 v[110:111], v159 offset:6656
    v_mfma_f32_16x16x32_bf16 v[92:95], v[136:139], v[124:127], v[92:95]
    s_waitcnt lgkmcnt(12)
    v_mfma_f32_16x16x32_bf16 v[0:3], v[140:143], v[96:99], v[0:3]
    v_subrev_u32 v156, 0xa000, v156
    ds_read_b64_tr_b16 v[136:137], v156 offset:0
    s_waitcnt lgkmcnt(9)
    v_mfma_f32_16x16x32_bf16 v[24:27], v[140:143], v[100:103], v[24:27]
    ds_read_b64_tr_b16 v[138:139], v156 offset:2048
    s_waitcnt lgkmcnt(6)
    v_mfma_f32_16x16x32_bf16 v[48:51], v[140:143], v[104:107], v[48:51]
    s_waitcnt lgkmcnt(2)
    v_mfma_f32_16x16x32_bf16 v[72:75], v[140:143], v[108:111], v[72:75]
    v_mfma_f32_16x16x32_bf16 v[4:7], v[144:147], v[96:99], v[4:7]
    v_subrev_u32 v157, 0xa000, v157
    ds_read_b64_tr_b16 v[140:141], v157 offset:0
    v_mfma_f32_16x16x32_bf16 v[28:31], v[144:147], v[100:103], v[28:31]
    ds_read_b64_tr_b16 v[142:143], v157 offset:2048
    v_mfma_f32_16x16x32_bf16 v[52:55], v[144:147], v[104:107], v[52:55]
    v_mfma_f32_16x16x32_bf16 v[76:79], v[144:147], v[108:111], v[76:79]
    v_mfma_f32_16x16x32_bf16 v[8:11], v[128:131], v[96:99], v[8:11]
    ds_read_b64_tr_b16 v[144:145], v152 offset:4096
    v_mfma_f32_16x16x32_bf16 v[32:35], v[128:131], v[100:103], v[32:35]
    ds_read_b64_tr_b16 v[146:147], v152 offset:6144
    v_mfma_f32_16x16x32_bf16 v[56:59], v[128:131], v[104:107], v[56:59]
    ds_read_b64 v[112:113], v159 offset:1024
    ds_read_b64 v[114:115], v159 offset:1536
    v_mfma_f32_16x16x32_bf16 v[80:83], v[128:131], v[108:111], v[80:83]
    v_mfma_f32_16x16x32_bf16 v[12:15], v[132:135], v[96:99], v[12:15]
    ds_read_b64_tr_b16 v[128:129], v153 offset:4096
    v_mfma_f32_16x16x32_bf16 v[36:39], v[132:135], v[100:103], v[36:39]
    ds_read_b64_tr_b16 v[130:131], v153 offset:6144
    v_mfma_f32_16x16x32_bf16 v[60:63], v[132:135], v[104:107], v[60:63]
    ds_read_b64 v[116:117], v159 offset:3072
    ds_read_b64 v[118:119], v159 offset:3584
    v_mfma_f32_16x16x32_bf16 v[84:87], v[132:135], v[108:111], v[84:87]
    s_waitcnt lgkmcnt(10)
    v_mfma_f32_16x16x32_bf16 v[16:19], v[136:139], v[96:99], v[16:19]
    ds_read_b64_tr_b16 v[132:133], v154 offset:4096
    v_mfma_f32_16x16x32_bf16 v[40:43], v[136:139], v[100:103], v[40:43]
    ds_read_b64_tr_b16 v[134:135], v154 offset:6144
    v_mfma_f32_16x16x32_bf16 v[64:67], v[136:139], v[104:107], v[64:67]
    ds_read_b64 v[120:121], v159 offset:5120
    ds_read_b64 v[122:123], v159 offset:5632
    v_mfma_f32_16x16x32_bf16 v[88:91], v[136:139], v[108:111], v[88:91]
    s_waitcnt lgkmcnt(12)
    v_mfma_f32_16x16x32_bf16 v[20:23], v[140:143], v[96:99], v[20:23]
    ds_read_b64_tr_b16 v[136:137], v155 offset:4096
    v_mfma_f32_16x16x32_bf16 v[44:47], v[140:143], v[100:103], v[44:47]
    ds_read_b64_tr_b16 v[138:139], v155 offset:6144
    v_mfma_f32_16x16x32_bf16 v[68:71], v[140:143], v[104:107], v[68:71]
    ds_read_b64 v[124:125], v159 offset:7168
    s_waitcnt lgkmcnt(13)
    ds_read_b64 v[126:127], v159 offset:7680
    v_mfma_f32_16x16x32_bf16 v[92:95], v[140:143], v[108:111], v[92:95]
    s_waitcnt lgkmcnt(12)
    v_mfma_f32_16x16x32_bf16 v[0:3], v[144:147], v[112:115], v[0:3]
    ds_read_b64_tr_b16 v[140:141], v156 offset:4096
    s_waitcnt lgkmcnt(9)
    v_mfma_f32_16x16x32_bf16 v[24:27], v[144:147], v[116:119], v[24:27]
    ds_read_b64_tr_b16 v[142:143], v156 offset:6144
    s_waitcnt lgkmcnt(6)
    v_mfma_f32_16x16x32_bf16 v[48:51], v[144:147], v[120:123], v[48:51]
    s_waitcnt lgkmcnt(2)
    v_mfma_f32_16x16x32_bf16 v[72:75], v[144:147], v[124:127], v[72:75]
    v_mfma_f32_16x16x32_bf16 v[4:7], v[128:131], v[112:115], v[4:7]
    ds_read_b64_tr_b16 v[144:145], v157 offset:4096
    v_mfma_f32_16x16x32_bf16 v[28:31], v[128:131], v[116:119], v[28:31]
    ds_read_b64_tr_b16 v[146:147], v157 offset:6144
    v_mfma_f32_16x16x32_bf16 v[52:55], v[128:131], v[120:123], v[52:55]
    v_mfma_f32_16x16x32_bf16 v[76:79], v[128:131], v[124:127], v[76:79]
    v_mfma_f32_16x16x32_bf16 v[8:11], v[132:135], v[112:115], v[8:11]
    s_waitcnt lgkmcnt(0)
    s_barrier
    v_mfma_f32_16x16x32_bf16 v[32:35], v[132:135], v[116:119], v[32:35]
    ds_read_b64_tr_b16 v[128:129], v152 offset:40960
    v_mfma_f32_16x16x32_bf16 v[56:59], v[132:135], v[120:123], v[56:59]
    ds_read_b64_tr_b16 v[130:131], v152 offset:43008
    v_mfma_f32_16x16x32_bf16 v[80:83], v[132:135], v[124:127], v[80:83]
    ds_read_b128 v[96:99], v158 offset:40960
    v_mfma_f32_16x16x32_bf16 v[12:15], v[136:139], v[112:115], v[12:15]
    ds_read_b64_tr_b16 v[132:133], v153 offset:40960
    v_mfma_f32_16x16x32_bf16 v[36:39], v[136:139], v[116:119], v[36:39]
    ds_read_b64_tr_b16 v[134:135], v153 offset:43008
    v_mfma_f32_16x16x32_bf16 v[60:63], v[136:139], v[120:123], v[60:63]
    ds_read_b128 v[100:103], v158 offset:43008
    v_mfma_f32_16x16x32_bf16 v[84:87], v[136:139], v[124:127], v[84:87]
    v_mfma_f32_16x16x32_bf16 v[16:19], v[140:143], v[112:115], v[16:19]
    ds_read_b64_tr_b16 v[136:137], v154 offset:40960
    v_mfma_f32_16x16x32_bf16 v[40:43], v[140:143], v[116:119], v[40:43]
    ds_read_b64_tr_b16 v[138:139], v154 offset:43008
    v_mfma_f32_16x16x32_bf16 v[64:67], v[140:143], v[120:123], v[64:67]
    ds_read_b128 v[104:107], v158 offset:45056
    v_mfma_f32_16x16x32_bf16 v[88:91], v[140:143], v[124:127], v[88:91]
    v_mfma_f32_16x16x32_bf16 v[20:23], v[144:147], v[112:115], v[20:23]
    ds_read_b64_tr_b16 v[140:141], v155 offset:40960
    v_mfma_f32_16x16x32_bf16 v[44:47], v[144:147], v[116:119], v[44:47]
    ds_read_b64_tr_b16 v[142:143], v155 offset:43008
    v_mfma_f32_16x16x32_bf16 v[68:71], v[144:147], v[120:123], v[68:71]
    ds_read_b128 v[108:111], v158 offset:47104
    v_mfma_f32_16x16x32_bf16 v[92:95], v[144:147], v[124:127], v[92:95]
    s_waitcnt lgkmcnt(9)
    v_mfma_f32_16x16x32_bf16 v[0:3], v[128:131], v[96:99], v[0:3]
    ds_read_b64_tr_b16 v[144:145], v156 offset:40960
    s_waitcnt lgkmcnt(7)
    v_mfma_f32_16x16x32_bf16 v[24:27], v[128:131], v[100:103], v[24:27]
    ds_read_b64_tr_b16 v[146:147], v156 offset:43008
    s_waitcnt lgkmcnt(5)
    v_mfma_f32_16x16x32_bf16 v[48:51], v[128:131], v[104:107], v[48:51]
    s_waitcnt lgkmcnt(2)
    v_mfma_f32_16x16x32_bf16 v[72:75], v[128:131], v[108:111], v[72:75]
    v_mfma_f32_16x16x32_bf16 v[4:7], v[132:135], v[96:99], v[4:7]
    ds_read_b64_tr_b16 v[128:129], v157 offset:40960
    v_mfma_f32_16x16x32_bf16 v[28:31], v[132:135], v[100:103], v[28:31]
    ds_read_b64_tr_b16 v[130:131], v157 offset:43008
    v_mfma_f32_16x16x32_bf16 v[52:55], v[132:135], v[104:107], v[52:55]
    v_mfma_f32_16x16x32_bf16 v[76:79], v[132:135], v[108:111], v[76:79]
    v_mfma_f32_16x16x32_bf16 v[8:11], v[136:139], v[96:99], v[8:11]
    ds_read_b64_tr_b16 v[132:133], v152 offset:45056
    v_mfma_f32_16x16x32_bf16 v[32:35], v[136:139], v[100:103], v[32:35]
    ds_read_b64_tr_b16 v[134:135], v152 offset:47104
    v_mfma_f32_16x16x32_bf16 v[56:59], v[136:139], v[104:107], v[56:59]
    ds_read_b128 v[112:115], v158 offset:41984
    v_mfma_f32_16x16x32_bf16 v[80:83], v[136:139], v[108:111], v[80:83]
    v_mfma_f32_16x16x32_bf16 v[12:15], v[140:143], v[96:99], v[12:15]
    ds_read_b64_tr_b16 v[136:137], v153 offset:45056
    v_mfma_f32_16x16x32_bf16 v[36:39], v[140:143], v[100:103], v[36:39]
    ds_read_b64_tr_b16 v[138:139], v153 offset:47104
    v_mfma_f32_16x16x32_bf16 v[60:63], v[140:143], v[104:107], v[60:63]
    ds_read_b128 v[116:119], v158 offset:44032
    v_mfma_f32_16x16x32_bf16 v[84:87], v[140:143], v[108:111], v[84:87]
    s_waitcnt lgkmcnt(8)
    v_mfma_f32_16x16x32_bf16 v[16:19], v[144:147], v[96:99], v[16:19]
    ds_read_b64_tr_b16 v[140:141], v154 offset:45056
    v_mfma_f32_16x16x32_bf16 v[40:43], v[144:147], v[100:103], v[40:43]
    ds_read_b64_tr_b16 v[142:143], v154 offset:47104
    v_mfma_f32_16x16x32_bf16 v[64:67], v[144:147], v[104:107], v[64:67]
    ds_read_b128 v[120:123], v158 offset:46080
    v_mfma_f32_16x16x32_bf16 v[88:91], v[144:147], v[108:111], v[88:91]
    s_waitcnt lgkmcnt(9)
    v_mfma_f32_16x16x32_bf16 v[20:23], v[128:131], v[96:99], v[20:23]
    ds_read_b64_tr_b16 v[144:145], v155 offset:45056
    v_mfma_f32_16x16x32_bf16 v[44:47], v[128:131], v[100:103], v[44:47]
    ds_read_b64_tr_b16 v[146:147], v155 offset:47104
    v_mfma_f32_16x16x32_bf16 v[68:71], v[128:131], v[104:107], v[68:71]
    ds_read_b128 v[124:127], v158 offset:48128
    v_mfma_f32_16x16x32_bf16 v[92:95], v[128:131], v[108:111], v[92:95]
    s_waitcnt lgkmcnt(9)
    v_mfma_f32_16x16x32_bf16 v[0:3], v[132:135], v[112:115], v[0:3]
    ds_read_b64_tr_b16 v[128:129], v156 offset:45056
    s_waitcnt lgkmcnt(7)
    v_mfma_f32_16x16x32_bf16 v[24:27], v[132:135], v[116:119], v[24:27]
    ds_read_b64_tr_b16 v[130:131], v156 offset:47104
    s_waitcnt lgkmcnt(5)
    v_mfma_f32_16x16x32_bf16 v[48:51], v[132:135], v[120:123], v[48:51]
    s_waitcnt lgkmcnt(2)
    v_mfma_f32_16x16x32_bf16 v[72:75], v[132:135], v[124:127], v[72:75]
    v_mfma_f32_16x16x32_bf16 v[4:7], v[136:139], v[112:115], v[4:7]
    ds_read_b64_tr_b16 v[132:133], v157 offset:45056
    v_mfma_f32_16x16x32_bf16 v[28:31], v[136:139], v[116:119], v[28:31]
    ds_read_b64_tr_b16 v[134:135], v157 offset:47104
    v_mfma_f32_16x16x32_bf16 v[52:55], v[136:139], v[120:123], v[52:55]
    v_mfma_f32_16x16x32_bf16 v[76:79], v[136:139], v[124:127], v[76:79]
    v_mfma_f32_16x16x32_bf16 v[8:11], v[140:143], v[112:115], v[8:11]
    s_waitcnt lgkmcnt(0)
    s_barrier
    v_mfma_f32_16x16x32_bf16 v[32:35], v[140:143], v[116:119], v[32:35]
    v_add_u32 v152, 0xa000, v152
    ds_read_b64_tr_b16 v[136:137], v152 offset:40960
    v_mfma_f32_16x16x32_bf16 v[56:59], v[140:143], v[120:123], v[56:59]
    ds_read_b64_tr_b16 v[138:139], v152 offset:43008
    v_mfma_f32_16x16x32_bf16 v[80:83], v[140:143], v[124:127], v[80:83]
    v_add_u32 v158, 0xa000, v158
    ds_read_b128 v[96:99], v158 offset:40960
    v_mfma_f32_16x16x32_bf16 v[12:15], v[144:147], v[112:115], v[12:15]
    v_add_u32 v153, 0xa000, v153
    ds_read_b64_tr_b16 v[140:141], v153 offset:40960
    v_mfma_f32_16x16x32_bf16 v[36:39], v[144:147], v[116:119], v[36:39]
    ds_read_b64_tr_b16 v[142:143], v153 offset:43008
    v_mfma_f32_16x16x32_bf16 v[60:63], v[144:147], v[120:123], v[60:63]
    ds_read_b128 v[100:103], v158 offset:43008
    v_mfma_f32_16x16x32_bf16 v[84:87], v[144:147], v[124:127], v[84:87]
    v_mfma_f32_16x16x32_bf16 v[16:19], v[128:131], v[112:115], v[16:19]
    v_add_u32 v154, 0xa000, v154
    ds_read_b64_tr_b16 v[144:145], v154 offset:40960
    v_mfma_f32_16x16x32_bf16 v[40:43], v[128:131], v[116:119], v[40:43]
    ds_read_b64_tr_b16 v[146:147], v154 offset:43008
    v_mfma_f32_16x16x32_bf16 v[64:67], v[128:131], v[120:123], v[64:67]
    ds_read_b128 v[104:107], v158 offset:45056
    v_mfma_f32_16x16x32_bf16 v[88:91], v[128:131], v[124:127], v[88:91]
    v_mfma_f32_16x16x32_bf16 v[20:23], v[132:135], v[112:115], v[20:23]
    v_add_u32 v155, 0xa000, v155
    ds_read_b64_tr_b16 v[128:129], v155 offset:40960
    v_mfma_f32_16x16x32_bf16 v[44:47], v[132:135], v[116:119], v[44:47]
    ds_read_b64_tr_b16 v[130:131], v155 offset:43008
    v_mfma_f32_16x16x32_bf16 v[68:71], v[132:135], v[120:123], v[68:71]
    ds_read_b128 v[108:111], v158 offset:47104
    v_mfma_f32_16x16x32_bf16 v[92:95], v[132:135], v[124:127], v[92:95]
    s_waitcnt lgkmcnt(9)
    v_mfma_f32_16x16x32_bf16 v[0:3], v[136:139], v[96:99], v[0:3]
    v_add_u32 v156, 0xa000, v156
    ds_read_b64_tr_b16 v[132:133], v156 offset:40960
    s_waitcnt lgkmcnt(7)
    v_mfma_f32_16x16x32_bf16 v[24:27], v[136:139], v[100:103], v[24:27]
    ds_read_b64_tr_b16 v[134:135], v156 offset:43008
    s_waitcnt lgkmcnt(5)
    v_mfma_f32_16x16x32_bf16 v[48:51], v[136:139], v[104:107], v[48:51]
    s_waitcnt lgkmcnt(2)
    v_mfma_f32_16x16x32_bf16 v[72:75], v[136:139], v[108:111], v[72:75]
    v_mfma_f32_16x16x32_bf16 v[4:7], v[140:143], v[96:99], v[4:7]
    v_add_u32 v157, 0xa000, v157
    ds_read_b64_tr_b16 v[136:137], v157 offset:40960
    v_mfma_f32_16x16x32_bf16 v[28:31], v[140:143], v[100:103], v[28:31]
    ds_read_b64_tr_b16 v[138:139], v157 offset:43008
    v_mfma_f32_16x16x32_bf16 v[52:55], v[140:143], v[104:107], v[52:55]
    v_mfma_f32_16x16x32_bf16 v[76:79], v[140:143], v[108:111], v[76:79]
    v_mfma_f32_16x16x32_bf16 v[8:11], v[144:147], v[96:99], v[8:11]
    ds_read_b64_tr_b16 v[140:141], v152 offset:45056
    v_mfma_f32_16x16x32_bf16 v[32:35], v[144:147], v[100:103], v[32:35]
    ds_read_b64_tr_b16 v[142:143], v152 offset:47104
    v_mfma_f32_16x16x32_bf16 v[56:59], v[144:147], v[104:107], v[56:59]
    ds_read_b128 v[112:115], v158 offset:41984
    v_mfma_f32_16x16x32_bf16 v[80:83], v[144:147], v[108:111], v[80:83]
    v_mfma_f32_16x16x32_bf16 v[12:15], v[128:131], v[96:99], v[12:15]
    ds_read_b64_tr_b16 v[144:145], v153 offset:45056
    v_mfma_f32_16x16x32_bf16 v[36:39], v[128:131], v[100:103], v[36:39]
    ds_read_b64_tr_b16 v[146:147], v153 offset:47104
    v_mfma_f32_16x16x32_bf16 v[60:63], v[128:131], v[104:107], v[60:63]
    ds_read_b128 v[116:119], v158 offset:44032
    v_mfma_f32_16x16x32_bf16 v[84:87], v[128:131], v[108:111], v[84:87]
    s_waitcnt lgkmcnt(8)
    v_mfma_f32_16x16x32_bf16 v[16:19], v[132:135], v[96:99], v[16:19]
    ds_read_b64_tr_b16 v[128:129], v154 offset:45056
    v_mfma_f32_16x16x32_bf16 v[40:43], v[132:135], v[100:103], v[40:43]
    ds_read_b64_tr_b16 v[130:131], v154 offset:47104
    v_mfma_f32_16x16x32_bf16 v[64:67], v[132:135], v[104:107], v[64:67]
    ds_read_b128 v[120:123], v158 offset:46080
    v_mfma_f32_16x16x32_bf16 v[88:91], v[132:135], v[108:111], v[88:91]
    s_waitcnt lgkmcnt(9)
    v_mfma_f32_16x16x32_bf16 v[20:23], v[136:139], v[96:99], v[20:23]
    ds_read_b64_tr_b16 v[132:133], v155 offset:45056
    v_mfma_f32_16x16x32_bf16 v[44:47], v[136:139], v[100:103], v[44:47]
    ds_read_b64_tr_b16 v[134:135], v155 offset:47104
    v_mfma_f32_16x16x32_bf16 v[68:71], v[136:139], v[104:107], v[68:71]
    ds_read_b128 v[124:127], v158 offset:48128
    v_mfma_f32_16x16x32_bf16 v[92:95], v[136:139], v[108:111], v[92:95]
    s_waitcnt lgkmcnt(9)
    v_mfma_f32_16x16x32_bf16 v[0:3], v[140:143], v[112:115], v[0:3]
    ds_read_b64_tr_b16 v[136:137], v156 offset:45056
    s_waitcnt lgkmcnt(7)
    v_mfma_f32_16x16x32_bf16 v[24:27], v[140:143], v[116:119], v[24:27]
    ds_read_b64_tr_b16 v[138:139], v156 offset:47104
    s_waitcnt lgkmcnt(5)
    v_mfma_f32_16x16x32_bf16 v[48:51], v[140:143], v[120:123], v[48:51]
    s_waitcnt lgkmcnt(2)
    v_mfma_f32_16x16x32_bf16 v[72:75], v[140:143], v[124:127], v[72:75]
    v_mfma_f32_16x16x32_bf16 v[4:7], v[144:147], v[112:115], v[4:7]
    ds_read_b64_tr_b16 v[140:141], v157 offset:45056
    v_mfma_f32_16x16x32_bf16 v[28:31], v[144:147], v[116:119], v[28:31]
    ds_read_b64_tr_b16 v[142:143], v157 offset:47104
    v_mfma_f32_16x16x32_bf16 v[52:55], v[144:147], v[120:123], v[52:55]
    v_mfma_f32_16x16x32_bf16 v[76:79], v[144:147], v[124:127], v[76:79]
    v_mfma_f32_16x16x32_bf16 v[8:11], v[128:131], v[112:115], v[8:11]
    s_waitcnt lgkmcnt(0)
    s_barrier
    v_mfma_f32_16x16x32_bf16 v[32:35], v[128:131], v[116:119], v[32:35]
    v_subrev_u32 v152, 0xa000, v152
    ds_read_b64_tr_b16 v[144:145], v152 offset:0
    v_mfma_f32_16x16x32_bf16 v[56:59], v[128:131], v[120:123], v[56:59]
    ds_read_b64_tr_b16 v[146:147], v152 offset:2048
    v_mfma_f32_16x16x32_bf16 v[80:83], v[128:131], v[124:127], v[80:83]
    v_subrev_u32 v158, 0xa000, v158
    ds_read_b128 v[96:99], v158 offset:0
    v_mfma_f32_16x16x32_bf16 v[12:15], v[132:135], v[112:115], v[12:15]
    v_subrev_u32 v153, 0xa000, v153
    ds_read_b64_tr_b16 v[128:129], v153 offset:0
    v_mfma_f32_16x16x32_bf16 v[36:39], v[132:135], v[116:119], v[36:39]
    ds_read_b64_tr_b16 v[130:131], v153 offset:2048
    v_mfma_f32_16x16x32_bf16 v[60:63], v[132:135], v[120:123], v[60:63]
    ds_read_b128 v[100:103], v158 offset:2048
    v_mfma_f32_16x16x32_bf16 v[84:87], v[132:135], v[124:127], v[84:87]
    v_mfma_f32_16x16x32_bf16 v[16:19], v[136:139], v[112:115], v[16:19]
    v_subrev_u32 v154, 0xa000, v154
    ds_read_b64_tr_b16 v[132:133], v154 offset:0
    v_mfma_f32_16x16x32_bf16 v[40:43], v[136:139], v[116:119], v[40:43]
    ds_read_b64_tr_b16 v[134:135], v154 offset:2048
    v_mfma_f32_16x16x32_bf16 v[64:67], v[136:139], v[120:123], v[64:67]
    ds_read_b128 v[104:107], v158 offset:4096
    v_mfma_f32_16x16x32_bf16 v[88:91], v[136:139], v[124:127], v[88:91]
    v_mfma_f32_16x16x32_bf16 v[20:23], v[140:143], v[112:115], v[20:23]
    v_subrev_u32 v155, 0xa000, v155
    ds_read_b64_tr_b16 v[136:137], v155 offset:0
    v_mfma_f32_16x16x32_bf16 v[44:47], v[140:143], v[116:119], v[44:47]
    ds_read_b64_tr_b16 v[138:139], v155 offset:2048
    v_mfma_f32_16x16x32_bf16 v[68:71], v[140:143], v[120:123], v[68:71]
    ds_read_b128 v[108:111], v158 offset:6144
    v_mfma_f32_16x16x32_bf16 v[92:95], v[140:143], v[124:127], v[92:95]
    s_waitcnt lgkmcnt(9)
    v_mfma_f32_16x16x32_bf16 v[0:3], v[144:147], v[96:99], v[0:3]
    v_subrev_u32 v156, 0xa000, v156
    ds_read_b64_tr_b16 v[140:141], v156 offset:0
    s_waitcnt lgkmcnt(7)
    v_mfma_f32_16x16x32_bf16 v[24:27], v[144:147], v[100:103], v[24:27]
    ds_read_b64_tr_b16 v[142:143], v156 offset:2048
    s_waitcnt lgkmcnt(5)
    v_mfma_f32_16x16x32_bf16 v[48:51], v[144:147], v[104:107], v[48:51]
    s_waitcnt lgkmcnt(2)
    v_mfma_f32_16x16x32_bf16 v[72:75], v[144:147], v[108:111], v[72:75]
    v_mfma_f32_16x16x32_bf16 v[4:7], v[128:131], v[96:99], v[4:7]
    v_subrev_u32 v157, 0xa000, v157
    ds_read_b64_tr_b16 v[144:145], v157 offset:0
    v_mfma_f32_16x16x32_bf16 v[28:31], v[128:131], v[100:103], v[28:31]
    ds_read_b64_tr_b16 v[146:147], v157 offset:2048
    v_mfma_f32_16x16x32_bf16 v[52:55], v[128:131], v[104:107], v[52:55]
    v_mfma_f32_16x16x32_bf16 v[76:79], v[128:131], v[108:111], v[76:79]
    v_mfma_f32_16x16x32_bf16 v[8:11], v[132:135], v[96:99], v[8:11]
    ds_read_b64_tr_b16 v[128:129], v152 offset:4096
    v_mfma_f32_16x16x32_bf16 v[32:35], v[132:135], v[100:103], v[32:35]
    ds_read_b64_tr_b16 v[130:131], v152 offset:6144
    v_mfma_f32_16x16x32_bf16 v[56:59], v[132:135], v[104:107], v[56:59]
    ds_read_b128 v[112:115], v158 offset:1024
    v_mfma_f32_16x16x32_bf16 v[80:83], v[132:135], v[108:111], v[80:83]
    v_mfma_f32_16x16x32_bf16 v[12:15], v[136:139], v[96:99], v[12:15]
    ds_read_b64_tr_b16 v[132:133], v153 offset:4096
    v_mfma_f32_16x16x32_bf16 v[36:39], v[136:139], v[100:103], v[36:39]
    ds_read_b64_tr_b16 v[134:135], v153 offset:6144
    v_mfma_f32_16x16x32_bf16 v[60:63], v[136:139], v[104:107], v[60:63]
    ds_read_b128 v[116:119], v158 offset:3072
    v_mfma_f32_16x16x32_bf16 v[84:87], v[136:139], v[108:111], v[84:87]
    s_waitcnt lgkmcnt(8)
    v_mfma_f32_16x16x32_bf16 v[16:19], v[140:143], v[96:99], v[16:19]
    ds_read_b64_tr_b16 v[136:137], v154 offset:4096
    v_mfma_f32_16x16x32_bf16 v[40:43], v[140:143], v[100:103], v[40:43]
    ds_read_b64_tr_b16 v[138:139], v154 offset:6144
    v_mfma_f32_16x16x32_bf16 v[64:67], v[140:143], v[104:107], v[64:67]
    ds_read_b128 v[120:123], v158 offset:5120
    v_mfma_f32_16x16x32_bf16 v[88:91], v[140:143], v[108:111], v[88:91]
    s_waitcnt lgkmcnt(9)
    v_mfma_f32_16x16x32_bf16 v[20:23], v[144:147], v[96:99], v[20:23]
    ds_read_b64_tr_b16 v[140:141], v155 offset:4096
    v_mfma_f32_16x16x32_bf16 v[44:47], v[144:147], v[100:103], v[44:47]
    ds_read_b64_tr_b16 v[142:143], v155 offset:6144
    v_mfma_f32_16x16x32_bf16 v[68:71], v[144:147], v[104:107], v[68:71]
    ds_read_b128 v[124:127], v158 offset:7168
    v_mfma_f32_16x16x32_bf16 v[92:95], v[144:147], v[108:111], v[92:95]
    s_waitcnt lgkmcnt(9)
    v_mfma_f32_16x16x32_bf16 v[0:3], v[128:131], v[112:115], v[0:3]
    ds_read_b64_tr_b16 v[144:145], v156 offset:4096
    s_waitcnt lgkmcnt(7)
    v_mfma_f32_16x16x32_bf16 v[24:27], v[128:131], v[116:119], v[24:27]
    ds_read_b64_tr_b16 v[146:147], v156 offset:6144
    s_waitcnt lgkmcnt(5)
    v_mfma_f32_16x16x32_bf16 v[48:51], v[128:131], v[120:123], v[48:51]
    s_waitcnt lgkmcnt(2)
    v_mfma_f32_16x16x32_bf16 v[72:75], v[128:131], v[124:127], v[72:75]
    v_mfma_f32_16x16x32_bf16 v[4:7], v[132:135], v[112:115], v[4:7]
    ds_read_b64_tr_b16 v[128:129], v157 offset:4096
    v_mfma_f32_16x16x32_bf16 v[28:31], v[132:135], v[116:119], v[28:31]
    ds_read_b64_tr_b16 v[130:131], v157 offset:6144
    v_mfma_f32_16x16x32_bf16 v[52:55], v[132:135], v[120:123], v[52:55]
    v_mfma_f32_16x16x32_bf16 v[76:79], v[132:135], v[124:127], v[76:79]
    v_mfma_f32_16x16x32_bf16 v[8:11], v[136:139], v[112:115], v[8:11]
    s_waitcnt lgkmcnt(0)
    s_barrier
    v_mfma_f32_16x16x32_bf16 v[32:35], v[136:139], v[116:119], v[32:35]
    ds_read_b64_tr_b16 v[132:133], v152 offset:40960
    v_mfma_f32_16x16x32_bf16 v[56:59], v[136:139], v[120:123], v[56:59]
    ds_read_b64_tr_b16 v[134:135], v152 offset:43008
    v_mfma_f32_16x16x32_bf16 v[80:83], v[136:139], v[124:127], v[80:83]
    ds_read_b128 v[96:99], v158 offset:40960
    v_mfma_f32_16x16x32_bf16 v[12:15], v[140:143], v[112:115], v[12:15]
    ds_read_b64_tr_b16 v[136:137], v153 offset:40960
    v_mfma_f32_16x16x32_bf16 v[36:39], v[140:143], v[116:119], v[36:39]
    ds_read_b64_tr_b16 v[138:139], v153 offset:43008
    v_mfma_f32_16x16x32_bf16 v[60:63], v[140:143], v[120:123], v[60:63]
    ds_read_b128 v[100:103], v158 offset:43008
    v_mfma_f32_16x16x32_bf16 v[84:87], v[140:143], v[124:127], v[84:87]
    v_mfma_f32_16x16x32_bf16 v[16:19], v[144:147], v[112:115], v[16:19]
    ds_read_b64_tr_b16 v[140:141], v154 offset:40960
    v_mfma_f32_16x16x32_bf16 v[40:43], v[144:147], v[116:119], v[40:43]
    ds_read_b64_tr_b16 v[142:143], v154 offset:43008
    v_mfma_f32_16x16x32_bf16 v[64:67], v[144:147], v[120:123], v[64:67]
    ds_read_b128 v[104:107], v158 offset:45056
    v_mfma_f32_16x16x32_bf16 v[88:91], v[144:147], v[124:127], v[88:91]
    v_mfma_f32_16x16x32_bf16 v[20:23], v[128:131], v[112:115], v[20:23]
    ds_read_b64_tr_b16 v[144:145], v155 offset:40960
    v_mfma_f32_16x16x32_bf16 v[44:47], v[128:131], v[116:119], v[44:47]
    ds_read_b64_tr_b16 v[146:147], v155 offset:43008
    v_mfma_f32_16x16x32_bf16 v[68:71], v[128:131], v[120:123], v[68:71]
    ds_read_b128 v[108:111], v158 offset:47104
    v_mfma_f32_16x16x32_bf16 v[92:95], v[128:131], v[124:127], v[92:95]
    s_waitcnt lgkmcnt(9)
    v_mfma_f32_16x16x32_bf16 v[0:3], v[132:135], v[96:99], v[0:3]
    ds_read_b64_tr_b16 v[128:129], v156 offset:40960
    s_waitcnt lgkmcnt(7)
    v_mfma_f32_16x16x32_bf16 v[24:27], v[132:135], v[100:103], v[24:27]
    ds_read_b64_tr_b16 v[130:131], v156 offset:43008
    s_waitcnt lgkmcnt(5)
    v_mfma_f32_16x16x32_bf16 v[48:51], v[132:135], v[104:107], v[48:51]
    s_waitcnt lgkmcnt(2)
    v_mfma_f32_16x16x32_bf16 v[72:75], v[132:135], v[108:111], v[72:75]
    v_mfma_f32_16x16x32_bf16 v[4:7], v[136:139], v[96:99], v[4:7]
    ds_read_b64_tr_b16 v[132:133], v157 offset:40960
    v_mfma_f32_16x16x32_bf16 v[28:31], v[136:139], v[100:103], v[28:31]
    ds_read_b64_tr_b16 v[134:135], v157 offset:43008
    v_mfma_f32_16x16x32_bf16 v[52:55], v[136:139], v[104:107], v[52:55]
    v_mfma_f32_16x16x32_bf16 v[76:79], v[136:139], v[108:111], v[76:79]
    v_mfma_f32_16x16x32_bf16 v[8:11], v[140:143], v[96:99], v[8:11]
    ds_read_b64_tr_b16 v[136:137], v152 offset:45056
    v_mfma_f32_16x16x32_bf16 v[32:35], v[140:143], v[100:103], v[32:35]
    ds_read_b64_tr_b16 v[138:139], v152 offset:47104
    v_mfma_f32_16x16x32_bf16 v[56:59], v[140:143], v[104:107], v[56:59]
    ds_read_b128 v[112:115], v158 offset:41984
    v_mfma_f32_16x16x32_bf16 v[80:83], v[140:143], v[108:111], v[80:83]
    v_mfma_f32_16x16x32_bf16 v[12:15], v[144:147], v[96:99], v[12:15]
    ds_read_b64_tr_b16 v[140:141], v153 offset:45056
    v_mfma_f32_16x16x32_bf16 v[36:39], v[144:147], v[100:103], v[36:39]
    ds_read_b64_tr_b16 v[142:143], v153 offset:47104
    v_mfma_f32_16x16x32_bf16 v[60:63], v[144:147], v[104:107], v[60:63]
    ds_read_b128 v[116:119], v158 offset:44032
    v_mfma_f32_16x16x32_bf16 v[84:87], v[144:147], v[108:111], v[84:87]
    s_waitcnt lgkmcnt(8)
    v_mfma_f32_16x16x32_bf16 v[16:19], v[128:131], v[96:99], v[16:19]
    ds_read_b64_tr_b16 v[144:145], v154 offset:45056
    v_mfma_f32_16x16x32_bf16 v[40:43], v[128:131], v[100:103], v[40:43]
    ds_read_b64_tr_b16 v[146:147], v154 offset:47104
    v_mfma_f32_16x16x32_bf16 v[64:67], v[128:131], v[104:107], v[64:67]
    ds_read_b128 v[120:123], v158 offset:46080
    v_mfma_f32_16x16x32_bf16 v[88:91], v[128:131], v[108:111], v[88:91]
    s_waitcnt lgkmcnt(9)
    v_mfma_f32_16x16x32_bf16 v[20:23], v[132:135], v[96:99], v[20:23]
    ds_read_b64_tr_b16 v[128:129], v155 offset:45056
    v_mfma_f32_16x16x32_bf16 v[44:47], v[132:135], v[100:103], v[44:47]
    ds_read_b64_tr_b16 v[130:131], v155 offset:47104
    v_mfma_f32_16x16x32_bf16 v[68:71], v[132:135], v[104:107], v[68:71]
    ds_read_b128 v[124:127], v158 offset:48128
    v_mfma_f32_16x16x32_bf16 v[92:95], v[132:135], v[108:111], v[92:95]
    s_waitcnt lgkmcnt(9)
    v_mfma_f32_16x16x32_bf16 v[0:3], v[136:139], v[112:115], v[0:3]
    ds_read_b64_tr_b16 v[132:133], v156 offset:45056
    s_waitcnt lgkmcnt(7)
    v_mfma_f32_16x16x32_bf16 v[24:27], v[136:139], v[116:119], v[24:27]
    ds_read_b64_tr_b16 v[134:135], v156 offset:47104
    s_waitcnt lgkmcnt(5)
    v_mfma_f32_16x16x32_bf16 v[48:51], v[136:139], v[120:123], v[48:51]
    s_waitcnt lgkmcnt(2)
    v_mfma_f32_16x16x32_bf16 v[72:75], v[136:139], v[124:127], v[72:75]
    v_mfma_f32_16x16x32_bf16 v[4:7], v[140:143], v[112:115], v[4:7]
    ds_read_b64_tr_b16 v[136:137], v157 offset:45056
    v_mfma_f32_16x16x32_bf16 v[28:31], v[140:143], v[116:119], v[28:31]
    ds_read_b64_tr_b16 v[138:139], v157 offset:47104
    v_mfma_f32_16x16x32_bf16 v[52:55], v[140:143], v[120:123], v[52:55]
    v_mfma_f32_16x16x32_bf16 v[76:79], v[140:143], v[124:127], v[76:79]
    v_mfma_f32_16x16x32_bf16 v[8:11], v[144:147], v[112:115], v[8:11]
    s_waitcnt lgkmcnt(0)
    s_barrier
    v_mfma_f32_16x16x32_bf16 v[32:35], v[144:147], v[116:119], v[32:35]
    v_add_u32 v152, 0xa000, v152
    ds_read_b64_tr_b16 v[140:141], v152 offset:40960
    v_mfma_f32_16x16x32_bf16 v[56:59], v[144:147], v[120:123], v[56:59]
    ds_read_b64_tr_b16 v[142:143], v152 offset:43008
    v_mfma_f32_16x16x32_bf16 v[80:83], v[144:147], v[124:127], v[80:83]
    v_add_u32 v158, 0xa000, v158
    ds_read_b128 v[96:99], v158 offset:40960
    v_mfma_f32_16x16x32_bf16 v[12:15], v[128:131], v[112:115], v[12:15]
    v_add_u32 v153, 0xa000, v153
    ds_read_b64_tr_b16 v[144:145], v153 offset:40960
    v_mfma_f32_16x16x32_bf16 v[36:39], v[128:131], v[116:119], v[36:39]
    ds_read_b64_tr_b16 v[146:147], v153 offset:43008
    v_mfma_f32_16x16x32_bf16 v[60:63], v[128:131], v[120:123], v[60:63]
    ds_read_b128 v[100:103], v158 offset:43008
    v_mfma_f32_16x16x32_bf16 v[84:87], v[128:131], v[124:127], v[84:87]
    v_mfma_f32_16x16x32_bf16 v[16:19], v[132:135], v[112:115], v[16:19]
    v_add_u32 v154, 0xa000, v154
    ds_read_b64_tr_b16 v[128:129], v154 offset:40960
    v_mfma_f32_16x16x32_bf16 v[40:43], v[132:135], v[116:119], v[40:43]
    ds_read_b64_tr_b16 v[130:131], v154 offset:43008
    v_mfma_f32_16x16x32_bf16 v[64:67], v[132:135], v[120:123], v[64:67]
    ds_read_b128 v[104:107], v158 offset:45056
    v_mfma_f32_16x16x32_bf16 v[88:91], v[132:135], v[124:127], v[88:91]
    v_mfma_f32_16x16x32_bf16 v[20:23], v[136:139], v[112:115], v[20:23]
    v_add_u32 v155, 0xa000, v155
    ds_read_b64_tr_b16 v[132:133], v155 offset:40960
    v_mfma_f32_16x16x32_bf16 v[44:47], v[136:139], v[116:119], v[44:47]
    ds_read_b64_tr_b16 v[134:135], v155 offset:43008
    v_mfma_f32_16x16x32_bf16 v[68:71], v[136:139], v[120:123], v[68:71]
    ds_read_b128 v[108:111], v158 offset:47104
    v_mfma_f32_16x16x32_bf16 v[92:95], v[136:139], v[124:127], v[92:95]
    s_waitcnt lgkmcnt(9)
    v_mfma_f32_16x16x32_bf16 v[0:3], v[140:143], v[96:99], v[0:3]
    v_add_u32 v156, 0xa000, v156
    ds_read_b64_tr_b16 v[136:137], v156 offset:40960
    s_waitcnt lgkmcnt(7)
    v_mfma_f32_16x16x32_bf16 v[24:27], v[140:143], v[100:103], v[24:27]
    ds_read_b64_tr_b16 v[138:139], v156 offset:43008
    s_waitcnt lgkmcnt(5)
    v_mfma_f32_16x16x32_bf16 v[48:51], v[140:143], v[104:107], v[48:51]
    s_waitcnt lgkmcnt(2)
    v_mfma_f32_16x16x32_bf16 v[72:75], v[140:143], v[108:111], v[72:75]
    v_mfma_f32_16x16x32_bf16 v[4:7], v[144:147], v[96:99], v[4:7]
    v_add_u32 v157, 0xa000, v157
    ds_read_b64_tr_b16 v[140:141], v157 offset:40960
    v_mfma_f32_16x16x32_bf16 v[28:31], v[144:147], v[100:103], v[28:31]
    ds_read_b64_tr_b16 v[142:143], v157 offset:43008
    v_mfma_f32_16x16x32_bf16 v[52:55], v[144:147], v[104:107], v[52:55]
    v_mfma_f32_16x16x32_bf16 v[76:79], v[144:147], v[108:111], v[76:79]
    v_mfma_f32_16x16x32_bf16 v[8:11], v[128:131], v[96:99], v[8:11]
    ds_read_b64_tr_b16 v[144:145], v152 offset:45056
    v_mfma_f32_16x16x32_bf16 v[32:35], v[128:131], v[100:103], v[32:35]
    ds_read_b64_tr_b16 v[146:147], v152 offset:47104
    v_mfma_f32_16x16x32_bf16 v[56:59], v[128:131], v[104:107], v[56:59]
    ds_read_b128 v[112:115], v158 offset:41984
    v_mfma_f32_16x16x32_bf16 v[80:83], v[128:131], v[108:111], v[80:83]
    v_mfma_f32_16x16x32_bf16 v[12:15], v[132:135], v[96:99], v[12:15]
    ds_read_b64_tr_b16 v[128:129], v153 offset:45056
    v_mfma_f32_16x16x32_bf16 v[36:39], v[132:135], v[100:103], v[36:39]
    ds_read_b64_tr_b16 v[130:131], v153 offset:47104
    v_mfma_f32_16x16x32_bf16 v[60:63], v[132:135], v[104:107], v[60:63]
    ds_read_b128 v[116:119], v158 offset:44032
    v_mfma_f32_16x16x32_bf16 v[84:87], v[132:135], v[108:111], v[84:87]
    s_waitcnt lgkmcnt(8)
    v_mfma_f32_16x16x32_bf16 v[16:19], v[136:139], v[96:99], v[16:19]
    ds_read_b64_tr_b16 v[132:133], v154 offset:45056
    v_mfma_f32_16x16x32_bf16 v[40:43], v[136:139], v[100:103], v[40:43]
    ds_read_b64_tr_b16 v[134:135], v154 offset:47104
    v_mfma_f32_16x16x32_bf16 v[64:67], v[136:139], v[104:107], v[64:67]
    ds_read_b128 v[120:123], v158 offset:46080
    v_mfma_f32_16x16x32_bf16 v[88:91], v[136:139], v[108:111], v[88:91]
    s_waitcnt lgkmcnt(9)
    v_mfma_f32_16x16x32_bf16 v[20:23], v[140:143], v[96:99], v[20:23]
    ds_read_b64_tr_b16 v[136:137], v155 offset:45056
    v_mfma_f32_16x16x32_bf16 v[44:47], v[140:143], v[100:103], v[44:47]
    ds_read_b64_tr_b16 v[138:139], v155 offset:47104
    v_mfma_f32_16x16x32_bf16 v[68:71], v[140:143], v[104:107], v[68:71]
    ds_read_b128 v[124:127], v158 offset:48128
    v_mfma_f32_16x16x32_bf16 v[92:95], v[140:143], v[108:111], v[92:95]
    s_waitcnt lgkmcnt(9)
    v_mfma_f32_16x16x32_bf16 v[0:3], v[144:147], v[112:115], v[0:3]
    ds_read_b64_tr_b16 v[140:141], v156 offset:45056
    s_waitcnt lgkmcnt(7)
    v_mfma_f32_16x16x32_bf16 v[24:27], v[144:147], v[116:119], v[24:27]
    ds_read_b64_tr_b16 v[142:143], v156 offset:47104
    s_waitcnt lgkmcnt(5)
    v_mfma_f32_16x16x32_bf16 v[48:51], v[144:147], v[120:123], v[48:51]
    s_waitcnt lgkmcnt(2)
    v_mfma_f32_16x16x32_bf16 v[72:75], v[144:147], v[124:127], v[72:75]
    v_mfma_f32_16x16x32_bf16 v[4:7], v[128:131], v[112:115], v[4:7]
    ds_read_b64_tr_b16 v[144:145], v157 offset:45056
    v_mfma_f32_16x16x32_bf16 v[28:31], v[128:131], v[116:119], v[28:31]
    ds_read_b64_tr_b16 v[146:147], v157 offset:47104
    v_mfma_f32_16x16x32_bf16 v[52:55], v[128:131], v[120:123], v[52:55]
    v_mfma_f32_16x16x32_bf16 v[76:79], v[128:131], v[124:127], v[76:79]
    v_mfma_f32_16x16x32_bf16 v[8:11], v[132:135], v[112:115], v[8:11]
    s_waitcnt lgkmcnt(0)
    s_barrier
    v_mfma_f32_16x16x32_bf16 v[32:35], v[132:135], v[116:119], v[32:35]
    v_subrev_u32 v152, 0xa000, v152
    ds_read_b64_tr_b16 v[128:129], v152 offset:0
    v_mfma_f32_16x16x32_bf16 v[56:59], v[132:135], v[120:123], v[56:59]
    ds_read_b64_tr_b16 v[130:131], v152 offset:2048
    v_mfma_f32_16x16x32_bf16 v[80:83], v[132:135], v[124:127], v[80:83]
    v_subrev_u32 v158, 0xa000, v158
    ds_read_b128 v[96:99], v158 offset:0
    v_mfma_f32_16x16x32_bf16 v[12:15], v[136:139], v[112:115], v[12:15]
    v_subrev_u32 v153, 0xa000, v153
    ds_read_b64_tr_b16 v[132:133], v153 offset:0
    v_mfma_f32_16x16x32_bf16 v[36:39], v[136:139], v[116:119], v[36:39]
    ds_read_b64_tr_b16 v[134:135], v153 offset:2048
    v_mfma_f32_16x16x32_bf16 v[60:63], v[136:139], v[120:123], v[60:63]
    ds_read_b128 v[100:103], v158 offset:2048
    v_mfma_f32_16x16x32_bf16 v[84:87], v[136:139], v[124:127], v[84:87]
    v_mfma_f32_16x16x32_bf16 v[16:19], v[140:143], v[112:115], v[16:19]
    v_subrev_u32 v154, 0xa000, v154
    ds_read_b64_tr_b16 v[136:137], v154 offset:0
    v_mfma_f32_16x16x32_bf16 v[40:43], v[140:143], v[116:119], v[40:43]
    ds_read_b64_tr_b16 v[138:139], v154 offset:2048
    v_mfma_f32_16x16x32_bf16 v[64:67], v[140:143], v[120:123], v[64:67]
    ds_read_b128 v[104:107], v158 offset:4096
    v_mfma_f32_16x16x32_bf16 v[88:91], v[140:143], v[124:127], v[88:91]
    v_mfma_f32_16x16x32_bf16 v[20:23], v[144:147], v[112:115], v[20:23]
    v_subrev_u32 v155, 0xa000, v155
    ds_read_b64_tr_b16 v[140:141], v155 offset:0
    v_mfma_f32_16x16x32_bf16 v[44:47], v[144:147], v[116:119], v[44:47]
    ds_read_b64_tr_b16 v[142:143], v155 offset:2048
    v_mfma_f32_16x16x32_bf16 v[68:71], v[144:147], v[120:123], v[68:71]
    ds_read_b128 v[108:111], v158 offset:6144
    v_mfma_f32_16x16x32_bf16 v[92:95], v[144:147], v[124:127], v[92:95]
    s_waitcnt lgkmcnt(9)
    v_mfma_f32_16x16x32_bf16 v[0:3], v[128:131], v[96:99], v[0:3]
    v_subrev_u32 v156, 0xa000, v156
    ds_read_b64_tr_b16 v[144:145], v156 offset:0
    s_waitcnt lgkmcnt(7)
    v_mfma_f32_16x16x32_bf16 v[24:27], v[128:131], v[100:103], v[24:27]
    ds_read_b64_tr_b16 v[146:147], v156 offset:2048
    s_waitcnt lgkmcnt(5)
    v_mfma_f32_16x16x32_bf16 v[48:51], v[128:131], v[104:107], v[48:51]
    s_waitcnt lgkmcnt(2)
    v_mfma_f32_16x16x32_bf16 v[72:75], v[128:131], v[108:111], v[72:75]
    v_mfma_f32_16x16x32_bf16 v[4:7], v[132:135], v[96:99], v[4:7]
    v_subrev_u32 v157, 0xa000, v157
    ds_read_b64_tr_b16 v[128:129], v157 offset:0
    v_mfma_f32_16x16x32_bf16 v[28:31], v[132:135], v[100:103], v[28:31]
    ds_read_b64_tr_b16 v[130:131], v157 offset:2048
    v_mfma_f32_16x16x32_bf16 v[52:55], v[132:135], v[104:107], v[52:55]
    v_mfma_f32_16x16x32_bf16 v[76:79], v[132:135], v[108:111], v[76:79]
    v_mfma_f32_16x16x32_bf16 v[8:11], v[136:139], v[96:99], v[8:11]
    ds_read_b64_tr_b16 v[132:133], v152 offset:4096
    v_mfma_f32_16x16x32_bf16 v[32:35], v[136:139], v[100:103], v[32:35]
    ds_read_b64_tr_b16 v[134:135], v152 offset:6144
    v_mfma_f32_16x16x32_bf16 v[56:59], v[136:139], v[104:107], v[56:59]
    ds_read_b128 v[112:115], v158 offset:1024
    v_mfma_f32_16x16x32_bf16 v[80:83], v[136:139], v[108:111], v[80:83]
    v_mfma_f32_16x16x32_bf16 v[12:15], v[140:143], v[96:99], v[12:15]
    ds_read_b64_tr_b16 v[136:137], v153 offset:4096
    v_mfma_f32_16x16x32_bf16 v[36:39], v[140:143], v[100:103], v[36:39]
    ds_read_b64_tr_b16 v[138:139], v153 offset:6144
    v_mfma_f32_16x16x32_bf16 v[60:63], v[140:143], v[104:107], v[60:63]
    ds_read_b128 v[116:119], v158 offset:3072
    v_mfma_f32_16x16x32_bf16 v[84:87], v[140:143], v[108:111], v[84:87]
    s_waitcnt lgkmcnt(8)
    v_mfma_f32_16x16x32_bf16 v[16:19], v[144:147], v[96:99], v[16:19]
    ds_read_b64_tr_b16 v[140:141], v154 offset:4096
    v_mfma_f32_16x16x32_bf16 v[40:43], v[144:147], v[100:103], v[40:43]
    ds_read_b64_tr_b16 v[142:143], v154 offset:6144
    v_mfma_f32_16x16x32_bf16 v[64:67], v[144:147], v[104:107], v[64:67]
    ds_read_b128 v[120:123], v158 offset:5120
    v_mfma_f32_16x16x32_bf16 v[88:91], v[144:147], v[108:111], v[88:91]
    s_waitcnt lgkmcnt(9)
    v_mfma_f32_16x16x32_bf16 v[20:23], v[128:131], v[96:99], v[20:23]
    ds_read_b64_tr_b16 v[144:145], v155 offset:4096
    v_mfma_f32_16x16x32_bf16 v[44:47], v[128:131], v[100:103], v[44:47]
    ds_read_b64_tr_b16 v[146:147], v155 offset:6144
    v_mfma_f32_16x16x32_bf16 v[68:71], v[128:131], v[104:107], v[68:71]
    ds_read_b128 v[124:127], v158 offset:7168
    v_mfma_f32_16x16x32_bf16 v[92:95], v[128:131], v[108:111], v[92:95]
    s_waitcnt lgkmcnt(9)
    v_mfma_f32_16x16x32_bf16 v[0:3], v[132:135], v[112:115], v[0:3]
    ds_read_b64_tr_b16 v[128:129], v156 offset:4096
    s_waitcnt lgkmcnt(7)
    v_mfma_f32_16x16x32_bf16 v[24:27], v[132:135], v[116:119], v[24:27]
    ds_read_b64_tr_b16 v[130:131], v156 offset:6144
    s_waitcnt lgkmcnt(5)
    v_mfma_f32_16x16x32_bf16 v[48:51], v[132:135], v[120:123], v[48:51]
    s_waitcnt lgkmcnt(2)
    v_mfma_f32_16x16x32_bf16 v[72:75], v[132:135], v[124:127], v[72:75]
    v_mfma_f32_16x16x32_bf16 v[4:7], v[136:139], v[112:115], v[4:7]
    ds_read_b64_tr_b16 v[132:133], v157 offset:4096
    v_mfma_f32_16x16x32_bf16 v[28:31], v[136:139], v[116:119], v[28:31]
    ds_read_b64_tr_b16 v[134:135], v157 offset:6144
    v_mfma_f32_16x16x32_bf16 v[52:55], v[136:139], v[120:123], v[52:55]
    v_mfma_f32_16x16x32_bf16 v[76:79], v[136:139], v[124:127], v[76:79]
    v_mfma_f32_16x16x32_bf16 v[8:11], v[140:143], v[112:115], v[8:11]
    s_waitcnt lgkmcnt(0)
    s_barrier
    v_mfma_f32_16x16x32_bf16 v[32:35], v[140:143], v[116:119], v[32:35]
    ds_read_b64_tr_b16 v[136:137], v152 offset:40960
    v_mfma_f32_16x16x32_bf16 v[56:59], v[140:143], v[120:123], v[56:59]
    ds_read_b64_tr_b16 v[138:139], v152 offset:43008
    v_mfma_f32_16x16x32_bf16 v[80:83], v[140:143], v[124:127], v[80:83]
    ds_read_b128 v[96:99], v158 offset:40960
    v_mfma_f32_16x16x32_bf16 v[12:15], v[144:147], v[112:115], v[12:15]
    ds_read_b64_tr_b16 v[140:141], v153 offset:40960
    v_mfma_f32_16x16x32_bf16 v[36:39], v[144:147], v[116:119], v[36:39]
    ds_read_b64_tr_b16 v[142:143], v153 offset:43008
    v_mfma_f32_16x16x32_bf16 v[60:63], v[144:147], v[120:123], v[60:63]
    ds_read_b128 v[100:103], v158 offset:43008
    v_mfma_f32_16x16x32_bf16 v[84:87], v[144:147], v[124:127], v[84:87]
    v_mfma_f32_16x16x32_bf16 v[16:19], v[128:131], v[112:115], v[16:19]
    ds_read_b64_tr_b16 v[144:145], v154 offset:40960
    v_mfma_f32_16x16x32_bf16 v[40:43], v[128:131], v[116:119], v[40:43]
    ds_read_b64_tr_b16 v[146:147], v154 offset:43008
    v_mfma_f32_16x16x32_bf16 v[64:67], v[128:131], v[120:123], v[64:67]
    ds_read_b128 v[104:107], v158 offset:45056
    v_mfma_f32_16x16x32_bf16 v[88:91], v[128:131], v[124:127], v[88:91]
    v_mfma_f32_16x16x32_bf16 v[20:23], v[132:135], v[112:115], v[20:23]
    ds_read_b64_tr_b16 v[128:129], v155 offset:40960
    v_mfma_f32_16x16x32_bf16 v[44:47], v[132:135], v[116:119], v[44:47]
    ds_read_b64_tr_b16 v[130:131], v155 offset:43008
    v_mfma_f32_16x16x32_bf16 v[68:71], v[132:135], v[120:123], v[68:71]
    ds_read_b128 v[108:111], v158 offset:47104
    v_mfma_f32_16x16x32_bf16 v[92:95], v[132:135], v[124:127], v[92:95]
    s_waitcnt lgkmcnt(9)
    v_mfma_f32_16x16x32_bf16 v[0:3], v[136:139], v[96:99], v[0:3]
    ds_read_b64_tr_b16 v[132:133], v156 offset:40960
    s_waitcnt lgkmcnt(7)
    v_mfma_f32_16x16x32_bf16 v[24:27], v[136:139], v[100:103], v[24:27]
    ds_read_b64_tr_b16 v[134:135], v156 offset:43008
    s_waitcnt lgkmcnt(5)
    v_mfma_f32_16x16x32_bf16 v[48:51], v[136:139], v[104:107], v[48:51]
    s_waitcnt lgkmcnt(2)
    v_mfma_f32_16x16x32_bf16 v[72:75], v[136:139], v[108:111], v[72:75]
    v_mfma_f32_16x16x32_bf16 v[4:7], v[140:143], v[96:99], v[4:7]
    ds_read_b64_tr_b16 v[136:137], v157 offset:40960
    v_mfma_f32_16x16x32_bf16 v[28:31], v[140:143], v[100:103], v[28:31]
    ds_read_b64_tr_b16 v[138:139], v157 offset:43008
    v_mfma_f32_16x16x32_bf16 v[52:55], v[140:143], v[104:107], v[52:55]
    v_mfma_f32_16x16x32_bf16 v[76:79], v[140:143], v[108:111], v[76:79]
    v_mfma_f32_16x16x32_bf16 v[8:11], v[144:147], v[96:99], v[8:11]
    ds_read_b64_tr_b16 v[140:141], v152 offset:45056
    v_mfma_f32_16x16x32_bf16 v[32:35], v[144:147], v[100:103], v[32:35]
    ds_read_b64_tr_b16 v[142:143], v152 offset:47104
    v_mfma_f32_16x16x32_bf16 v[56:59], v[144:147], v[104:107], v[56:59]
    ds_read_b128 v[112:115], v158 offset:41984
    v_mfma_f32_16x16x32_bf16 v[80:83], v[144:147], v[108:111], v[80:83]
    v_mfma_f32_16x16x32_bf16 v[12:15], v[128:131], v[96:99], v[12:15]
    ds_read_b64_tr_b16 v[144:145], v153 offset:45056
    v_mfma_f32_16x16x32_bf16 v[36:39], v[128:131], v[100:103], v[36:39]
    ds_read_b64_tr_b16 v[146:147], v153 offset:47104
    v_mfma_f32_16x16x32_bf16 v[60:63], v[128:131], v[104:107], v[60:63]
    ds_read_b128 v[116:119], v158 offset:44032
    v_mfma_f32_16x16x32_bf16 v[84:87], v[128:131], v[108:111], v[84:87]
    s_waitcnt lgkmcnt(8)
    v_mfma_f32_16x16x32_bf16 v[16:19], v[132:135], v[96:99], v[16:19]
    ds_read_b64_tr_b16 v[128:129], v154 offset:45056
    v_mfma_f32_16x16x32_bf16 v[40:43], v[132:135], v[100:103], v[40:43]
    ds_read_b64_tr_b16 v[130:131], v154 offset:47104
    v_mfma_f32_16x16x32_bf16 v[64:67], v[132:135], v[104:107], v[64:67]
    ds_read_b128 v[120:123], v158 offset:46080
    v_mfma_f32_16x16x32_bf16 v[88:91], v[132:135], v[108:111], v[88:91]
    s_waitcnt lgkmcnt(9)
    v_mfma_f32_16x16x32_bf16 v[20:23], v[136:139], v[96:99], v[20:23]
    ds_read_b64_tr_b16 v[132:133], v155 offset:45056
    v_mfma_f32_16x16x32_bf16 v[44:47], v[136:139], v[100:103], v[44:47]
    ds_read_b64_tr_b16 v[134:135], v155 offset:47104
    v_mfma_f32_16x16x32_bf16 v[68:71], v[136:139], v[104:107], v[68:71]
    ds_read_b128 v[124:127], v158 offset:48128
    v_mfma_f32_16x16x32_bf16 v[92:95], v[136:139], v[108:111], v[92:95]
    s_waitcnt lgkmcnt(9)
    v_mfma_f32_16x16x32_bf16 v[0:3], v[140:143], v[112:115], v[0:3]
    ds_read_b64_tr_b16 v[136:137], v156 offset:45056
    s_waitcnt lgkmcnt(7)
    v_mfma_f32_16x16x32_bf16 v[24:27], v[140:143], v[116:119], v[24:27]
    ds_read_b64_tr_b16 v[138:139], v156 offset:47104
    s_waitcnt lgkmcnt(5)
    v_mfma_f32_16x16x32_bf16 v[48:51], v[140:143], v[120:123], v[48:51]
    s_waitcnt lgkmcnt(2)
    v_mfma_f32_16x16x32_bf16 v[72:75], v[140:143], v[124:127], v[72:75]
    v_mfma_f32_16x16x32_bf16 v[4:7], v[144:147], v[112:115], v[4:7]
    ds_read_b64_tr_b16 v[140:141], v157 offset:45056
    v_mfma_f32_16x16x32_bf16 v[28:31], v[144:147], v[116:119], v[28:31]
    ds_read_b64_tr_b16 v[142:143], v157 offset:47104
    v_mfma_f32_16x16x32_bf16 v[52:55], v[144:147], v[120:123], v[52:55]
    v_mfma_f32_16x16x32_bf16 v[76:79], v[144:147], v[124:127], v[76:79]
    v_mfma_f32_16x16x32_bf16 v[8:11], v[128:131], v[112:115], v[8:11]
    s_waitcnt lgkmcnt(0)
    s_barrier
    v_mfma_f32_16x16x32_bf16 v[32:35], v[128:131], v[116:119], v[32:35]
    v_add_u32 v152, 0xa000, v152
    ds_read_b64_tr_b16 v[144:145], v152 offset:40960
    v_mfma_f32_16x16x32_bf16 v[56:59], v[128:131], v[120:123], v[56:59]
    ds_read_b64_tr_b16 v[146:147], v152 offset:43008
    v_mfma_f32_16x16x32_bf16 v[80:83], v[128:131], v[124:127], v[80:83]
    v_add_u32 v158, 0xa000, v158
    ds_read_b128 v[96:99], v158 offset:40960
    v_mfma_f32_16x16x32_bf16 v[12:15], v[132:135], v[112:115], v[12:15]
    v_add_u32 v153, 0xa000, v153
    ds_read_b64_tr_b16 v[128:129], v153 offset:40960
    v_mfma_f32_16x16x32_bf16 v[36:39], v[132:135], v[116:119], v[36:39]
    ds_read_b64_tr_b16 v[130:131], v153 offset:43008
    v_mfma_f32_16x16x32_bf16 v[60:63], v[132:135], v[120:123], v[60:63]
    ds_read_b128 v[100:103], v158 offset:43008
    v_mfma_f32_16x16x32_bf16 v[84:87], v[132:135], v[124:127], v[84:87]
    v_mfma_f32_16x16x32_bf16 v[16:19], v[136:139], v[112:115], v[16:19]
    v_add_u32 v154, 0xa000, v154
    ds_read_b64_tr_b16 v[132:133], v154 offset:40960
    v_mfma_f32_16x16x32_bf16 v[40:43], v[136:139], v[116:119], v[40:43]
    ds_read_b64_tr_b16 v[134:135], v154 offset:43008
    v_mfma_f32_16x16x32_bf16 v[64:67], v[136:139], v[120:123], v[64:67]
    ds_read_b128 v[104:107], v158 offset:45056
    v_mfma_f32_16x16x32_bf16 v[88:91], v[136:139], v[124:127], v[88:91]
    v_mfma_f32_16x16x32_bf16 v[20:23], v[140:143], v[112:115], v[20:23]
    v_add_u32 v155, 0xa000, v155
    ds_read_b64_tr_b16 v[136:137], v155 offset:40960
    v_mfma_f32_16x16x32_bf16 v[44:47], v[140:143], v[116:119], v[44:47]
    ds_read_b64_tr_b16 v[138:139], v155 offset:43008
    v_mfma_f32_16x16x32_bf16 v[68:71], v[140:143], v[120:123], v[68:71]
    ds_read_b128 v[108:111], v158 offset:47104
    v_mfma_f32_16x16x32_bf16 v[92:95], v[140:143], v[124:127], v[92:95]
    s_waitcnt lgkmcnt(9)
    v_mfma_f32_16x16x32_bf16 v[0:3], v[144:147], v[96:99], v[0:3]
    v_add_u32 v156, 0xa000, v156
    ds_read_b64_tr_b16 v[140:141], v156 offset:40960
    s_waitcnt lgkmcnt(7)
    v_mfma_f32_16x16x32_bf16 v[24:27], v[144:147], v[100:103], v[24:27]
    ds_read_b64_tr_b16 v[142:143], v156 offset:43008
    s_waitcnt lgkmcnt(5)
    v_mfma_f32_16x16x32_bf16 v[48:51], v[144:147], v[104:107], v[48:51]
    s_waitcnt lgkmcnt(2)
    v_mfma_f32_16x16x32_bf16 v[72:75], v[144:147], v[108:111], v[72:75]
    v_mfma_f32_16x16x32_bf16 v[4:7], v[128:131], v[96:99], v[4:7]
    v_add_u32 v157, 0xa000, v157
    ds_read_b64_tr_b16 v[144:145], v157 offset:40960
    v_mfma_f32_16x16x32_bf16 v[28:31], v[128:131], v[100:103], v[28:31]
    ds_read_b64_tr_b16 v[146:147], v157 offset:43008
    v_mfma_f32_16x16x32_bf16 v[52:55], v[128:131], v[104:107], v[52:55]
    v_mfma_f32_16x16x32_bf16 v[76:79], v[128:131], v[108:111], v[76:79]
    v_mfma_f32_16x16x32_bf16 v[8:11], v[132:135], v[96:99], v[8:11]
    ds_read_b64_tr_b16 v[128:129], v152 offset:45056
    v_mfma_f32_16x16x32_bf16 v[32:35], v[132:135], v[100:103], v[32:35]
    ds_read_b64_tr_b16 v[130:131], v152 offset:47104
    v_mfma_f32_16x16x32_bf16 v[56:59], v[132:135], v[104:107], v[56:59]
    ds_read_b128 v[112:115], v158 offset:41984
    v_mfma_f32_16x16x32_bf16 v[80:83], v[132:135], v[108:111], v[80:83]
    v_mfma_f32_16x16x32_bf16 v[12:15], v[136:139], v[96:99], v[12:15]
    ds_read_b64_tr_b16 v[132:133], v153 offset:45056
    v_mfma_f32_16x16x32_bf16 v[36:39], v[136:139], v[100:103], v[36:39]
    ds_read_b64_tr_b16 v[134:135], v153 offset:47104
    v_mfma_f32_16x16x32_bf16 v[60:63], v[136:139], v[104:107], v[60:63]
    ds_read_b128 v[116:119], v158 offset:44032
    v_mfma_f32_16x16x32_bf16 v[84:87], v[136:139], v[108:111], v[84:87]
    s_waitcnt lgkmcnt(8)
    v_mfma_f32_16x16x32_bf16 v[16:19], v[140:143], v[96:99], v[16:19]
    ds_read_b64_tr_b16 v[136:137], v154 offset:45056
    v_mfma_f32_16x16x32_bf16 v[40:43], v[140:143], v[100:103], v[40:43]
    ds_read_b64_tr_b16 v[138:139], v154 offset:47104
    v_mfma_f32_16x16x32_bf16 v[64:67], v[140:143], v[104:107], v[64:67]
    ds_read_b128 v[120:123], v158 offset:46080
    v_mfma_f32_16x16x32_bf16 v[88:91], v[140:143], v[108:111], v[88:91]
    s_waitcnt lgkmcnt(9)
    v_mfma_f32_16x16x32_bf16 v[20:23], v[144:147], v[96:99], v[20:23]
    ds_read_b64_tr_b16 v[140:141], v155 offset:45056
    v_mfma_f32_16x16x32_bf16 v[44:47], v[144:147], v[100:103], v[44:47]
    ds_read_b64_tr_b16 v[142:143], v155 offset:47104
    v_mfma_f32_16x16x32_bf16 v[68:71], v[144:147], v[104:107], v[68:71]
    ds_read_b128 v[124:127], v158 offset:48128
    v_mfma_f32_16x16x32_bf16 v[92:95], v[144:147], v[108:111], v[92:95]
    s_waitcnt lgkmcnt(9)
    v_mfma_f32_16x16x32_bf16 v[0:3], v[128:131], v[112:115], v[0:3]
    ds_read_b64_tr_b16 v[144:145], v156 offset:45056
    s_waitcnt lgkmcnt(7)
    v_mfma_f32_16x16x32_bf16 v[24:27], v[128:131], v[116:119], v[24:27]
    ds_read_b64_tr_b16 v[146:147], v156 offset:47104
    s_waitcnt lgkmcnt(5)
    v_mfma_f32_16x16x32_bf16 v[48:51], v[128:131], v[120:123], v[48:51]
    s_waitcnt lgkmcnt(2)
    v_mfma_f32_16x16x32_bf16 v[72:75], v[128:131], v[124:127], v[72:75]
    v_mfma_f32_16x16x32_bf16 v[4:7], v[132:135], v[112:115], v[4:7]
    ds_read_b64_tr_b16 v[128:129], v157 offset:45056
    v_mfma_f32_16x16x32_bf16 v[28:31], v[132:135], v[116:119], v[28:31]
    ds_read_b64_tr_b16 v[130:131], v157 offset:47104
    v_mfma_f32_16x16x32_bf16 v[52:55], v[132:135], v[120:123], v[52:55]
    v_mfma_f32_16x16x32_bf16 v[76:79], v[132:135], v[124:127], v[76:79]
    v_mfma_f32_16x16x32_bf16 v[8:11], v[136:139], v[112:115], v[8:11]
    v_mfma_f32_16x16x32_bf16 v[32:35], v[136:139], v[116:119], v[32:35]
    v_mfma_f32_16x16x32_bf16 v[56:59], v[136:139], v[120:123], v[56:59]
    v_mfma_f32_16x16x32_bf16 v[80:83], v[136:139], v[124:127], v[80:83]
    v_mfma_f32_16x16x32_bf16 v[12:15], v[140:143], v[112:115], v[12:15]
    v_mfma_f32_16x16x32_bf16 v[36:39], v[140:143], v[116:119], v[36:39]
    v_mfma_f32_16x16x32_bf16 v[60:63], v[140:143], v[120:123], v[60:63]
    v_mfma_f32_16x16x32_bf16 v[84:87], v[140:143], v[124:127], v[84:87]
    s_waitcnt lgkmcnt(2)
    v_mfma_f32_16x16x32_bf16 v[16:19], v[144:147], v[112:115], v[16:19]
    v_mfma_f32_16x16x32_bf16 v[40:43], v[144:147], v[116:119], v[40:43]
    v_mfma_f32_16x16x32_bf16 v[64:67], v[144:147], v[120:123], v[64:67]
    v_mfma_f32_16x16x32_bf16 v[88:91], v[144:147], v[124:127], v[88:91]
    s_waitcnt lgkmcnt(0)
    v_mfma_f32_16x16x32_bf16 v[20:23], v[128:131], v[112:115], v[20:23]
    v_mfma_f32_16x16x32_bf16 v[44:47], v[128:131], v[116:119], v[44:47]
    v_mfma_f32_16x16x32_bf16 v[68:71], v[128:131], v[120:123], v[68:71]
    v_mfma_f32_16x16x32_bf16 v[92:95], v[128:131], v[124:127], v[92:95]
KM_EPI:
    s_waitcnt lgkmcnt(0)
    s_mul_i32 s38, s12, 6144
    s_add_u32 s38, s38, 122880
    v_add_u32 v158, s38, v245
    v_mov_b32 v100, 1
    v_mov_b32 v101, 0
    s_nop 3
    v_cvt_pk_bf16_f32 v0, v0, v1
    v_cvt_pk_bf16_f32 v1, v2, v3
    v_cvt_pk_bf16_f32 v2, v4, v5
    v_cvt_pk_bf16_f32 v3, v6, v7
    buffer_store_dwordx4 v[0:3], v245, s[24:27], s40 offen offset:0 sc1
    v_cvt_pk_bf16_f32 v8, v8, v9
    v_cvt_pk_bf16_f32 v9, v10, v11
    v_cvt_pk_bf16_f32 v10, v12, v13
    v_cvt_pk_bf16_f32 v11, v14, v15
    buffer_store_dwordx4 v[8:11], v245, s[24:27], s40 offen offset:1024 sc1
    v_cvt_pk_bf16_f32 v16, v16, v17
    v_cvt_pk_bf16_f32 v17, v18, v19
    v_cvt_pk_bf16_f32 v18, v20, v21
    v_cvt_pk_bf16_f32 v19, v22, v23
    buffer_store_dwordx4 v[16:19], v245, s[24:27], s40 offen offset:2048 sc1
    v_cvt_pk_bf16_f32 v24, v24, v25
    v_cvt_pk_bf16_f32 v25, v26, v27
    v_cvt_pk_bf16_f32 v26, v28, v29
    v_cvt_pk_bf16_f32 v27, v30, v31
    buffer_store_dwordx4 v[24:27], v245, s[24:27], s41 offen offset:0 sc1
    v_cvt_pk_bf16_f32 v32, v32, v33
    v_cvt_pk_bf16_f32 v33, v34, v35
    v_cvt_pk_bf16_f32 v34, v36, v37
    v_cvt_pk_bf16_f32 v35, v38, v39
    buffer_store_dwordx4 v[32:35], v245, s[24:27], s41 offen offset:1024 sc1
    v_cvt_pk_bf16_f32 v40, v40, v41
    v_cvt_pk_bf16_f32 v41, v42, v43
    v_cvt_pk_bf16_f32 v42, v44, v45
    v_cvt_pk_bf16_f32 v43, v46, v47
    buffer_store_dwordx4 v[40:43], v245, s[24:27], s41 offen offset:2048 sc1
    v_cvt_pk_bf16_f32 v48, v48, v49
    v_cvt_pk_bf16_f32 v49, v50, v51
    v_cvt_pk_bf16_f32 v50, v52, v53
    v_cvt_pk_bf16_f32 v51, v54, v55
    buffer_store_dwordx4 v[48:51], v245, s[24:27], s42 offen offset:0 sc1
    v_cvt_pk_bf16_f32 v56, v56, v57
    v_cvt_pk_bf16_f32 v57, v58, v59
    v_cvt_pk_bf16_f32 v58, v60, v61
    v_cvt_pk_bf16_f32 v59, v62, v63
    buffer_store_dwordx4 v[56:59], v245, s[24:27], s42 offen offset:1024 sc1
    v_cvt_pk_bf16_f32 v64, v64, v65
    v_cvt_pk_bf16_f32 v65, v66, v67
    v_cvt_pk_bf16_f32 v66, v68, v69
    v_cvt_pk_bf16_f32 v67, v70, v71
    buffer_store_dwordx4 v[64:67], v245, s[24:27], s42 offen offset:2048 sc1
    ds_write_b128 v158, v[72:75] offset:0
    ds_write_b128 v158, v[76:79] offset:1024
    ds_write_b128 v158, v[80:83] offset:2048
    ds_write_b128 v158, v[84:87] offset:3072
    ds_write_b128 v158, v[88:91] offset:4096
    ds_write_b128 v158, v[92:95] offset:5120
    s_waitcnt lgkmcnt(0)
    s_barrier
    s_mov_b64 exec, 1
    s_waitcnt vmcnt(6)
    buffer_atomic_add v100, v101, s[24:27], s56 offen offset:4
    s_waitcnt vmcnt(4)
    buffer_atomic_add v100, v101, s[24:27], s57 offen offset:8
    s_waitcnt vmcnt(2)
    buffer_atomic_add v100, v101, s[24:27], s58 offen offset:12
    s_mov_b64 exec, -1
    s_endpgm
KM_FLOAD:
    s_sub_u32 s34, s12, 4
    s_lshl_b32 s36, s34, 1
    s_add_u32 s36, s36, 0
    s_add_u32 s37, s36, s15
    s_add_u32 s37, s37, 1
    s_and_b32 s37, s37, 3
    s_and_b32 s36, s36, 4
    s_add_u32 s37, s37, s36
    s_lshl_b32 s36, s32, 3
    s_add_u32 s37, s37, s36
    s_mul_i32 s37, s37, 145
    s_mul_i32 s36, s15, 36
    s_add_u32 s37, s37, s36
    s_lshl_b32 s35, s37, 10
    s_lshl_b32 s36, s34, 1
    s_add_u32 s36, s36, 1
    s_add_u32 s37, s36, s15
    s_add_u32 s37, s37, 1
    s_and_b32 s37, s37, 3
    s_and_b32 s36, s36, 4
    s_add_u32 s37, s37, s36
    s_lshl_b32 s36, s32, 3
    s_add_u32 s37, s37, s36
    s_mul_i32 s37, s37, 145
    s_mul_i32 s36, s15, 36
    s_add_u32 s37, s37, s36
    s_lshl_b32 s40, s37, 10
    s_lshl_b32 s36, s34, 12
    s_mul_i32 s37, s15, 1152
    s_lshl_b32 s38, s34, 4
    s_add_u32 s37, s37, s38
    s_mul_i32 s37, s37, 1152
    s_mul_i32 s38, s33, 384
    s_add_u32 s37, s37, s38
    s_lshl_b32 s38, s34, 11
    s_add_u32 s38, s38, 16384
    s_setprio 0
    v_mul_f32 v200, v192, v200
    v_mul_f32 v192, v250, v192
    v_mul_f32 v201, v193, v201
    v_exp_f32 v192, v192
    v_mul_f32 v193, v250, v193
    v_mul_f32 v202, v194, v202
    v_add_f32 v192, 1.0, v192
    v_exp_f32 v193, v193
    v_mul_f32 v194, v250, v194
    v_mul_f32 v203, v195, v203
    v_rcp_f32 v192, v192
    v_add_f32 v193, 1.0, v193
    v_exp_f32 v194, v194
    v_mul_f32 v195, v250, v195
    v_mul_f32 v204, v196, v204
    v_mul_f32 v200, v192, v200
    v_rcp_f32 v193, v193
    v_add_f32 v194, 1.0, v194
    v_exp_f32 v195, v195
    v_mul_f32 v196, v250, v196
    v_mul_f32 v205, v197, v205
    v_mul_f32 v201, v193, v201
    v_rcp_f32 v194, v194
    v_add_f32 v195, 1.0, v195
    v_exp_f32 v196, v196
    v_mul_f32 v197, v250, v197
    v_mul_f32 v206, v198, v206
    v_mul_f32 v202, v194, v202
    v_rcp_f32 v195, v195
    v_add_f32 v196, 1.0, v196
    v_exp_f32 v197, v197
    v_mul_f32 v198, v250, v198
    v_mul_f32 v207, v199, v207
    v_mul_f32 v203, v195, v203
    v_rcp_f32 v196, v196
    v_add_f32 v197, 1.0, v197
    v_exp_f32 v198, v198
    v_mul_f32 v199, v250, v199
    v_mul_f32 v204, v196, v204
    v_rcp_f32 v197, v197
    v_add_f32 v198, 1.0, v198
    v_exp_f32 v199, v199
    v_mul_f32 v205, v197, v205
    v_rcp_f32 v198, v198
    v_add_f32 v199, 1.0, v199
    v_mul_f32 v206, v198, v206
    v_rcp_f32 v199, v199
    s_nop 0
    v_mul_f32 v207, v199, v207
    v_cvt_pk_bf16_f32 v234, v200, v201
    v_cvt_pk_bf16_f32 v235, v202, v203
    v_cvt_pk_bf16_f32 v238, v204, v205
    v_cvt_pk_bf16_f32 v239, v206, v207
    buffer_store_dwordx4 v[232:235], v245, s[24:27], s43 offen sc1
    s_add_u32 s48, s43, 148480
    buffer_store_dwordx4 v[236:239], v245, s[24:27], s48 offen sc1
    s_waitcnt vmcnt(4)
    s_barrier
    v_mov_b32 v31, 159744
    s_mov_b32 s50, 8192
    s_mov_b32 s51, 294912
    s_add_u32 m0, s36, 0x14000
    s_add_u32 s41, s35, s50
    buffer_load_dwordx4 v245, s[24:27], s41 offen offset:0 sc1 lds
    buffer_load_dwordx4 v245, s[24:27], s41 offen offset:1024 sc1 lds
    s_add_u32 m0, s36, 0x14800
    s_add_u32 s41, s40, s50
    buffer_load_dwordx4 v245, s[24:27], s41 offen offset:0 sc1 lds
    buffer_load_dwordx4 v245, s[24:27], s41 offen offset:1024 sc1 lds
    s_add_u32 s51, s51, s37
    s_add_u32 m0, s38, 0x14000
    s_add_u32 s41, s51, 0
    buffer_load_dwordx4 v246, s[4:7], s41 offen lds
    s_add_u32 m0, s38, 0x16000
    s_add_u32 s41, s51, 128
    buffer_load_dwordx4 v246, s[4:7], s41 offen lds
    s_add_u32 m0, s38, 0x18000
    s_add_u32 s41, s51, 256
    buffer_load_dwordx4 v246, s[4:7], s41 offen lds
    s_add_u32 m0, s38, 0x14400
    s_add_u32 s41, s51, 9216
    buffer_load_dwordx4 v246, s[4:7], s41 offen lds
    s_add_u32 m0, s38, 0x16400
    s_add_u32 s41, s51, 9344
    buffer_load_dwordx4 v246, s[4:7], s41 offen lds
    s_add_u32 m0, s38, 0x18400
    s_add_u32 s41, s51, 9472
    buffer_load_dwordx4 v246, s[4:7], s41 offen lds
    s_barrier
    s_mov_b32 s50, 12288
    s_mov_b32 s51, 442368
    s_add_u32 m0, s36, 0x0
    s_add_u32 s41, s35, s50
    buffer_load_dwordx4 v245, s[24:27], s41 offen offset:0 sc1 lds
    buffer_load_dwordx4 v245, s[24:27], s41 offen offset:1024 sc1 lds
    s_add_u32 m0, s36, 0x800
    s_add_u32 s41, s40, s50
    buffer_load_dwordx4 v245, s[24:27], s41 offen offset:0 sc1 lds
    buffer_load_dwordx4 v245, s[24:27], s41 offen offset:1024 sc1 lds
    s_add_u32 s51, s51, s37
    s_add_u32 m0, s38, 0x0
    s_add_u32 s41, s51, 0
    buffer_load_dwordx4 v246, s[4:7], s41 offen lds
    s_add_u32 m0, s38, 0x2000
    s_add_u32 s41, s51, 128
    buffer_load_dwordx4 v246, s[4:7], s41 offen lds
    s_add_u32 m0, s38, 0x4000
    s_add_u32 s41, s51, 256
    buffer_load_dwordx4 v246, s[4:7], s41 offen lds
    s_add_u32 m0, s38, 0x400
    s_add_u32 s41, s51, 9216
    buffer_load_dwordx4 v246, s[4:7], s41 offen lds
    s_add_u32 m0, s38, 0x2400
    s_add_u32 s41, s51, 9344
    buffer_load_dwordx4 v246, s[4:7], s41 offen lds
    s_add_u32 m0, s38, 0x4400
    s_add_u32 s41, s51, 9472
    buffer_load_dwordx4 v246, s[4:7], s41 offen lds
    s_waitcnt vmcnt(10)
    s_barrier
    s_mov_b32 s50, 18432
    s_mov_b32 s51, 663552
    s_add_u32 m0, s36, 0xa000
    s_add_u32 s41, s35, s50
    buffer_load_dwordx4 v245, s[24:27], s41 offen offset:0 sc1 lds
    buffer_load_dwordx4 v245, s[24:27], s41 offen offset:1024 sc1 lds
    s_add_u32 m0, s36, 0xa800
    s_add_u32 s41, s40, s50
    buffer_load_dwordx4 v245, s[24:27], s41 offen offset:0 sc1 lds
    buffer_load_dwordx4 v245, s[24:27], s41 offen offset:1024 sc1 lds
    s_add_u32 s51, s51, s37
    s_add_u32 m0, s38, 0xa000
    s_add_u32 s41, s51, 0
    buffer_load_dwordx4 v246, s[4:7], s41 offen lds
    s_add_u32 m0, s38, 0xc000
    s_add_u32 s41, s51, 128
    buffer_load_dwordx4 v246, s[4:7], s41 offen lds
    s_add_u32 m0, s38, 0xe000
    s_add_u32 s41, s51, 256
    buffer_load_dwordx4 v246, s[4:7], s41 offen lds
    s_add_u32 m0, s38, 0xa400
    s_add_u32 s41, s51, 9216
    buffer_load_dwordx4 v246, s[4:7], s41 offen lds
    s_add_u32 m0, s38, 0xc400
    s_add_u32 s41, s51, 9344
    buffer_load_dwordx4 v246, s[4:7], s41 offen lds
    s_add_u32 m0, s38, 0xe400
    s_add_u32 s41, s51, 9472
    buffer_load_dwordx4 v246, s[4:7], s41 offen lds
    s_waitcnt vmcnt(10)
    s_barrier
    s_mov_b32 s50, 22528
    s_mov_b32 s51, 811008
    s_add_u32 m0, s36, 0x14000
    s_add_u32 s41, s35, s50
    buffer_load_dwordx4 v245, s[24:27], s41 offen offset:0 sc1 lds
    buffer_load_dwordx4 v245, s[24:27], s41 offen offset:1024 sc1 lds
    s_add_u32 m0, s36, 0x14800
    s_add_u32 s41, s40, s50
    buffer_load_dwordx4 v245, s[24:27], s41 offen offset:0 sc1 lds
    buffer_load_dwordx4 v245, s[24:27], s41 offen offset:1024 sc1 lds
    s_add_u32 s51, s51, s37
    s_add_u32 m0, s38, 0x14000
    s_add_u32 s41, s51, 0
    buffer_load_dwordx4 v246, s[4:7], s41 offen lds
    s_add_u32 m0, s38, 0x16000
    s_add_u32 s41, s51, 128
    buffer_load_dwordx4 v246, s[4:7], s41 offen lds
    s_add_u32 m0, s38, 0x18000
    s_add_u32 s41, s51, 256
    buffer_load_dwordx4 v246, s[4:7], s41 offen lds
    s_add_u32 m0, s38, 0x14400
    s_add_u32 s41, s51, 9216
    buffer_load_dwordx4 v246, s[4:7], s41 offen lds
    s_add_u32 m0, s38, 0x16400
    s_add_u32 s41, s51, 9344
    buffer_load_dwordx4 v246, s[4:7], s41 offen lds
    s_add_u32 m0, s38, 0x18400
    s_add_u32 s41, s51, 9472
    buffer_load_dwordx4 v246, s[4:7], s41 offen lds
    s_waitcnt vmcnt(10)
    s_barrier
    s_mov_b32 s50, 26624
    s_mov_b32 s51, 958464
    s_add_u32 m0, s36, 0x0
    s_add_u32 s41, s35, s50
    buffer_load_dwordx4 v245, s[24:27], s41 offen offset:0 sc1 lds
    buffer_load_dwordx4 v245, s[24:27], s41 offen offset:1024 sc1 lds
    s_add_u32 m0, s36, 0x800
    s_add_u32 s41, s40, s50
    buffer_load_dwordx4 v245, s[24:27], s41 offen offset:0 sc1 lds
    buffer_load_dwordx4 v245, s[24:27], s41 offen offset:1024 sc1 lds
    s_add_u32 s51, s51, s37
    s_add_u32 m0, s38, 0x0
    s_add_u32 s41, s51, 0
    buffer_load_dwordx4 v246, s[4:7], s41 offen lds
    s_add_u32 m0, s38, 0x2000
    s_add_u32 s41, s51, 128
    buffer_load_dwordx4 v246, s[4:7], s41 offen lds
    s_add_u32 m0, s38, 0x4000
    s_add_u32 s41, s51, 256
    buffer_load_dwordx4 v246, s[4:7], s41 offen lds
    s_add_u32 m0, s38, 0x400
    s_add_u32 s41, s51, 9216
    buffer_load_dwordx4 v246, s[4:7], s41 offen lds
    s_add_u32 m0, s38, 0x2400
    s_add_u32 s41, s51, 9344
    buffer_load_dwordx4 v246, s[4:7], s41 offen lds
    s_add_u32 m0, s38, 0x4400
    s_add_u32 s41, s51, 9472
    buffer_load_dwordx4 v246, s[4:7], s41 offen lds
    s_waitcnt vmcnt(10)
    s_barrier
    s_mov_b32 s50, 30720
    s_mov_b32 s51, 1105920
    s_add_u32 m0, s36, 0xa000
    s_add_u32 s41, s35, s50
    buffer_load_dwordx4 v245, s[24:27], s41 offen offset:0 sc1 lds
    buffer_load_dwordx4 v245, s[24:27], s41 offen offset:1024 sc1 lds
    s_add_u32 m0, s36, 0xa800
    s_add_u32 s41, s40, s50
    buffer_load_dwordx4 v245, s[24:27], s41 offen offset:0 sc1 lds
    buffer_load_dwordx4 v245, s[24:27], s41 offen offset:1024 sc1 lds
    s_add_u32 s51, s51, s37
    s_add_u32 m0, s38, 0xa000
    s_add_u32 s41, s51, 0
    buffer_load_dwordx4 v246, s[4:7], s41 offen lds
    s_add_u32 m0, s38, 0xc000
    s_add_u32 s41, s51, 128
    buffer_load_dwordx4 v246, s[4:7], s41 offen lds
    s_add_u32 m0, s38, 0xe000
    s_add_u32 s41, s51, 256
    buffer_load_dwordx4 v246, s[4:7], s41 offen lds
    s_add_u32 m0, s38, 0xa400
    s_add_u32 s41, s51, 9216
    buffer_load_dwordx4 v246, s[4:7], s41 offen lds
    s_add_u32 m0, s38, 0xc400
    s_add_u32 s41, s51, 9344
    buffer_load_dwordx4 v246, s[4:7], s41 offen lds
    s_add_u32 m0, s38, 0xe400
    s_add_u32 s41, s51, 9472
    buffer_load_dwordx4 v246, s[4:7], s41 offen lds
    s_waitcnt vmcnt(10)
    s_barrier
    s_mov_b32 s50, 16384
    s_mov_b32 s51, 589824
    s_add_u32 m0, s36, 0x14000
    s_add_u32 s41, s35, s50
    buffer_load_dwordx4 v245, s[24:27], s41 offen offset:0 sc1 lds
    buffer_load_dwordx4 v245, s[24:27], s41 offen offset:1024 sc1 lds
    s_add_u32 m0, s36, 0x14800
    s_add_u32 s41, s40, s50
    buffer_load_dwordx4 v245, s[24:27], s41 offen offset:0 sc1 lds
    buffer_load_dwordx4 v245, s[24:27], s41 offen offset:1024 sc1 lds
    s_add_u32 s51, s51, s37
    s_add_u32 m0, s38, 0x14000
    s_add_u32 s41, s51, 0
    buffer_load_dwordx4 v246, s[4:7], s41 offen lds
    s_add_u32 m0, s38, 0x16000
    s_add_u32 s41, s51, 128
    buffer_load_dwordx4 v246, s[4:7], s41 offen lds
    s_add_u32 m0, s38, 0x18000
    s_add_u32 s41, s51, 256
    buffer_load_dwordx4 v246, s[4:7], s41 offen lds
    s_add_u32 m0, s38, 0x14400
    s_add_u32 s41, s51, 9216
    buffer_load_dwordx4 v246, s[4:7], s41 offen lds
    s_add_u32 m0, s38, 0x16400
    s_add_u32 s41, s51, 9344
    buffer_load_dwordx4 v246, s[4:7], s41 offen lds
    s_add_u32 m0, s38, 0x18400
    s_add_u32 s41, s51, 9472
    buffer_load_dwordx4 v246, s[4:7], s41 offen lds
    s_waitcnt vmcnt(10)
    s_barrier
    s_mov_b32 s50, 34816
    s_mov_b32 s51, 1253376
    s_add_u32 m0, s36, 0x0
    s_add_u32 s41, s35, s50
    buffer_load_dwordx4 v245, s[24:27], s41 offen offset:0 sc1 lds
    buffer_load_dwordx4 v245, s[24:27], s41 offen offset:1024 sc1 lds
    s_add_u32 m0, s36, 0x800
    s_add_u32 s41, s40, s50
    buffer_load_dwordx4 v245, s[24:27], s41 offen offset:0 sc1 lds
    buffer_load_dwordx4 v245, s[24:27], s41 offen offset:1024 sc1 lds
    s_add_u32 s51, s51, s37
    s_add_u32 m0, s38, 0x0
    s_add_u32 s41, s51, 0
    buffer_load_dwordx4 v246, s[4:7], s41 offen lds
    s_add_u32 m0, s38, 0x2000
    s_add_u32 s41, s51, 128
    buffer_load_dwordx4 v246, s[4:7], s41 offen lds
    s_add_u32 m0, s38, 0x4000
    s_add_u32 s41, s51, 256
    buffer_load_dwordx4 v246, s[4:7], s41 offen lds
    s_add_u32 m0, s38, 0x400
    s_add_u32 s41, s51, 9216
    buffer_load_dwordx4 v246, s[4:7], s41 offen lds
    s_add_u32 m0, s38, 0x2400
    s_add_u32 s41, s51, 9344
    buffer_load_dwordx4 v246, s[4:7], s41 offen lds
    s_add_u32 m0, s38, 0x4400
    s_add_u32 s41, s51, 9472
    buffer_load_dwordx4 v246, s[4:7], s41 offen lds
    s_waitcnt vmcnt(10)
    s_barrier
    s_mov_b32 s50, 2048
    s_mov_b32 s51, 73728
    s_add_u32 m0, s36, 0xa000
    s_add_u32 s41, s35, s50
    buffer_load_dwordx4 v245, s[24:27], s41 offen offset:0 sc1 lds
    buffer_load_dwordx4 v245, s[24:27], s41 offen offset:1024 sc1 lds
    s_add_u32 m0, s36, 0xa800
    s_add_u32 s41, s40, s50
    buffer_load_dwordx4 v245, s[24:27], s41 offen offset:0 sc1 lds
    buffer_load_dwordx4 v245, s[24:27], s41 offen offset:1024 sc1 lds
    s_add_u32 s51, s51, s37
    s_add_u32 m0, s38, 0xa000
    s_add_u32 s41, s51, 0
    buffer_load_dwordx4 v246, s[4:7], s41 offen lds
    s_add_u32 m0, s38, 0xc000
    s_add_u32 s41, s51, 128
    buffer_load_dwordx4 v246, s[4:7], s41 offen lds
    s_add_u32 m0, s38, 0xe000
    s_add_u32 s41, s51, 256
    buffer_load_dwordx4 v246, s[4:7], s41 offen lds
    s_add_u32 m0, s38, 0xa400
    s_add_u32 s41, s51, 9216
    buffer_load_dwordx4 v246, s[4:7], s41 offen lds
    s_add_u32 m0, s38, 0xc400
    s_add_u32 s41, s51, 9344
    buffer_load_dwordx4 v246, s[4:7], s41 offen lds
    s_add_u32 m0, s38, 0xe400
    s_add_u32 s41, s51, 9472
    buffer_load_dwordx4 v246, s[4:7], s41 offen lds
    s_waitcnt vmcnt(10)
    s_barrier
    s_mov_b32 s50, 6144
    s_mov_b32 s51, 221184
    s_add_u32 m0, s36, 0x14000
    s_add_u32 s41, s35, s50
    buffer_load_dwordx4 v245, s[24:27], s41 offen offset:0 sc1 lds
    buffer_load_dwordx4 v245, s[24:27], s41 offen offset:1024 sc1 lds
    s_add_u32 m0, s36, 0x14800
    s_add_u32 s41, s40, s50
    buffer_load_dwordx4 v245, s[24:27], s41 offen offset:0 sc1 lds
    buffer_load_dwordx4 v245, s[24:27], s41 offen offset:1024 sc1 lds
    s_add_u32 s51, s51, s37
    s_add_u32 m0, s38, 0x14000
    s_add_u32 s41, s51, 0
    buffer_load_dwordx4 v246, s[4:7], s41 offen lds
    s_add_u32 m0, s38, 0x16000
    s_add_u32 s41, s51, 128
    buffer_load_dwordx4 v246, s[4:7], s41 offen lds
    s_add_u32 m0, s38, 0x18000
    s_add_u32 s41, s51, 256
    buffer_load_dwordx4 v246, s[4:7], s41 offen lds
    s_add_u32 m0, s38, 0x14400
    s_add_u32 s41, s51, 9216
    buffer_load_dwordx4 v246, s[4:7], s41 offen lds
    s_add_u32 m0, s38, 0x16400
    s_add_u32 s41, s51, 9344
    buffer_load_dwordx4 v246, s[4:7], s41 offen lds
    s_add_u32 m0, s38, 0x18400
    s_add_u32 s41, s51, 9472
    buffer_load_dwordx4 v246, s[4:7], s41 offen lds
    s_waitcnt vmcnt(10)
    s_barrier
    s_mov_b32 s50, 10240
    s_mov_b32 s51, 368640
    s_add_u32 m0, s36, 0x0
    s_add_u32 s41, s35, s50
    buffer_load_dwordx4 v245, s[24:27], s41 offen offset:0 sc1 lds
    buffer_load_dwordx4 v245, s[24:27], s41 offen offset:1024 sc1 lds
    s_add_u32 m0, s36, 0x800
    s_add_u32 s41, s40, s50
    buffer_load_dwordx4 v245, s[24:27], s41 offen offset:0 sc1 lds
    buffer_load_dwordx4 v245, s[24:27], s41 offen offset:1024 sc1 lds
    s_add_u32 s51, s51, s37
    s_add_u32 m0, s38, 0x0
    s_add_u32 s41, s51, 0
    buffer_load_dwordx4 v246, s[4:7], s41 offen lds
    s_add_u32 m0, s38, 0x2000
    s_add_u32 s41, s51, 128
    buffer_load_dwordx4 v246, s[4:7], s41 offen lds
    s_add_u32 m0, s38, 0x4000
    s_add_u32 s41, s51, 256
    buffer_load_dwordx4 v246, s[4:7], s41 offen lds
    s_add_u32 m0, s38, 0x400
    s_add_u32 s41, s51, 9216
    buffer_load_dwordx4 v246, s[4:7], s41 offen lds
    s_add_u32 m0, s38, 0x2400
    s_add_u32 s41, s51, 9344
    buffer_load_dwordx4 v246, s[4:7], s41 offen lds
    s_add_u32 m0, s38, 0x4400
    s_add_u32 s41, s51, 9472
    buffer_load_dwordx4 v246, s[4:7], s41 offen lds
    s_load_dwordx2 s[16:17], s[0:1], 0
    s_load_dwordx2 s[20:21], s[0:1], 56
    s_mov_b32 s18, 0x240000
    s_mov_b32 s19, 0x00020000
    s_mov_b32 s22, 0x240000
    s_mov_b32 s23, 0x00020000
    s_and_b32 s30, s34, 1
    s_lshr_b32 s44, s34, 1
    s_lshl_b32 s42, s32, 3
    s_lshl_b32 s43, s30, 2
    s_add_u32 s42, s42, s43
    s_add_u32 s42, s42, s15
    s_mul_i32 s52, s33, 6
    s_mul_i32 s43, s44, 3
    s_add_u32 s52, s52, s43
    s_mul_i32 s53, s42, 18
    s_add_u32 s53, s53, s52
    s_lshl_b32 s53, s53, 10
    s_add_u32 s53, s53, 0x1a00000
    s_mul_i32 s54, s42, 18432
    s_lshl_b32 s43, s52, 6
    s_add_u32 s54, s54, s43
    v_add_u32 v4, 0, v249
    v_mul_u32_u24 v5, 171, v4
    v_lshrrev_b32 v5, 11, v5
    v_mul_u32_u24 v5, 960, v5
    v_lshl_add_u32 v20, v4, 4, v5
    v_add_u32 v4, 64, v249
    v_mul_u32_u24 v5, 171, v4
    v_lshrrev_b32 v5, 11, v5
    v_mul_u32_u24 v5, 960, v5
    v_lshl_add_u32 v21, v4, 4, v5
    v_add_u32 v4, 128, v249
    v_mul_u32_u24 v5, 171, v4
    v_lshrrev_b32 v5, 11, v5
    v_mul_u32_u24 v5, 960, v5
    v_lshl_add_u32 v22, v4, 4, v5
    s_mul_i32 s46, s34, 3072
    s_add_u32 s46, s46, 147456
    v_and_b32 v2, 15, v249
    v_mul_u32_u24 v2, 192, v2
    v_lshrrev_b32 v5, 4, v249
    v_lshl_add_u32 v2, v5, 3, v2
    v_add_u32 v2, s46, v2
    v_add_u32 v4, s46, v245
    v_mov_b32 v6, 0
    s_mul_i32 s43, s34, 6144
    s_add_u32 s43, s43, 122880
    v_add_u32 v7, s43, v245
    s_mul_i32 s56, s32, 3
    s_add_u32 s56, s56, s33
    s_lshl_b32 s56, s56, 2
    s_add_u32 s56, s56, s15
    s_lshl_b32 s56, s56, 2
    s_add_u32 s56, s56, s34
    s_lshl_b32 s56, s56, 7
    s_add_u32 s56, s56, 0x2780000
    s_waitcnt lgkmcnt(0)
    s_and_b32 s17, s17, 0xffff
    s_and_b32 s21, s21, 0xffff
    s_waitcnt vmcnt(10)
    s_barrier
    s_mov_b32 s50, 14336
    s_mov_b32 s51, 516096
    s_add_u32 m0, s36, 0xa000
    s_add_u32 s41, s35, s50
    buffer_load_dwordx4 v245, s[24:27], s41 offen offset:0 sc1 lds
    buffer_load_dwordx4 v245, s[24:27], s41 offen offset:1024 sc1 lds
    s_add_u32 m0, s36, 0xa800
    s_add_u32 s41, s40, s50
    buffer_load_dwordx4 v245, s[24:27], s41 offen offset:0 sc1 lds
    buffer_load_dwordx4 v245, s[24:27], s41 offen offset:1024 sc1 lds
    s_add_u32 s51, s51, s37
    s_add_u32 m0, s38, 0xa000
    s_add_u32 s41, s51, 0
    buffer_load_dwordx4 v246, s[4:7], s41 offen lds
    s_add_u32 m0, s38, 0xc000
    s_add_u32 s41, s51, 128
    buffer_load_dwordx4 v246, s[4:7], s41 offen lds
    s_add_u32 m0, s38, 0xe000
    s_add_u32 s41, s51, 256
    buffer_load_dwordx4 v246, s[4:7], s41 offen lds
    s_add_u32 m0, s38, 0xa400
    s_add_u32 s41, s51, 9216
    buffer_load_dwordx4 v246, s[4:7], s41 offen lds
    s_add_u32 m0, s38, 0xc400
    s_add_u32 s41, s51, 9344
    buffer_load_dwordx4 v246, s[4:7], s41 offen lds
    s_add_u32 m0, s38, 0xe400
    s_add_u32 s41, s51, 9472
    buffer_load_dwordx4 v246, s[4:7], s41 offen lds
    s_waitcnt vmcnt(10)
    s_barrier
    s_mov_b32 s50, 20480
    s_mov_b32 s51, 737280
    s_add_u32 m0, s36, 0x14000
    s_add_u32 s41, s35, s50
    buffer_load_dwordx4 v245, s[24:27], s41 offen offset:0 sc1 lds
    buffer_load_dwordx4 v245, s[24:27], s41 offen offset:1024 sc1 lds
    s_add_u32 m0, s36, 0x14800
    s_add_u32 s41, s40, s50
    buffer_load_dwordx4 v245, s[24:27], s41 offen offset:0 sc1 lds
    buffer_load_dwordx4 v245, s[24:27], s41 offen offset:1024 sc1 lds
    s_add_u32 s51, s51, s37
    s_add_u32 m0, s38, 0x14000
    s_add_u32 s41, s51, 0
    buffer_load_dwordx4 v246, s[4:7], s41 offen lds
    s_add_u32 m0, s38, 0x16000
    s_add_u32 s41, s51, 128
    buffer_load_dwordx4 v246, s[4:7], s41 offen lds
    s_add_u32 m0, s38, 0x18000
    s_add_u32 s41, s51, 256
    buffer_load_dwordx4 v246, s[4:7], s41 offen lds
    s_add_u32 m0, s38, 0x14400
    s_add_u32 s41, s51, 9216
    buffer_load_dwordx4 v246, s[4:7], s41 offen lds
    s_add_u32 m0, s38, 0x16400
    s_add_u32 s41, s51, 9344
    buffer_load_dwordx4 v246, s[4:7], s41 offen lds
    s_add_u32 m0, s38, 0x18400
    s_add_u32 s41, s51, 9472
    buffer_load_dwordx4 v246, s[4:7], s41 offen lds
    s_waitcnt vmcnt(10)
    s_barrier
    s_mov_b32 s50, 24576
    s_mov_b32 s51, 884736
    s_add_u32 m0, s36, 0x0
    s_add_u32 s41, s35, s50
    buffer_load_dwordx4 v245, s[24:27], s41 offen offset:0 sc1 lds
    buffer_load_dwordx4 v245, s[24:27], s41 offen offset:1024 sc1 lds
    s_add_u32 m0, s36, 0x800
    s_add_u32 s41, s40, s50
    buffer_load_dwordx4 v245, s[24:27], s41 offen offset:0 sc1 lds
    buffer_load_dwordx4 v245, s[24:27], s41 offen offset:1024 sc1 lds
    s_add_u32 s51, s51, s37
    s_add_u32 m0, s38, 0x0
    s_add_u32 s41, s51, 0
    buffer_load_dwordx4 v246, s[4:7], s41 offen lds
    s_add_u32 m0, s38, 0x2000
    s_add_u32 s41, s51, 128
    buffer_load_dwordx4 v246, s[4:7], s41 offen lds
    s_add_u32 m0, s38, 0x4000
    s_add_u32 s41, s51, 256
    buffer_load_dwordx4 v246, s[4:7], s41 offen lds
    s_add_u32 m0, s38, 0x400
    s_add_u32 s41, s51, 9216
    buffer_load_dwordx4 v246, s[4:7], s41 offen lds
    s_add_u32 m0, s38, 0x2400
    s_add_u32 s41, s51, 9344
    buffer_load_dwordx4 v246, s[4:7], s41 offen lds
    s_add_u32 m0, s38, 0x4400
    s_add_u32 s41, s51, 9472
    buffer_load_dwordx4 v246, s[4:7], s41 offen lds
    s_waitcnt vmcnt(10)
    s_barrier
    s_mov_b32 s50, 28672
    s_mov_b32 s51, 1032192
    s_add_u32 m0, s36, 0xa000
    s_add_u32 s41, s35, s50
    buffer_load_dwordx4 v245, s[24:27], s41 offen offset:0 sc1 lds
    buffer_load_dwordx4 v245, s[24:27], s41 offen offset:1024 sc1 lds
    s_add_u32 m0, s36, 0xa800
    s_add_u32 s41, s40, s50
    buffer_load_dwordx4 v245, s[24:27], s41 offen offset:0 sc1 lds
    buffer_load_dwordx4 v245, s[24:27], s41 offen offset:1024 sc1 lds
    s_add_u32 s51, s51, s37
    s_add_u32 m0, s38, 0xa000
    s_add_u32 s41, s51, 0
    buffer_load_dwordx4 v246, s[4:7], s41 offen lds
    s_add_u32 m0, s38, 0xc000
    s_add_u32 s41, s51, 128
    buffer_load_dwordx4 v246, s[4:7], s41 offen lds
    s_add_u32 m0, s38, 0xe000
    s_add_u32 s41, s51, 256
    buffer_load_dwordx4 v246, s[4:7], s41 offen lds
    s_add_u32 m0, s38, 0xa400
    s_add_u32 s41, s51, 9216
    buffer_load_dwordx4 v246, s[4:7], s41 offen lds
    s_add_u32 m0, s38, 0xc400
    s_add_u32 s41, s51, 9344
    buffer_load_dwordx4 v246, s[4:7], s41 offen lds
    s_add_u32 m0, s38, 0xe400
    s_add_u32 s41, s51, 9472
    buffer_load_dwordx4 v246, s[4:7], s41 offen lds
    s_waitcnt vmcnt(10)
    s_barrier
    s_mov_b32 s50, 32768
    s_mov_b32 s51, 1179648
    s_add_u32 m0, s36, 0x14000
    s_add_u32 s41, s35, s50
    buffer_load_dwordx4 v245, s[24:27], s41 offen offset:0 sc1 lds
    buffer_load_dwordx4 v245, s[24:27], s41 offen offset:1024 sc1 lds
    s_add_u32 m0, s36, 0x14800
    s_add_u32 s41, s40, s50
    buffer_load_dwordx4 v245, s[24:27], s41 offen offset:0 sc1 lds
    buffer_load_dwordx4 v245, s[24:27], s41 offen offset:1024 sc1 lds
    s_add_u32 s51, s51, s37
    s_add_u32 m0, s38, 0x14000
    s_add_u32 s41, s51, 0
    buffer_load_dwordx4 v246, s[4:7], s41 offen lds
    s_add_u32 m0, s38, 0x16000
    s_add_u32 s41, s51, 128
    buffer_load_dwordx4 v246, s[4:7], s41 offen lds
    s_add_u32 m0, s38, 0x18000
    s_add_u32 s41, s51, 256
    buffer_load_dwordx4 v246, s[4:7], s41 offen lds
    s_add_u32 m0, s38, 0x14400
    s_add_u32 s41, s51, 9216
    buffer_load_dwordx4 v246, s[4:7], s41 offen lds
    s_add_u32 m0, s38, 0x16400
    s_add_u32 s41, s51, 9344
    buffer_load_dwordx4 v246, s[4:7], s41 offen lds
    s_add_u32 m0, s38, 0x18400
    s_add_u32 s41, s51, 9472
    buffer_load_dwordx4 v246, s[4:7], s41 offen lds
    s_waitcnt vmcnt(10)
    s_barrier
KM_LFIN:
    s_add_u32 m0, s46, 0
    s_nop 0
    buffer_load_dwordx4 v20, s[16:19], s54 offen lds
    s_add_u32 m0, s46, 1024
    s_nop 0
    buffer_load_dwordx4 v21, s[16:19], s54 offen lds
    s_add_u32 m0, s46, 2048
    s_nop 0
    buffer_load_dwordx4 v22, s[16:19], s54 offen lds
    s_waitcnt vmcnt(3)
    s_barrier
    s_mov_b64 exec, 1
    v_mov_b32 v3, 0
    buffer_atomic_add v3, v6, s[24:27], s56 offen sc0
    s_mov_b64 exec, -1
    v_lshlrev_b32 v6, 2, v249
    v_mov_b32 v5, 1
    v_writelane_b32 v5, 8, 0
    s_waitcnt vmcnt(0)
    ds_read_b64 v[8:9], v2 offset:0
    ds_read_b64 v[10:11], v2 offset:32
    ds_read_b64 v[12:13], v2 offset:64
    ds_read_b64 v[14:15], v2 offset:96
    ds_read_b64 v[16:17], v2 offset:128
    ds_read_b64 v[18:19], v2 offset:160
    v_readfirstlane_b32 s59, v3
    s_nop 3
    s_cmp_lt_u32 s59, 8
    s_cbranch_scc1 KM_RNOEARLY
    s_add_u32 s58, s53, 0x900000
    buffer_load_dwordx4 v[140:143], v245, s[24:27], s58 offen offset:0 sc1
    buffer_load_dwordx4 v[144:147], v245, s[24:27], s58 offen offset:1024 sc1
    buffer_load_dwordx4 v[148:151], v245, s[24:27], s58 offen offset:2048 sc1
    s_add_u32 s58, s53, 0xb40000
    buffer_load_dwordx4 v[152:155], v245, s[24:27], s58 offen offset:0 sc1
    buffer_load_dwordx4 v[156:159], v245, s[24:27], s58 offen offset:1024 sc1
    buffer_load_dwordx4 v[160:163], v245, s[24:27], s58 offen offset:2048 sc1
KM_RNOEARLY:
    s_barrier
    s_mov_b32 s57, 0x100000
    s_mov_b64 exec, 0xf
KM_RPX:
    v_mov_b32 v3, 0
    buffer_atomic_add v3, v6, s[24:27], s56 offen sc0
    s_waitcnt vmcnt(0)
    v_cmp_ge_u32 vcc, v3, v5
    s_sub_u32 s57, s57, 1
    s_cbranch_scc1 KM_RPX_X
    s_cmp_eq_u64 vcc, exec
    s_cbranch_scc0 KM_RPX
KM_RPX_X:
    s_mov_b64 exec, -1
    s_cmp_lt_u32 s59, 8
    s_cbranch_scc0 KM_RNOLATE
    s_add_u32 s58, s53, 0x900000
    buffer_load_dwordx4 v[140:143], v245, s[24:27], s58 offen offset:0 sc1
    buffer_load_dwordx4 v[144:147], v245, s[24:27], s58 offen offset:1024 sc1
    buffer_load_dwordx4 v[148:151], v245, s[24:27], s58 offen offset:2048 sc1
    s_add_u32 s58, s53, 0xb40000
    buffer_load_dwordx4 v[152:155], v245, s[24:27], s58 offen offset:0 sc1
    buffer_load_dwordx4 v[156:159], v245, s[24:27], s58 offen offset:1024 sc1
    buffer_load_dwordx4 v[160:163], v245, s[24:27], s58 offen offset:2048 sc1
KM_RNOLATE:
    s_sub_u32 s58, s15, 1
    s_and_b32 s58, s58, 3
    s_mul_i32 s58, s58, 2359296
    s_add_u32 s58, s58, s53
    buffer_load_dwordx4 v[24:27], v245, s[24:27], s58 offen offset:0 sc1
    buffer_load_dwordx4 v[28:31], v245, s[24:27], s58 offen offset:1024 sc1
    buffer_load_dwordx4 v[32:35], v245, s[24:27], s58 offen offset:2048 sc1
    s_sub_u32 s58, s15, 2
    s_and_b32 s58, s58, 3
    s_mul_i32 s58, s58, 2359296
    s_add_u32 s58, s58, s53
    buffer_load_dwordx4 v[36:39], v245, s[24:27], s58 offen offset:0 sc1
    buffer_load_dwordx4 v[40:43], v245, s[24:27], s58 offen offset:1024 sc1
    buffer_load_dwordx4 v[44:47], v245, s[24:27], s58 offen offset:2048 sc1
    s_sub_u32 s58, s15, 3
    s_and_b32 s58, s58, 3
    s_mul_i32 s58, s58, 2359296
    s_add_u32 s58, s58, s53
    buffer_load_dwordx4 v[48:51], v245, s[24:27], s58 offen offset:0 sc1
    buffer_load_dwordx4 v[52:55], v245, s[24:27], s58 offen offset:1024 sc1
    buffer_load_dwordx4 v[56:59], v245, s[24:27], s58 offen offset:2048 sc1
    s_waitcnt lgkmcnt(0)
    v_lshlrev_b32 v100, 16, v8
    v_and_b32 v101, 0xffff0000, v8
    v_lshlrev_b32 v102, 16, v9
    v_and_b32 v103, 0xffff0000, v9
    v_lshlrev_b32 v104, 16, v10
    v_and_b32 v105, 0xffff0000, v10
    v_lshlrev_b32 v106, 16, v11
    v_and_b32 v107, 0xffff0000, v11
    v_lshlrev_b32 v108, 16, v12
    v_and_b32 v109, 0xffff0000, v12
    v_lshlrev_b32 v110, 16, v13
    v_and_b32 v111, 0xffff0000, v13
    v_lshlrev_b32 v112, 16, v14
    v_and_b32 v113, 0xffff0000, v14
    v_lshlrev_b32 v114, 16, v15
    v_and_b32 v115, 0xffff0000, v15
    v_lshlrev_b32 v116, 16, v16
    v_and_b32 v117, 0xffff0000, v16
    v_lshlrev_b32 v118, 16, v17
    v_and_b32 v119, 0xffff0000, v17
    v_lshlrev_b32 v120, 16, v18
    v_and_b32 v121, 0xffff0000, v18
    v_lshlrev_b32 v122, 16, v19
    v_and_b32 v123, 0xffff0000, v19
    ds_read_b128 v[64:67], v7 offset:0
    ds_read_b128 v[68:71], v7 offset:1024
    ds_read_b128 v[72:75], v7 offset:2048
    ds_read_b128 v[76:79], v7 offset:3072
    ds_read_b128 v[80:83], v7 offset:4096
    ds_read_b128 v[84:87], v7 offset:5120
    s_waitcnt lgkmcnt(0)
    v_add_f32 v100, v100, v64
    v_add_f32 v101, v101, v65
    v_add_f32 v102, v102, v66
    v_add_f32 v103, v103, v67
    v_add_f32 v104, v104, v68
    v_add_f32 v105, v105, v69
    v_add_f32 v106, v106, v70
    v_add_f32 v107, v107, v71
    v_add_f32 v108, v108, v72
    v_add_f32 v109, v109, v73
    v_add_f32 v110, v110, v74
    v_add_f32 v111, v111, v75
    v_add_f32 v112, v112, v76
    v_add_f32 v113, v113, v77
    v_add_f32 v114, v114, v78
    v_add_f32 v115, v115, v79
    v_add_f32 v116, v116, v80
    v_add_f32 v117, v117, v81
    v_add_f32 v118, v118, v82
    v_add_f32 v119, v119, v83
    v_add_f32 v120, v120, v84
    v_add_f32 v121, v121, v85
    v_add_f32 v122, v122, v86
    v_add_f32 v123, v123, v87
    s_waitcnt vmcnt(9)
    v_lshlrev_b32 v90, 16, v140
    v_and_b32 v91, 0xffff0000, v140
    v_add_f32 v100, v100, v90
    v_add_f32 v101, v101, v91
    v_lshlrev_b32 v90, 16, v141
    v_and_b32 v91, 0xffff0000, v141
    v_add_f32 v102, v102, v90
    v_add_f32 v103, v103, v91
    v_lshlrev_b32 v90, 16, v142
    v_and_b32 v91, 0xffff0000, v142
    v_add_f32 v104, v104, v90
    v_add_f32 v105, v105, v91
    v_lshlrev_b32 v90, 16, v143
    v_and_b32 v91, 0xffff0000, v143
    v_add_f32 v106, v106, v90
    v_add_f32 v107, v107, v91
    v_lshlrev_b32 v90, 16, v144
    v_and_b32 v91, 0xffff0000, v144
    v_add_f32 v108, v108, v90
    v_add_f32 v109, v109, v91
    v_lshlrev_b32 v90, 16, v145
    v_and_b32 v91, 0xffff0000, v145
    v_add_f32 v110, v110, v90
    v_add_f32 v111, v111, v91
    v_lshlrev_b32 v90, 16, v146
    v_and_b32 v91, 0xffff0000, v146
    v_add_f32 v112, v112, v90
    v_add_f32 v113, v113, v91
    v_lshlrev_b32 v90, 16, v147
    v_and_b32 v91, 0xffff0000, v147
    v_add_f32 v114, v114, v90
    v_add_f32 v115, v115, v91
    v_lshlrev_b32 v90, 16, v148
    v_and_b32 v91, 0xffff0000, v148
    v_add_f32 v116, v116, v90
    v_add_f32 v117, v117, v91
    v_lshlrev_b32 v90, 16, v149
    v_and_b32 v91, 0xffff0000, v149
    v_add_f32 v118, v118, v90
    v_add_f32 v119, v119, v91
    v_lshlrev_b32 v90, 16, v150
    v_and_b32 v91, 0xffff0000, v150
    v_add_f32 v120, v120, v90
    v_add_f32 v121, v121, v91
    v_lshlrev_b32 v90, 16, v151
    v_and_b32 v91, 0xffff0000, v151
    v_add_f32 v122, v122, v90
    v_add_f32 v123, v123, v91
    v_lshlrev_b32 v90, 16, v152
    v_and_b32 v91, 0xffff0000, v152
    v_add_f32 v100, v100, v90
    v_add_f32 v101, v101, v91
    v_lshlrev_b32 v90, 16, v153
    v_and_b32 v91, 0xffff0000, v153
    v_add_f32 v102, v102, v90
    v_add_f32 v103, v103, v91
    v_lshlrev_b32 v90, 16, v154
    v_and_b32 v91, 0xffff0000, v154
    v_add_f32 v104, v104, v90
    v_add_f32 v105, v105, v91
    v_lshlrev_b32 v90, 16, v155
    v_and_b32 v91, 0xffff0000, v155
    v_add_f32 v106, v106, v90
    v_add_f32 v107, v107, v91
    v_lshlrev_b32 v90, 16, v156
    v_and_b32 v91, 0xffff0000, v156
    v_add_f32 v108, v108, v90
    v_add_f32 v109, v109, v91
    v_lshlrev_b32 v90, 16, v157
    v_and_b32 v91, 0xffff0000, v157
    v_add_f32 v110, v110, v90
    v_add_f32 v111, v111, v91
    v_lshlrev_b32 v90, 16, v158
    v_and_b32 v91, 0xffff0000, v158
    v_add_f32 v112, v112, v90
    v_add_f32 v113, v113, v91
    v_lshlrev_b32 v90, 16, v159
    v_and_b32 v91, 0xffff0000, v159
    v_add_f32 v114, v114, v90
    v_add_f32 v115, v115, v91
    v_lshlrev_b32 v90, 16, v160
    v_and_b32 v91, 0xffff0000, v160
    v_add_f32 v116, v116, v90
    v_add_f32 v117, v117, v91
    v_lshlrev_b32 v90, 16, v161
    v_and_b32 v91, 0xffff0000, v161
    v_add_f32 v118, v118, v90
    v_add_f32 v119, v119, v91
    v_lshlrev_b32 v90, 16, v162
    v_and_b32 v91, 0xffff0000, v162
    v_add_f32 v120, v120, v90
    v_add_f32 v121, v121, v91
    v_lshlrev_b32 v90, 16, v163
    v_and_b32 v91, 0xffff0000, v163
    v_add_f32 v122, v122, v90
    v_add_f32 v123, v123, v91
    s_waitcnt vmcnt(8)
    v_lshlrev_b32 v90, 16, v24
    v_and_b32 v91, 0xffff0000, v24
    v_add_f32 v100, v100, v90
    v_add_f32 v101, v101, v91
    v_lshlrev_b32 v90, 16, v25
    v_and_b32 v91, 0xffff0000, v25
    v_add_f32 v102, v102, v90
    v_add_f32 v103, v103, v91
    v_lshlrev_b32 v90, 16, v26
    v_and_b32 v91, 0xffff0000, v26
    v_add_f32 v104, v104, v90
    v_add_f32 v105, v105, v91
    v_lshlrev_b32 v90, 16, v27
    v_and_b32 v91, 0xffff0000, v27
    v_add_f32 v106, v106, v90
    v_add_f32 v107, v107, v91
    s_waitcnt vmcnt(7)
    v_lshlrev_b32 v90, 16, v28
    v_and_b32 v91, 0xffff0000, v28
    v_add_f32 v108, v108, v90
    v_add_f32 v109, v109, v91
    v_lshlrev_b32 v90, 16, v29
    v_and_b32 v91, 0xffff0000, v29
    v_add_f32 v110, v110, v90
    v_add_f32 v111, v111, v91
    v_lshlrev_b32 v90, 16, v30
    v_and_b32 v91, 0xffff0000, v30
    v_add_f32 v112, v112, v90
    v_add_f32 v113, v113, v91
    v_lshlrev_b32 v90, 16, v31
    v_and_b32 v91, 0xffff0000, v31
    v_add_f32 v114, v114, v90
    v_add_f32 v115, v115, v91
    s_waitcnt vmcnt(6)
    v_lshlrev_b32 v90, 16, v32
    v_and_b32 v91, 0xffff0000, v32
    v_add_f32 v116, v116, v90
    v_add_f32 v117, v117, v91
    v_lshlrev_b32 v90, 16, v33
    v_and_b32 v91, 0xffff0000, v33
    v_add_f32 v118, v118, v90
    v_add_f32 v119, v119, v91
    v_lshlrev_b32 v90, 16, v34
    v_and_b32 v91, 0xffff0000, v34
    v_add_f32 v120, v120, v90
    v_add_f32 v121, v121, v91
    v_lshlrev_b32 v90, 16, v35
    v_and_b32 v91, 0xffff0000, v35
    v_add_f32 v122, v122, v90
    v_add_f32 v123, v123, v91
    s_waitcnt vmcnt(5)
    v_lshlrev_b32 v90, 16, v36
    v_and_b32 v91, 0xffff0000, v36
    v_add_f32 v100, v100, v90
    v_add_f32 v101, v101, v91
    v_lshlrev_b32 v90, 16, v37
    v_and_b32 v91, 0xffff0000, v37
    v_add_f32 v102, v102, v90
    v_add_f32 v103, v103, v91
    v_lshlrev_b32 v90, 16, v38
    v_and_b32 v91, 0xffff0000, v38
    v_add_f32 v104, v104, v90
    v_add_f32 v105, v105, v91
    v_lshlrev_b32 v90, 16, v39
    v_and_b32 v91, 0xffff0000, v39
    v_add_f32 v106, v106, v90
    v_add_f32 v107, v107, v91
    s_waitcnt vmcnt(4)
    v_lshlrev_b32 v90, 16, v40
    v_and_b32 v91, 0xffff0000, v40
    v_add_f32 v108, v108, v90
    v_add_f32 v109, v109, v91
    v_lshlrev_b32 v90, 16, v41
    v_and_b32 v91, 0xffff0000, v41
    v_add_f32 v110, v110, v90
    v_add_f32 v111, v111, v91
    v_lshlrev_b32 v90, 16, v42
    v_and_b32 v91, 0xffff0000, v42
    v_add_f32 v112, v112, v90
    v_add_f32 v113, v113, v91
    v_lshlrev_b32 v90, 16, v43
    v_and_b32 v91, 0xffff0000, v43
    v_add_f32 v114, v114, v90
    v_add_f32 v115, v115, v91
    s_waitcnt vmcnt(3)
    v_lshlrev_b32 v90, 16, v44
    v_and_b32 v91, 0xffff0000, v44
    v_add_f32 v116, v116, v90
    v_add_f32 v117, v117, v91
    v_lshlrev_b32 v90, 16, v45
    v_and_b32 v91, 0xffff0000, v45
    v_add_f32 v118, v118, v90
    v_add_f32 v119, v119, v91
    v_lshlrev_b32 v90, 16, v46
    v_and_b32 v91, 0xffff0000, v46
    v_add_f32 v120, v120, v90
    v_add_f32 v121, v121, v91
    v_lshlrev_b32 v90, 16, v47
    v_and_b32 v91, 0xffff0000, v47
    v_add_f32 v122, v122, v90
    v_add_f32 v123, v123, v91
    s_waitcnt vmcnt(2)
    v_lshlrev_b32 v90, 16, v48
    v_and_b32 v91, 0xffff0000, v48
    v_add_f32 v100, v100, v90
    v_add_f32 v101, v101, v91
    v_lshlrev_b32 v90, 16, v49
    v_and_b32 v91, 0xffff0000, v49
    v_add_f32 v102, v102, v90
    v_add_f32 v103, v103, v91
    v_lshlrev_b32 v90, 16, v50
    v_and_b32 v91, 0xffff0000, v50
    v_add_f32 v104, v104, v90
    v_add_f32 v105, v105, v91
    v_lshlrev_b32 v90, 16, v51
    v_and_b32 v91, 0xffff0000, v51
    v_add_f32 v106, v106, v90
    v_add_f32 v107, v107, v91
    v_cvt_pk_bf16_f32 v8, v100, v101
    v_cvt_pk_bf16_f32 v9, v102, v103
    v_cvt_pk_bf16_f32 v10, v104, v105
    v_cvt_pk_bf16_f32 v11, v106, v107
    ds_write_b64 v2, v[8:9] offset:0
    ds_write_b64 v2, v[10:11] offset:32
    s_waitcnt vmcnt(1)
    v_lshlrev_b32 v90, 16, v52
    v_and_b32 v91, 0xffff0000, v52
    v_add_f32 v108, v108, v90
    v_add_f32 v109, v109, v91
    v_lshlrev_b32 v90, 16, v53
    v_and_b32 v91, 0xffff0000, v53
    v_add_f32 v110, v110, v90
    v_add_f32 v111, v111, v91
    v_lshlrev_b32 v90, 16, v54
    v_and_b32 v91, 0xffff0000, v54
    v_add_f32 v112, v112, v90
    v_add_f32 v113, v113, v91
    v_lshlrev_b32 v90, 16, v55
    v_and_b32 v91, 0xffff0000, v55
    v_add_f32 v114, v114, v90
    v_add_f32 v115, v115, v91
    v_cvt_pk_bf16_f32 v12, v108, v109
    v_cvt_pk_bf16_f32 v13, v110, v111
    v_cvt_pk_bf16_f32 v14, v112, v113
    v_cvt_pk_bf16_f32 v15, v114, v115
    ds_write_b64 v2, v[12:13] offset:64
    ds_write_b64 v2, v[14:15] offset:96
    s_waitcnt vmcnt(0)
    v_lshlrev_b32 v90, 16, v56
    v_and_b32 v91, 0xffff0000, v56
    v_add_f32 v116, v116, v90
    v_add_f32 v117, v117, v91
    v_lshlrev_b32 v90, 16, v57
    v_and_b32 v91, 0xffff0000, v57
    v_add_f32 v118, v118, v90
    v_add_f32 v119, v119, v91
    v_lshlrev_b32 v90, 16, v58
    v_and_b32 v91, 0xffff0000, v58
    v_add_f32 v120, v120, v90
    v_add_f32 v121, v121, v91
    v_lshlrev_b32 v90, 16, v59
    v_and_b32 v91, 0xffff0000, v59
    v_add_f32 v122, v122, v90
    v_add_f32 v123, v123, v91
    v_cvt_pk_bf16_f32 v16, v116, v117
    v_cvt_pk_bf16_f32 v17, v118, v119
    v_cvt_pk_bf16_f32 v18, v120, v121
    v_cvt_pk_bf16_f32 v19, v122, v123
    ds_write_b64 v2, v[16:17] offset:128
    ds_write_b64 v2, v[18:19] offset:160
    ds_read_b128 v[24:27], v4 offset:0
    ds_read_b128 v[28:31], v4 offset:1024
    ds_read_b128 v[32:35], v4 offset:2048
    s_waitcnt lgkmcnt(2)
    buffer_store_dwordx4 v[24:27], v20, s[20:23], s54 offen sc1
    s_waitcnt lgkmcnt(1)
    buffer_store_dwordx4 v[28:31], v21, s[20:23], s54 offen sc1
    s_waitcnt lgkmcnt(0)
    buffer_store_dwordx4 v[32:35], v22, s[20:23], s54 offen sc1
    s_endpgm
KM_ROLEA:
    s_waitcnt lgkmcnt(6)
    v_mfma_f32_16x16x32_bf16 v[176:179], v[224:227], v[136:139], v[176:179]
    ds_read_b64_tr_b16 v[220:221], v243 offset:50176
    v_add_f32 v151, 1.0, v151
    v_mfma_f32_16x16x32_bf16 v[180:183], v[224:227], v[140:143], v[180:183]
    ds_read_b64_tr_b16 v[222:223], v243 offset:50688
    v_mul_f32 v158, v150, v158
    v_rcp_f32 v151, v151
    v_mfma_f32_16x16x32_bf16 v[184:187], v[228:231], v[136:139], v[184:187]
    ds_read_b64_tr_b16 v[224:225], v243 offset:57344
    s_nop 0
    v_mfma_f32_16x16x32_bf16 v[188:191], v[228:231], v[140:143], v[188:191]
    ds_read_b64_tr_b16 v[226:227], v243 offset:57856
    v_mul_f32 v159, v151, v159
    s_waitcnt lgkmcnt(6)
    v_mfma_f32_16x16x32_bf16 v[192:195], v[208:211], v[96:99], v[192:195]
    ds_read_b64_tr_b16 v[228:229], v243 offset:58368
    v_cvt_pk_bf16_f32 v232, v152, v153
    v_mfma_f32_16x16x32_bf16 v[196:199], v[208:211], v[100:103], v[196:199]
    ds_read_b64_tr_b16 v[230:231], v243 offset:58880
    v_cvt_pk_bf16_f32 v233, v154, v155
    s_add_u32 m0, s52, 0x16000
    s_add_u32 s50, s50, s51
    buffer_load_dwordx4 v248, s[20:23], s50 offen lds
    v_mfma_f32_16x16x32_bf16 v[200:203], v[212:215], v[96:99], v[200:203]
    v_add_u32 v243, 0x10000, v243
    ds_read_b64_tr_b16 v[208:209], v243 offset:0
    v_cvt_pk_bf16_f32 v236, v156, v157
    v_mfma_f32_16x16x32_bf16 v[204:207], v[212:215], v[100:103], v[204:207]
    ds_read_b64_tr_b16 v[210:211], v243 offset:512
    v_cvt_pk_bf16_f32 v237, v158, v159
    s_waitcnt lgkmcnt(6)
    v_mfma_f32_16x16x32_bf16 v[192:195], v[216:219], v[104:107], v[192:195]
    ds_read_b64_tr_b16 v[212:213], v243 offset:1024
    v_mul_f32 v168, v160, v168
    v_mfma_f32_16x16x32_bf16 v[196:199], v[216:219], v[108:111], v[196:199]
    ds_read_b64_tr_b16 v[214:215], v243 offset:1536
    v_mul_f32 v160, v250, v160
    v_mul_f32 v169, v161, v169
    v_mfma_f32_16x16x32_bf16 v[200:203], v[220:223], v[104:107], v[200:203]
    ds_read_b64_tr_b16 v[216:217], v243 offset:8192
    v_exp_f32 v160, v160
    v_mfma_f32_16x16x32_bf16 v[204:207], v[220:223], v[108:111], v[204:207]
    ds_read_b64_tr_b16 v[218:219], v243 offset:8704
    v_mul_f32 v161, v250, v161
    s_add_u32 m0, s52, 0x18000
    s_add_u32 s50, s50, s51
    buffer_load_dwordx4 v248, s[20:23], s50 offen lds
    s_waitcnt lgkmcnt(6)
    v_mfma_f32_16x16x32_bf16 v[192:195], v[224:227], v[112:115], v[192:195]
    ds_read_b64_tr_b16 v[220:221], v243 offset:9216
    v_mul_f32 v170, v162, v170
    v_mfma_f32_16x16x32_bf16 v[196:199], v[224:227], v[116:119], v[196:199]
    ds_read_b64_tr_b16 v[222:223], v243 offset:9728
    v_add_f32 v160, 1.0, v160
    v_exp_f32 v161, v161
    s_mov_b32 exec_lo, 0x3ffff
    s_mov_b32 exec_hi, 0x0
    buffer_load_dword v255, v252, s[16:19], s53 offen
    s_mov_b64 exec, -1
    v_mfma_f32_16x16x32_bf16 v[200:203], v[228:231], v[112:115], v[200:203]
    ds_read_b64_tr_b16 v[224:225], v243 offset:16384
    v_mul_f32 v162, v250, v162
    v_mfma_f32_16x16x32_bf16 v[204:207], v[228:231], v[116:119], v[204:207]
    ds_read_b64_tr_b16 v[226:227], v243 offset:16896
    v_mul_f32 v171, v163, v171
    s_waitcnt lgkmcnt(6)
    v_mfma_f32_16x16x32_bf16 v[192:195], v[208:211], v[120:123], v[192:195]
    ds_read_b64_tr_b16 v[228:229], v243 offset:17408
    v_rcp_f32 v160, v160
    v_mfma_f32_16x16x32_bf16 v[196:199], v[208:211], v[124:127], v[196:199]
    ds_read_b64_tr_b16 v[230:231], v243 offset:17920
    v_add_f32 v161, 1.0, v161
    v_exp_f32 v162, v162
    v_mfma_f32_16x16x32_bf16 v[200:203], v[212:215], v[120:123], v[200:203]
    v_mul_f32 v163, v250, v163
    v_mfma_f32_16x16x32_bf16 v[204:207], v[212:215], v[124:127], v[204:207]
    v_mul_f32 v172, v164, v172
    s_waitcnt lgkmcnt(4)
    v_mfma_f32_16x16x32_bf16 v[192:195], v[216:219], v[128:131], v[192:195]
    v_mul_f32 v168, v160, v168
    v_rcp_f32 v161, v161
    v_add_f32 v162, 1.0, v162
    v_mfma_f32_16x16x32_bf16 v[196:199], v[216:219], v[132:135], v[196:199]
    s_waitcnt vmcnt(4) lgkmcnt(0)
    s_barrier
    ds_read_b64_tr_b16 v[208:209], v244 offset:1024
    ds_read_b64_tr_b16 v[210:211], v244 offset:1152
    ds_read_b64_tr_b16 v[212:213], v244 offset:3072
    ds_read_b64_tr_b16 v[214:215], v244 offset:3200
    s_setprio 3
    v_mfma_f32_16x16x32_bf16 v[200:203], v[220:223], v[128:131], v[200:203]
    ds_read_b64_tr_b16 v[216:217], v244 offset:9216
    v_exp_f32 v163, v163
    v_mfma_f32_16x16x32_bf16 v[204:207], v[220:223], v[132:135], v[204:207]
    ds_read_b64_tr_b16 v[218:219], v244 offset:9344
    v_mul_f32 v164, v250, v164
    s_add_u32 m0, s52, 0x1a000
    s_add_u32 s50, s50, s51
    buffer_load_dwordx4 v248, s[20:23], s50 offen lds
    v_mfma_f32_16x16x32_bf16 v[192:195], v[224:227], v[136:139], v[192:195]
    ds_read_b64_tr_b16 v[220:221], v244 offset:11264
    v_mul_f32 v173, v165, v173
    v_mfma_f32_16x16x32_bf16 v[196:199], v[224:227], v[140:143], v[196:199]
    ds_read_b64_tr_b16 v[222:223], v244 offset:11392
    v_mul_f32 v169, v161, v169
    v_mfma_f32_16x16x32_bf16 v[200:203], v[228:231], v[136:139], v[200:203]
    ds_read_b64_tr_b16 v[224:225], v244 offset:17408
    v_rcp_f32 v162, v162
    v_mfma_f32_16x16x32_bf16 v[204:207], v[228:231], v[140:143], v[204:207]
    ds_read_b64_tr_b16 v[226:227], v244 offset:17536
    v_add_f32 v163, 1.0, v163
    v_exp_f32 v164, v164
    s_waitcnt lgkmcnt(6)
    v_mfma_f32_16x16x32_bf16 v[144:147], v[208:211], v[0:3], 0
    ds_read_b64_tr_b16 v[228:229], v244 offset:19456
    v_mul_f32 v165, v250, v165
    v_mfma_f32_16x16x32_bf16 v[148:151], v[208:211], v[4:7], 0
    ds_read_b64_tr_b16 v[230:231], v244 offset:19584
    v_mul_f32 v174, v166, v174
    s_add_u32 m0, s52, 0x1c000
    s_add_u32 s50, s50, s51
    buffer_load_dwordx4 v248, s[20:23], s50 offen lds
    v_mfma_f32_16x16x32_bf16 v[152:155], v[212:215], v[0:3], 0
    ds_read_b64_tr_b16 v[208:209], v244 offset:25600
    v_mul_f32 v170, v162, v170
    v_mfma_f32_16x16x32_bf16 v[156:159], v[212:215], v[4:7], 0
    ds_read_b64_tr_b16 v[210:211], v244 offset:25728
    v_rcp_f32 v163, v163
    v_add_f32 v164, 1.0, v164
    s_waitcnt lgkmcnt(6)
    v_mfma_f32_16x16x32_bf16 v[144:147], v[216:219], v[8:11], v[144:147]
    ds_read_b64_tr_b16 v[212:213], v244 offset:27648
    v_exp_f32 v165, v165
    v_mfma_f32_16x16x32_bf16 v[148:151], v[216:219], v[12:15], v[148:151]
    ds_read_b64_tr_b16 v[214:215], v244 offset:27776
    v_mul_f32 v166, v250, v166
    v_mfma_f32_16x16x32_bf16 v[152:155], v[220:223], v[8:11], v[152:155]
    ds_read_b64_tr_b16 v[216:217], v244 offset:33792
    v_mul_f32 v175, v167, v175
    v_mfma_f32_16x16x32_bf16 v[156:159], v[220:223], v[12:15], v[156:159]
    ds_read_b64_tr_b16 v[218:219], v244 offset:33920
    v_mul_f32 v171, v163, v171
    v_rcp_f32 v164, v164
    s_add_u32 m0, s52, 0x1e000
    s_add_u32 s50, s50, s51
    buffer_load_dwordx4 v248, s[20:23], s50 offen lds
    s_waitcnt lgkmcnt(6)
    v_mfma_f32_16x16x32_bf16 v[144:147], v[224:227], v[16:19], v[144:147]
    ds_read_b64_tr_b16 v[220:221], v244 offset:35840
    v_add_f32 v165, 1.0, v165
    v_mfma_f32_16x16x32_bf16 v[148:151], v[224:227], v[20:23], v[148:151]
    ds_read_b64_tr_b16 v[222:223], v244 offset:35968
    v_exp_f32 v166, v166
    v_mfma_f32_16x16x32_bf16 v[152:155], v[228:231], v[16:19], v[152:155]
    ds_read_b64_tr_b16 v[224:225], v244 offset:41984
    v_mul_f32 v167, v250, v167
    v_mfma_f32_16x16x32_bf16 v[156:159], v[228:231], v[20:23], v[156:159]
    ds_read_b64_tr_b16 v[226:227], v244 offset:42112
    v_mul_f32 v172, v164, v172
    s_waitcnt lgkmcnt(6)
    s_setprio 2
    v_mfma_f32_16x16x32_bf16 v[144:147], v[208:211], v[24:27], v[144:147]
    ds_read_b64_tr_b16 v[228:229], v244 offset:44032
    v_rcp_f32 v165, v165
    v_mfma_f32_16x16x32_bf16 v[148:151], v[208:211], v[28:31], v[148:151]
    ds_read_b64_tr_b16 v[230:231], v244 offset:44160
    v_add_f32 v166, 1.0, v166
    v_exp_f32 v167, v167
    s_add_u32 m0, s52, 0x20000
    s_add_u32 s50, s50, s51
    buffer_load_dwordx4 v248, s[20:23], s50 offen lds
    v_mfma_f32_16x16x32_bf16 v[152:155], v[212:215], v[24:27], v[152:155]
    ds_read_b64_tr_b16 v[208:209], v244 offset:50176
    v_mul_f32 v173, v165, v173
    v_mfma_f32_16x16x32_bf16 v[156:159], v[212:215], v[28:31], v[156:159]
    ds_read_b64_tr_b16 v[210:211], v244 offset:50304
    v_rcp_f32 v166, v166
    s_waitcnt lgkmcnt(6)
    v_mfma_f32_16x16x32_bf16 v[144:147], v[216:219], v[32:35], v[144:147]
    ds_read_b64_tr_b16 v[212:213], v244 offset:52224
    v_add_f32 v167, 1.0, v167
    v_mfma_f32_16x16x32_bf16 v[148:151], v[216:219], v[36:39], v[148:151]
    ds_read_b64_tr_b16 v[214:215], v244 offset:52352
    v_mul_f32 v174, v166, v174
    v_rcp_f32 v167, v167
    v_mfma_f32_16x16x32_bf16 v[152:155], v[220:223], v[32:35], v[152:155]
    ds_read_b64_tr_b16 v[216:217], v244 offset:58368
    s_nop 0
    v_mfma_f32_16x16x32_bf16 v[156:159], v[220:223], v[36:39], v[156:159]
    ds_read_b64_tr_b16 v[218:219], v244 offset:58496
    v_mul_f32 v175, v167, v175
    s_add_u32 m0, s52, 0x22000
    s_add_u32 s50, s50, s51
    buffer_load_dwordx4 v248, s[20:23], s50 offen lds
    s_waitcnt lgkmcnt(6)
    v_mfma_f32_16x16x32_bf16 v[144:147], v[224:227], v[40:43], v[144:147]
    ds_read_b64_tr_b16 v[220:221], v244 offset:60416
    v_cvt_pk_bf16_f32 v234, v168, v169
    v_mfma_f32_16x16x32_bf16 v[148:151], v[224:227], v[44:47], v[148:151]
    ds_read_b64_tr_b16 v[222:223], v244 offset:60544
    v_cvt_pk_bf16_f32 v235, v170, v171
    v_cvt_pk_bf16_f32 v238, v172, v173
    v_mfma_f32_16x16x32_bf16 v[152:155], v[228:231], v[40:43], v[152:155]
    v_add_u32 v244, 0x10000, v244
    ds_read_b64_tr_b16 v[224:225], v244 offset:1024
    v_cvt_pk_bf16_f32 v239, v174, v175
    v_mfma_f32_16x16x32_bf16 v[156:159], v[228:231], v[44:47], v[156:159]
    ds_read_b64_tr_b16 v[226:227], v244 offset:1152
    buffer_store_dwordx4 v[232:235], v245, s[24:27], s40 offen sc1
    s_waitcnt lgkmcnt(6)
    v_mfma_f32_16x16x32_bf16 v[144:147], v[208:211], v[48:51], v[144:147]
    ds_read_b64_tr_b16 v[228:229], v244 offset:3072
    s_add_u32 s48, s40, 148480
    v_mfma_f32_16x16x32_bf16 v[148:151], v[208:211], v[52:55], v[148:151]
    ds_read_b64_tr_b16 v[230:231], v244 offset:3200
    buffer_store_dwordx4 v[236:239], v245, s[24:27], s48 offen sc1
    s_add_u32 m0, s52, 0x24000
    s_add_u32 s50, s50, s51
    buffer_load_dwordx4 v248, s[20:23], s50 offen lds
    v_mfma_f32_16x16x32_bf16 v[152:155], v[212:215], v[48:51], v[152:155]
    v_subrev_u32 v240, 0x20000, v240
    ds_read_b64_tr_b16 v[208:209], v240 offset:0
    v_mul_f32 v184, v176, v184
    v_mfma_f32_16x16x32_bf16 v[156:159], v[212:215], v[52:55], v[156:159]
    ds_read_b64_tr_b16 v[210:211], v240 offset:512
    v_mul_f32 v176, v250, v176
    s_waitcnt lgkmcnt(6)
    v_mfma_f32_16x16x32_bf16 v[144:147], v[216:219], v[56:59], v[144:147]
    v_subrev_u32 v241, 0x20000, v241
    ds_read_b64_tr_b16 v[212:213], v241 offset:0
    v_mul_f32 v185, v177, v185
    v_mfma_f32_16x16x32_bf16 v[148:151], v[216:219], v[60:63], v[148:151]
    ds_read_b64_tr_b16 v[214:215], v241 offset:512
    v_exp_f32 v176, v176
    s_setprio 1
    v_mfma_f32_16x16x32_bf16 v[152:155], v[220:223], v[56:59], v[152:155]
    ds_read_b64_tr_b16 v[216:217], v240 offset:8192
    v_mul_f32 v177, v250, v177
    v_mfma_f32_16x16x32_bf16 v[156:159], v[220:223], v[60:63], v[156:159]
    ds_read_b64_tr_b16 v[218:219], v240 offset:8704
    v_mul_f32 v186, v178, v186
    s_waitcnt lgkmcnt(6)
    v_mfma_f32_16x16x32_bf16 v[144:147], v[224:227], v[64:67], v[144:147]
    ds_read_b64_tr_b16 v[220:221], v241 offset:8192
    v_add_f32 v176, 1.0, v176
    v_mfma_f32_16x16x32_bf16 v[148:151], v[224:227], v[68:71], v[148:151]
    ds_read_b64_tr_b16 v[222:223], v241 offset:8704
    v_exp_f32 v177, v177
    v_mfma_f32_16x16x32_bf16 v[152:155], v[228:231], v[64:67], v[152:155]
    ds_read_b64_tr_b16 v[224:225], v240 offset:16384
    v_mul_f32 v178, v250, v178
    v_mfma_f32_16x16x32_bf16 v[156:159], v[228:231], v[68:71], v[156:159]
    ds_read_b64_tr_b16 v[226:227], v240 offset:16896
    v_mul_f32 v187, v179, v187
    s_waitcnt lgkmcnt(6)
    v_mfma_f32_16x16x32_bf16 v[160:163], v[208:211], v[0:3], 0
    ds_read_b64_tr_b16 v[228:229], v241 offset:16384
    v_rcp_f32 v176, v176
    v_mfma_f32_16x16x32_bf16 v[164:167], v[208:211], v[4:7], 0
    ds_read_b64_tr_b16 v[230:231], v241 offset:16896
    v_add_f32 v177, 1.0, v177
    v_mfma_f32_16x16x32_bf16 v[168:171], v[212:215], v[0:3], 0
    ds_read_b64_tr_b16 v[208:209], v240 offset:24576
    v_exp_f32 v178, v178
    v_mfma_f32_16x16x32_bf16 v[172:175], v[212:215], v[4:7], 0
    ds_read_b64_tr_b16 v[210:211], v240 offset:25088
    v_mul_f32 v179, v250, v179
    s_waitcnt lgkmcnt(6)
    v_mfma_f32_16x16x32_bf16 v[160:163], v[216:219], v[8:11], v[160:163]
    ds_read_b64_tr_b16 v[212:213], v241 offset:24576
    v_mul_f32 v188, v180, v188
    v_mfma_f32_16x16x32_bf16 v[164:167], v[216:219], v[12:15], v[164:167]
    ds_read_b64_tr_b16 v[214:215], v241 offset:25088
    v_mul_f32 v184, v176, v184
    v_mfma_f32_16x16x32_bf16 v[168:171], v[220:223], v[8:11], v[168:171]
    ds_read_b64_tr_b16 v[216:217], v240 offset:32768
    v_rcp_f32 v177, v177
    v_mfma_f32_16x16x32_bf16 v[172:175], v[220:223], v[12:15], v[172:175]
    ds_read_b64_tr_b16 v[218:219], v240 offset:33280
    v_add_f32 v178, 1.0, v178
    s_waitcnt lgkmcnt(6)
    v_mfma_f32_16x16x32_bf16 v[160:163], v[224:227], v[16:19], v[160:163]
    ds_read_b64_tr_b16 v[220:221], v241 offset:32768
    v_exp_f32 v179, v179
    v_mfma_f32_16x16x32_bf16 v[164:167], v[224:227], v[20:23], v[164:167]
    ds_read_b64_tr_b16 v[222:223], v241 offset:33280
    v_mul_f32 v180, v250, v180
    v_mfma_f32_16x16x32_bf16 v[168:171], v[228:231], v[16:19], v[168:171]
    ds_read_b64_tr_b16 v[224:225], v240 offset:40960
    v_mul_f32 v189, v181, v189
    v_mfma_f32_16x16x32_bf16 v[172:175], v[228:231], v[20:23], v[172:175]
    ds_read_b64_tr_b16 v[226:227], v240 offset:41472
    v_mul_f32 v185, v177, v185
    s_waitcnt lgkmcnt(6)
    s_setprio 0
    v_mfma_f32_16x16x32_bf16 v[160:163], v[208:211], v[24:27], v[160:163]
    ds_read_b64_tr_b16 v[228:229], v241 offset:40960
    v_rcp_f32 v178, v178
    v_mfma_f32_16x16x32_bf16 v[164:167], v[208:211], v[28:31], v[164:167]
    ds_read_b64_tr_b16 v[230:231], v241 offset:41472
    v_add_f32 v179, 1.0, v179
    v_mfma_f32_16x16x32_bf16 v[168:171], v[212:215], v[24:27], v[168:171]
    ds_read_b64_tr_b16 v[208:209], v240 offset:49152
    v_exp_f32 v180, v180
    v_mfma_f32_16x16x32_bf16 v[172:175], v[212:215], v[28:31], v[172:175]
    ds_read_b64_tr_b16 v[210:211], v240 offset:49664
    v_mul_f32 v181, v250, v181
    s_waitcnt lgkmcnt(6)
    v_mfma_f32_16x16x32_bf16 v[160:163], v[216:219], v[32:35], v[160:163]
    ds_read_b64_tr_b16 v[212:213], v241 offset:49152
    v_mul_f32 v190, v182, v190
    v_mfma_f32_16x16x32_bf16 v[164:167], v[216:219], v[36:39], v[164:167]
    ds_read_b64_tr_b16 v[214:215], v241 offset:49664
    v_mul_f32 v186, v178, v186
    v_mfma_f32_16x16x32_bf16 v[168:171], v[220:223], v[32:35], v[168:171]
    ds_read_b64_tr_b16 v[216:217], v240 offset:57344
    v_rcp_f32 v179, v179
    v_mfma_f32_16x16x32_bf16 v[172:175], v[220:223], v[36:39], v[172:175]
    ds_read_b64_tr_b16 v[218:219], v240 offset:57856
    v_add_f32 v180, 1.0, v180
    s_waitcnt lgkmcnt(6)
    v_mfma_f32_16x16x32_bf16 v[160:163], v[224:227], v[40:43], v[160:163]
    ds_read_b64_tr_b16 v[220:221], v241 offset:57344
    v_exp_f32 v181, v181
    v_mfma_f32_16x16x32_bf16 v[164:167], v[224:227], v[44:47], v[164:167]
    ds_read_b64_tr_b16 v[222:223], v241 offset:57856
    v_mul_f32 v182, v250, v182
    v_mfma_f32_16x16x32_bf16 v[168:171], v[228:231], v[40:43], v[168:171]
    v_add_u32 v240, 0x10000, v240
    ds_read_b64_tr_b16 v[224:225], v240 offset:0
    v_mul_f32 v191, v183, v191
    v_mfma_f32_16x16x32_bf16 v[172:175], v[228:231], v[44:47], v[172:175]
    ds_read_b64_tr_b16 v[226:227], v240 offset:512
    v_mul_f32 v187, v179, v187
    s_waitcnt lgkmcnt(6)
    v_mfma_f32_16x16x32_bf16 v[160:163], v[208:211], v[48:51], v[160:163]
    v_add_u32 v241, 0x10000, v241
    ds_read_b64_tr_b16 v[228:229], v241 offset:0
    v_rcp_f32 v180, v180
    v_mfma_f32_16x16x32_bf16 v[164:167], v[208:211], v[52:55], v[164:167]
    ds_read_b64_tr_b16 v[230:231], v241 offset:512
    v_add_f32 v181, 1.0, v181
    v_mfma_f32_16x16x32_bf16 v[168:171], v[212:215], v[48:51], v[168:171]
    v_exp_f32 v182, v182
    v_mfma_f32_16x16x32_bf16 v[172:175], v[212:215], v[52:55], v[172:175]
    v_mul_f32 v183, v250, v183
    s_waitcnt lgkmcnt(4)
    v_mfma_f32_16x16x32_bf16 v[160:163], v[216:219], v[56:59], v[160:163]
    v_mul_f32 v188, v180, v188
    v_rcp_f32 v181, v181
    v_mfma_f32_16x16x32_bf16 v[164:167], v[216:219], v[60:63], v[164:167]
    s_waitcnt vmcnt(0) lgkmcnt(0)
    s_barrier
    ds_read_b64_tr_b16 v[208:209], v240 offset:16384
    ds_read_b64_tr_b16 v[210:211], v240 offset:16896
    ds_read_b64_tr_b16 v[212:213], v241 offset:16384
    ds_read_b64_tr_b16 v[214:215], v241 offset:16896
    s_setprio 3
    v_mfma_f32_16x16x32_bf16 v[168:171], v[220:223], v[56:59], v[168:171]
    ds_read_b64_tr_b16 v[216:217], v240 offset:24576
    v_add_f32 v182, 1.0, v182
    v_mfma_f32_16x16x32_bf16 v[172:175], v[220:223], v[60:63], v[172:175]
    ds_read_b64_tr_b16 v[218:219], v240 offset:25088
    v_exp_f32 v183, v183
    s_add_u32 m0, s52, 0x0
    s_mov_b32 s50, 0
    buffer_load_dwordx4 v247, s[16:19], s50 offen lds
    v_mfma_f32_16x16x32_bf16 v[160:163], v[224:227], v[64:67], v[160:163]
    ds_read_b64_tr_b16 v[220:221], v241 offset:24576
    v_mul_f32 v189, v181, v189
    v_mfma_f32_16x16x32_bf16 v[164:167], v[224:227], v[68:71], v[164:167]
    ds_read_b64_tr_b16 v[222:223], v241 offset:25088
    v_rcp_f32 v182, v182
    v_mfma_f32_16x16x32_bf16 v[168:171], v[228:231], v[64:67], v[168:171]
    ds_read_b64_tr_b16 v[224:225], v240 offset:32768
    v_add_f32 v183, 1.0, v183
    v_mfma_f32_16x16x32_bf16 v[172:175], v[228:231], v[68:71], v[172:175]
    ds_read_b64_tr_b16 v[226:227], v240 offset:33280
    v_mul_f32 v190, v182, v190
    s_waitcnt lgkmcnt(6)
    v_mfma_f32_16x16x32_bf16 v[160:163], v[208:211], v[72:75], v[160:163]
    ds_read_b64_tr_b16 v[228:229], v241 offset:32768
    v_rcp_f32 v183, v183
    v_mfma_f32_16x16x32_bf16 v[164:167], v[208:211], v[76:79], v[164:167]
    ds_read_b64_tr_b16 v[230:231], v241 offset:33280
    s_nop 0
    s_add_u32 m0, s52, 0x2000
    s_add_u32 s50, s50, 294912
    buffer_load_dwordx4 v247, s[16:19], s50 offen lds
    v_mfma_f32_16x16x32_bf16 v[168:171], v[212:215], v[72:75], v[168:171]
    ds_read_b64_tr_b16 v[208:209], v240 offset:40960
    v_mul_f32 v191, v183, v191
    v_mfma_f32_16x16x32_bf16 v[172:175], v[212:215], v[76:79], v[172:175]
    ds_read_b64_tr_b16 v[210:211], v240 offset:41472
    v_cvt_pk_bf16_f32 v232, v184, v185
    s_waitcnt lgkmcnt(6)
    v_mfma_f32_16x16x32_bf16 v[160:163], v[216:219], v[80:83], v[160:163]
    ds_read_b64_tr_b16 v[212:213], v241 offset:40960
    v_cvt_pk_bf16_f32 v233, v186, v187
    v_mfma_f32_16x16x32_bf16 v[164:167], v[216:219], v[84:87], v[164:167]
    ds_read_b64_tr_b16 v[214:215], v241 offset:41472
    v_cvt_pk_bf16_f32 v236, v188, v189
    v_mfma_f32_16x16x32_bf16 v[168:171], v[220:223], v[80:83], v[168:171]
    ds_read_b64_tr_b16 v[216:217], v240 offset:49152
    v_mfma_f32_16x16x32_bf16 v[172:175], v[220:223], v[84:87], v[172:175]
    ds_read_b64_tr_b16 v[218:219], v240 offset:49664
    v_cvt_pk_bf16_f32 v237, v190, v191
    s_add_u32 m0, s52, 0x4000
    s_add_u32 s50, s50, 294912
    buffer_load_dwordx4 v247, s[16:19], s50 offen lds
    s_waitcnt lgkmcnt(6)
    v_mfma_f32_16x16x32_bf16 v[160:163], v[224:227], v[88:91], v[160:163]
    ds_read_b64_tr_b16 v[220:221], v241 offset:49152
    v_mul_f32 v200, v192, v200
    v_mfma_f32_16x16x32_bf16 v[164:167], v[224:227], v[92:95], v[164:167]
    ds_read_b64_tr_b16 v[222:223], v241 offset:49664
    v_mul_f32 v192, v250, v192
    v_mfma_f32_16x16x32_bf16 v[168:171], v[228:231], v[88:91], v[168:171]
    ds_read_b64_tr_b16 v[224:225], v240 offset:57344
    v_mul_f32 v201, v193, v201
    v_mfma_f32_16x16x32_bf16 v[172:175], v[228:231], v[92:95], v[172:175]
    ds_read_b64_tr_b16 v[226:227], v240 offset:57856
    v_exp_f32 v192, v192
    s_waitcnt lgkmcnt(6)
    s_setprio 2
    v_mfma_f32_16x16x32_bf16 v[160:163], v[208:211], v[96:99], v[160:163]
    ds_read_b64_tr_b16 v[228:229], v241 offset:57344
    v_mul_f32 v193, v250, v193
    v_mfma_f32_16x16x32_bf16 v[164:167], v[208:211], v[100:103], v[164:167]
    ds_read_b64_tr_b16 v[230:231], v241 offset:57856
    v_mul_f32 v202, v194, v202
    s_add_u32 m0, s52, 0x6000
    s_add_u32 s50, s50, 294912
    buffer_load_dwordx4 v247, s[16:19], s50 offen lds
    v_mfma_f32_16x16x32_bf16 v[168:171], v[212:215], v[96:99], v[168:171]
    v_add_u32 v240, 0x10000, v240
    ds_read_b64_tr_b16 v[208:209], v240 offset:0
    v_add_f32 v192, 1.0, v192
    v_mfma_f32_16x16x32_bf16 v[172:175], v[212:215], v[100:103], v[172:175]
    ds_read_b64_tr_b16 v[210:211], v240 offset:512
    v_exp_f32 v193, v193
    s_waitcnt lgkmcnt(6)
    v_mfma_f32_16x16x32_bf16 v[160:163], v[216:219], v[104:107], v[160:163]
    v_add_u32 v241, 0x10000, v241
    ds_read_b64_tr_b16 v[212:213], v241 offset:0
    v_mul_f32 v194, v250, v194
    v_mfma_f32_16x16x32_bf16 v[164:167], v[216:219], v[108:111], v[164:167]
    ds_read_b64_tr_b16 v[214:215], v241 offset:512
    v_mul_f32 v203, v195, v203
    v_mfma_f32_16x16x32_bf16 v[168:171], v[220:223], v[104:107], v[168:171]
    ds_read_b64_tr_b16 v[216:217], v240 offset:8192
    v_rcp_f32 v192, v192
    v_mfma_f32_16x16x32_bf16 v[172:175], v[220:223], v[108:111], v[172:175]
    ds_read_b64_tr_b16 v[218:219], v240 offset:8704
    v_add_f32 v193, 1.0, v193
    s_add_u32 m0, s52, 0x8000
    s_add_u32 s50, s50, 294912
    buffer_load_dwordx4 v247, s[16:19], s50 offen lds
    s_waitcnt lgkmcnt(6)
    v_mfma_f32_16x16x32_bf16 v[160:163], v[224:227], v[112:115], v[160:163]
    ds_read_b64_tr_b16 v[220:221], v241 offset:8192
    v_exp_f32 v194, v194
    v_mfma_f32_16x16x32_bf16 v[164:167], v[224:227], v[116:119], v[164:167]
    ds_read_b64_tr_b16 v[222:223], v241 offset:8704
    v_mul_f32 v195, v250, v195
    v_mfma_f32_16x16x32_bf16 v[168:171], v[228:231], v[112:115], v[168:171]
    ds_read_b64_tr_b16 v[224:225], v240 offset:16384
    v_mfma_f32_16x16x32_bf16 v[172:175], v[228:231], v[116:119], v[172:175]
    ds_read_b64_tr_b16 v[226:227], v240 offset:16896
    v_mul_f32 v204, v196, v204
    s_waitcnt lgkmcnt(6)
    v_mfma_f32_16x16x32_bf16 v[160:163], v[208:211], v[120:123], v[160:163]
    ds_read_b64_tr_b16 v[228:229], v241 offset:16384
    v_mul_f32 v200, v192, v200
    v_mfma_f32_16x16x32_bf16 v[164:167], v[208:211], v[124:127], v[164:167]
    ds_read_b64_tr_b16 v[230:231], v241 offset:16896
    v_rcp_f32 v193, v193
    s_add_u32 m0, s52, 0xa000
    s_add_u32 s50, s50, 294912
    buffer_load_dwordx4 v247, s[16:19], s50 offen lds
    v_mfma_f32_16x16x32_bf16 v[168:171], v[212:215], v[120:123], v[168:171]
    ds_read_b64_tr_b16 v[208:209], v244 offset:17408
    v_add_f32 v194, 1.0, v194
    v_mfma_f32_16x16x32_bf16 v[172:175], v[212:215], v[124:127], v[172:175]
    ds_read_b64_tr_b16 v[210:211], v244 offset:17536
    v_exp_f32 v195, v195
    s_waitcnt lgkmcnt(6)
    v_mfma_f32_16x16x32_bf16 v[160:163], v[216:219], v[128:131], v[160:163]
    ds_read_b64_tr_b16 v[212:213], v244 offset:19456
    v_mul_f32 v196, v250, v196
    v_mfma_f32_16x16x32_bf16 v[164:167], v[216:219], v[132:135], v[164:167]
    ds_read_b64_tr_b16 v[214:215], v244 offset:19584
    v_mul_f32 v205, v197, v205
    s_setprio 1
    v_mfma_f32_16x16x32_bf16 v[168:171], v[220:223], v[128:131], v[168:171]
    ds_read_b64_tr_b16 v[216:217], v244 offset:25600
    v_mul_f32 v201, v193, v201
    v_mfma_f32_16x16x32_bf16 v[172:175], v[220:223], v[132:135], v[172:175]
    ds_read_b64_tr_b16 v[218:219], v244 offset:25728
    v_rcp_f32 v194, v194
    s_add_u32 m0, s52, 0xc000
    s_add_u32 s50, s50, 294912
    buffer_load_dwordx4 v247, s[16:19], s50 offen lds
    s_waitcnt lgkmcnt(6)
    v_mfma_f32_16x16x32_bf16 v[160:163], v[224:227], v[136:139], v[160:163]
    ds_read_b64_tr_b16 v[220:221], v244 offset:27648
    v_add_f32 v195, 1.0, v195
    v_mfma_f32_16x16x32_bf16 v[164:167], v[224:227], v[140:143], v[164:167]
    ds_read_b64_tr_b16 v[222:223], v244 offset:27776
    v_exp_f32 v196, v196
    v_mfma_f32_16x16x32_bf16 v[168:171], v[228:231], v[136:139], v[168:171]
    ds_read_b64_tr_b16 v[224:225], v244 offset:33792
    v_mul_f32 v197, v250, v197
    v_mfma_f32_16x16x32_bf16 v[172:175], v[228:231], v[140:143], v[172:175]
    ds_read_b64_tr_b16 v[226:227], v244 offset:33920
    v_mul_f32 v206, v198, v206
    s_waitcnt lgkmcnt(6)
    v_mfma_f32_16x16x32_bf16 v[144:147], v[208:211], v[72:75], v[144:147]
    ds_read_b64_tr_b16 v[228:229], v244 offset:35840
    v_mfma_f32_16x16x32_bf16 v[148:151], v[208:211], v[76:79], v[148:151]
    ds_read_b64_tr_b16 v[230:231], v244 offset:35968
    v_mul_f32 v202, v194, v202
    s_add_u32 m0, s52, 0xe000
    s_add_u32 s50, s50, 294912
    buffer_load_dwordx4 v247, s[16:19], s50 offen lds
    v_mfma_f32_16x16x32_bf16 v[152:155], v[212:215], v[72:75], v[152:155]
    ds_read_b64_tr_b16 v[208:209], v244 offset:41984
    v_rcp_f32 v195, v195
    v_mfma_f32_16x16x32_bf16 v[156:159], v[212:215], v[76:79], v[156:159]
    ds_read_b64_tr_b16 v[210:211], v244 offset:42112
    v_add_f32 v196, 1.0, v196
    s_waitcnt lgkmcnt(6)
    v_mfma_f32_16x16x32_bf16 v[144:147], v[216:219], v[80:83], v[144:147]
    ds_read_b64_tr_b16 v[212:213], v244 offset:44032
    v_exp_f32 v197, v197
    v_mul_f32 v198, v250, v198
    v_mfma_f32_16x16x32_bf16 v[148:151], v[216:219], v[84:87], v[148:151]
    ds_read_b64_tr_b16 v[214:215], v244 offset:44160
    v_cvt_pk_bf16_f32 v160, v160, v161
    v_cvt_pk_bf16_f32 v161, v162, v163
    v_mfma_f32_16x16x32_bf16 v[152:155], v[220:223], v[80:83], v[152:155]
    ds_read_b64_tr_b16 v[216:217], v244 offset:50176
    v_mul_f32 v207, v199, v207
    v_mfma_f32_16x16x32_bf16 v[156:159], v[220:223], v[84:87], v[156:159]
    ds_read_b64_tr_b16 v[218:219], v244 offset:50304
    v_mul_f32 v203, v195, v203
    v_cvt_pk_bf16_f32 v164, v164, v165
    s_add_u32 m0, s52, 0x10000
    s_add_u32 s50, s50, 294912
    buffer_load_dwordx4 v247, s[16:19], s50 offen lds
    s_waitcnt lgkmcnt(6)
    v_mfma_f32_16x16x32_bf16 v[144:147], v[224:227], v[88:91], v[144:147]
    ds_read_b64_tr_b16 v[220:221], v244 offset:52224
    v_rcp_f32 v196, v196
    v_mfma_f32_16x16x32_bf16 v[148:151], v[224:227], v[92:95], v[148:151]
    ds_read_b64_tr_b16 v[222:223], v244 offset:52352
    v_add_f32 v197, 1.0, v197
    v_cvt_pk_bf16_f32 v165, v166, v167
    v_mfma_f32_16x16x32_bf16 v[152:155], v[228:231], v[88:91], v[152:155]
    ds_read_b64_tr_b16 v[224:225], v244 offset:58368
    v_exp_f32 v198, v198
    v_mfma_f32_16x16x32_bf16 v[156:159], v[228:231], v[92:95], v[156:159]
    ds_read_b64_tr_b16 v[226:227], v244 offset:58496
    v_mul_f32 v199, v250, v199
    s_add_u32 s47, s46, 0x0
    s_waitcnt lgkmcnt(6)
    s_setprio 0
    v_mfma_f32_16x16x32_bf16 v[144:147], v[208:211], v[96:99], v[144:147]
    ds_read_b64_tr_b16 v[228:229], v244 offset:60416
    v_mul_f32 v204, v196, v204
    v_mfma_f32_16x16x32_bf16 v[148:151], v[208:211], v[100:103], v[148:151]
    ds_read_b64_tr_b16 v[230:231], v244 offset:60544
    v_rcp_f32 v197, v197
    buffer_store_dwordx2 v[160:161], v249, s[28:31], s47 offen offset:0 sc1
    v_mfma_f32_16x16x32_bf16 v[152:155], v[212:215], v[96:99], v[152:155]
    v_add_u32 v244, 0x10000, v244
    ds_read_b64_tr_b16 v[208:209], v244 offset:1024
    v_add_f32 v198, 1.0, v198
    v_mfma_f32_16x16x32_bf16 v[156:159], v[212:215], v[100:103], v[156:159]
    ds_read_b64_tr_b16 v[210:211], v244 offset:1152
    v_exp_f32 v199, v199
    buffer_store_dwordx2 v[164:165], v249, s[28:31], s47 offen offset:128 sc1
    s_waitcnt lgkmcnt(6)
    v_mfma_f32_16x16x32_bf16 v[144:147], v[216:219], v[104:107], v[144:147]
    ds_read_b64_tr_b16 v[212:213], v244 offset:3072
    v_mul_f32 v205, v197, v205
    v_mfma_f32_16x16x32_bf16 v[148:151], v[216:219], v[108:111], v[148:151]
    ds_read_b64_tr_b16 v[214:215], v244 offset:3200
    v_cvt_pk_bf16_f32 v168, v168, v169
    v_cvt_pk_bf16_f32 v169, v170, v171
    v_mfma_f32_16x16x32_bf16 v[152:155], v[220:223], v[104:107], v[152:155]
    ds_read_b64_tr_b16 v[216:217], v244 offset:9216
    v_rcp_f32 v198, v198
    v_mfma_f32_16x16x32_bf16 v[156:159], v[220:223], v[108:111], v[156:159]
    ds_read_b64_tr_b16 v[218:219], v244 offset:9344
    v_add_f32 v199, 1.0, v199
    v_cvt_pk_bf16_f32 v172, v172, v173
    s_waitcnt lgkmcnt(6)
    v_mfma_f32_16x16x32_bf16 v[144:147], v[224:227], v[112:115], v[144:147]
    ds_read_b64_tr_b16 v[220:221], v244 offset:11264
    v_mul_f32 v206, v198, v206
    v_mfma_f32_16x16x32_bf16 v[148:151], v[224:227], v[116:119], v[148:151]
    ds_read_b64_tr_b16 v[222:223], v244 offset:11392
    v_rcp_f32 v199, v199
    v_cvt_pk_bf16_f32 v173, v174, v175
    v_mfma_f32_16x16x32_bf16 v[152:155], v[228:231], v[112:115], v[152:155]
    ds_read_b64_tr_b16 v[224:225], v244 offset:17408
    s_nop 0
    v_mfma_f32_16x16x32_bf16 v[156:159], v[228:231], v[116:119], v[156:159]
    ds_read_b64_tr_b16 v[226:227], v244 offset:17536
    v_mul_f32 v207, v199, v207
    s_add_u32 s47, s46, 0x10000
    s_waitcnt lgkmcnt(6)
    v_mfma_f32_16x16x32_bf16 v[144:147], v[208:211], v[120:123], v[144:147]
    ds_read_b64_tr_b16 v[228:229], v244 offset:19456
    v_cvt_pk_bf16_f32 v234, v200, v201
    v_mfma_f32_16x16x32_bf16 v[148:151], v[208:211], v[124:127], v[148:151]
    ds_read_b64_tr_b16 v[230:231], v244 offset:19584
    v_cvt_pk_bf16_f32 v235, v202, v203
    buffer_store_dwordx2 v[168:169], v249, s[28:31], s47 offen offset:0 sc1
    v_mfma_f32_16x16x32_bf16 v[152:155], v[212:215], v[120:123], v[152:155]
    v_cvt_pk_bf16_f32 v238, v204, v205
    v_mfma_f32_16x16x32_bf16 v[156:159], v[212:215], v[124:127], v[156:159]
    v_cvt_pk_bf16_f32 v239, v206, v207
    buffer_store_dwordx2 v[172:173], v249, s[28:31], s47 offen offset:128 sc1
    s_waitcnt lgkmcnt(4)
    v_mfma_f32_16x16x32_bf16 v[144:147], v[216:219], v[128:131], v[144:147]
    buffer_store_dwordx4 v[232:235], v245, s[24:27], s41 offen sc1
    s_add_u32 s48, s41, 148480
    v_mfma_f32_16x16x32_bf16 v[148:151], v[216:219], v[132:135], v[148:151]
    s_waitcnt vmcnt(5) lgkmcnt(0)
    s_barrier
    v_subrev_u32 v243, 0x20000, v243
    ds_read_b64_tr_b16 v[208:209], v243 offset:0
    ds_read_b64_tr_b16 v[210:211], v243 offset:512
    ds_read_b64_tr_b16 v[212:213], v243 offset:1024
    ds_read_b64_tr_b16 v[214:215], v243 offset:1536
    s_setprio 3
    v_mfma_f32_16x16x32_bf16 v[152:155], v[220:223], v[128:131], v[152:155]
    ds_read_b64_tr_b16 v[216:217], v243 offset:8192
    v_mfma_f32_16x16x32_bf16 v[156:159], v[220:223], v[132:135], v[156:159]
    ds_read_b64_tr_b16 v[218:219], v243 offset:8704
    buffer_store_dwordx4 v[236:239], v245, s[24:27], s48 offen sc1
    s_add_u32 m0, s52, 0x14000
    s_add_u32 s50, s50, 294912
    buffer_load_dwordx4 v247, s[16:19], s50 offen lds
    v_mfma_f32_16x16x32_bf16 v[144:147], v[224:227], v[136:139], v[144:147]
    ds_read_b64_tr_b16 v[220:221], v243 offset:9216
    v_mfma_f32_16x16x32_bf16 v[148:151], v[224:227], v[140:143], v[148:151]
    ds_read_b64_tr_b16 v[222:223], v243 offset:9728
    v_mfma_f32_16x16x32_bf16 v[152:155], v[228:231], v[136:139], v[152:155]
    ds_read_b64_tr_b16 v[224:225], v243 offset:16384
    v_mfma_f32_16x16x32_bf16 v[156:159], v[228:231], v[140:143], v[156:159]
    ds_read_b64_tr_b16 v[226:227], v243 offset:16896
    s_waitcnt lgkmcnt(6)
    v_mfma_f32_16x16x32_bf16 v[192:195], v[208:211], v[0:3], 0
    ds_read_b64_tr_b16 v[228:229], v243 offset:17408
    v_mfma_f32_16x16x32_bf16 v[196:199], v[208:211], v[4:7], 0
    ds_read_b64_tr_b16 v[230:231], v243 offset:17920
    s_add_u32 m0, s52, 0x16000
    s_add_u32 s50, s50, 294912
    buffer_load_dwordx4 v247, s[16:19], s50 offen lds
    v_mfma_f32_16x16x32_bf16 v[200:203], v[212:215], v[0:3], 0
    ds_read_b64_tr_b16 v[208:209], v243 offset:24576
    v_mfma_f32_16x16x32_bf16 v[204:207], v[212:215], v[4:7], 0
    ds_read_b64_tr_b16 v[210:211], v243 offset:25088
    s_waitcnt lgkmcnt(6)
    v_mfma_f32_16x16x32_bf16 v[192:195], v[216:219], v[8:11], v[192:195]
    ds_read_b64_tr_b16 v[212:213], v243 offset:25600
    v_mul_f32 v152, v144, v152
    v_mfma_f32_16x16x32_bf16 v[196:199], v[216:219], v[12:15], v[196:199]
    ds_read_b64_tr_b16 v[214:215], v243 offset:26112
    v_mul_f32 v144, v250, v144
    v_mfma_f32_16x16x32_bf16 v[200:203], v[220:223], v[8:11], v[200:203]
    ds_read_b64_tr_b16 v[216:217], v243 offset:32768
    v_mfma_f32_16x16x32_bf16 v[204:207], v[220:223], v[12:15], v[204:207]
    ds_read_b64_tr_b16 v[218:219], v243 offset:33280
    v_mul_f32 v153, v145, v153
    s_add_u32 m0, s52, 0x18000
    s_add_u32 s50, s50, 294912
    buffer_load_dwordx4 v247, s[16:19], s50 offen lds
    s_waitcnt lgkmcnt(6)
    v_mfma_f32_16x16x32_bf16 v[192:195], v[224:227], v[16:19], v[192:195]
    ds_read_b64_tr_b16 v[220:221], v243 offset:33792
    v_mfma_f32_16x16x32_bf16 v[196:199], v[224:227], v[20:23], v[196:199]
    ds_read_b64_tr_b16 v[222:223], v243 offset:34304
    v_exp_f32 v144, v144
    v_mfma_f32_16x16x32_bf16 v[200:203], v[228:231], v[16:19], v[200:203]
    ds_read_b64_tr_b16 v[224:225], v243 offset:40960
    v_mul_f32 v145, v250, v145
    v_mfma_f32_16x16x32_bf16 v[204:207], v[228:231], v[20:23], v[204:207]
    ds_read_b64_tr_b16 v[226:227], v243 offset:41472
    v_mul_f32 v154, v146, v154
    s_waitcnt lgkmcnt(6)
    v_mfma_f32_16x16x32_bf16 v[192:195], v[208:211], v[24:27], v[192:195]
    ds_read_b64_tr_b16 v[228:229], v243 offset:41984
    v_mfma_f32_16x16x32_bf16 v[196:199], v[208:211], v[28:31], v[196:199]
    ds_read_b64_tr_b16 v[230:231], v243 offset:42496
    v_add_f32 v144, 1.0, v144
    s_add_u32 m0, s52, 0x1a000
    s_add_u32 s50, s50, 294912
    buffer_load_dwordx4 v247, s[16:19], s50 offen lds
    v_mfma_f32_16x16x32_bf16 v[200:203], v[212:215], v[24:27], v[200:203]
    ds_read_b64_tr_b16 v[208:209], v243 offset:49152
    v_mfma_f32_16x16x32_bf16 v[204:207], v[212:215], v[28:31], v[204:207]
    ds_read_b64_tr_b16 v[210:211], v243 offset:49664
    v_exp_f32 v145, v145
    s_waitcnt lgkmcnt(6)
    v_mfma_f32_16x16x32_bf16 v[192:195], v[216:219], v[32:35], v[192:195]
    ds_read_b64_tr_b16 v[212:213], v243 offset:50176
    v_mfma_f32_16x16x32_bf16 v[196:199], v[216:219], v[36:39], v[196:199]
    ds_read_b64_tr_b16 v[214:215], v243 offset:50688
    v_mul_f32 v146, v250, v146
    v_mfma_f32_16x16x32_bf16 v[200:203], v[220:223], v[32:35], v[200:203]
    ds_read_b64_tr_b16 v[216:217], v243 offset:57344
    v_mul_f32 v155, v147, v155
    v_mfma_f32_16x16x32_bf16 v[204:207], v[220:223], v[36:39], v[204:207]
    ds_read_b64_tr_b16 v[218:219], v243 offset:57856
    v_rcp_f32 v144, v144
    s_add_u32 m0, s52, 0x1c000
    s_add_u32 s50, s50, 294912
    buffer_load_dwordx4 v247, s[16:19], s50 offen lds
    s_waitcnt lgkmcnt(6)
    v_mfma_f32_16x16x32_bf16 v[192:195], v[224:227], v[40:43], v[192:195]
    ds_read_b64_tr_b16 v[220:221], v243 offset:58368
    v_mfma_f32_16x16x32_bf16 v[196:199], v[224:227], v[44:47], v[196:199]
    ds_read_b64_tr_b16 v[222:223], v243 offset:58880
    v_add_f32 v145, 1.0, v145
    v_mfma_f32_16x16x32_bf16 v[200:203], v[228:231], v[40:43], v[200:203]
    v_add_u32 v243, 0x10000, v243
    ds_read_b64_tr_b16 v[224:225], v243 offset:0
    v_mfma_f32_16x16x32_bf16 v[204:207], v[228:231], v[44:47], v[204:207]
    ds_read_b64_tr_b16 v[226:227], v243 offset:512
    v_exp_f32 v146, v146
    s_waitcnt lgkmcnt(6)
    v_mfma_f32_16x16x32_bf16 v[192:195], v[208:211], v[48:51], v[192:195]
    ds_read_b64_tr_b16 v[228:229], v243 offset:1024
    v_mfma_f32_16x16x32_bf16 v[196:199], v[208:211], v[52:55], v[196:199]
    ds_read_b64_tr_b16 v[230:231], v243 offset:1536
    v_mul_f32 v147, v250, v147
    s_add_u32 m0, s52, 0x1e000
    s_add_u32 s50, s50, 294912
    buffer_load_dwordx4 v247, s[16:19], s50 offen lds
    v_mfma_f32_16x16x32_bf16 v[200:203], v[212:215], v[48:51], v[200:203]
    v_subrev_u32 v242, 0x20000, v242
    ds_read_b64_tr_b16 v[208:209], v242 offset:0
    v_mul_f32 v156, v148, v156
    v_mfma_f32_16x16x32_bf16 v[204:207], v[212:215], v[52:55], v[204:207]
    ds_read_b64_tr_b16 v[210:211], v242 offset:512
    v_mul_f32 v152, v144, v152
    s_waitcnt lgkmcnt(6)
    v_mfma_f32_16x16x32_bf16 v[192:195], v[216:219], v[56:59], v[192:195]
    ds_read_b64_tr_b16 v[212:213], v242 offset:1024
    v_mfma_f32_16x16x32_bf16 v[196:199], v[216:219], v[60:63], v[196:199]
    ds_read_b64_tr_b16 v[214:215], v242 offset:1536
    v_rcp_f32 v145, v145
    s_setprio 2
    v_mfma_f32_16x16x32_bf16 v[200:203], v[220:223], v[56:59], v[200:203]
    ds_read_b64_tr_b16 v[216:217], v242 offset:8192
    v_mfma_f32_16x16x32_bf16 v[204:207], v[220:223], v[60:63], v[204:207]
    ds_read_b64_tr_b16 v[218:219], v242 offset:8704
    v_add_f32 v146, 1.0, v146
    s_add_u32 m0, s52, 0x20000
    s_add_u32 s50, s50, 294912
    buffer_load_dwordx4 v247, s[16:19], s50 offen lds
    s_waitcnt lgkmcnt(6)
    v_mfma_f32_16x16x32_bf16 v[192:195], v[224:227], v[64:67], v[192:195]
    ds_read_b64_tr_b16 v[220:221], v242 offset:9216
    v_exp_f32 v147, v147
    v_mfma_f32_16x16x32_bf16 v[196:199], v[224:227], v[68:71], v[196:199]
    ds_read_b64_tr_b16 v[222:223], v242 offset:9728
    v_mul_f32 v148, v250, v148
    v_mfma_f32_16x16x32_bf16 v[200:203], v[228:231], v[64:67], v[200:203]
    ds_read_b64_tr_b16 v[224:225], v242 offset:16384
    v_mfma_f32_16x16x32_bf16 v[204:207], v[228:231], v[68:71], v[204:207]
    ds_read_b64_tr_b16 v[226:227], v242 offset:16896
    v_mul_f32 v157, v149, v157
    s_waitcnt lgkmcnt(6)
    v_mfma_f32_16x16x32_bf16 v[176:179], v[208:211], v[0:3], 0
    ds_read_b64_tr_b16 v[228:229], v242 offset:17408
    v_mfma_f32_16x16x32_bf16 v[180:183], v[208:211], v[4:7], 0
    ds_read_b64_tr_b16 v[230:231], v242 offset:17920
    v_mul_f32 v153, v145, v153
    s_add_u32 m0, s52, 0x22000
    s_add_u32 s50, s50, 294912
    buffer_load_dwordx4 v247, s[16:19], s50 offen lds
    v_mfma_f32_16x16x32_bf16 v[184:187], v[212:215], v[0:3], 0
    ds_read_b64_tr_b16 v[208:209], v242 offset:24576
    v_mfma_f32_16x16x32_bf16 v[188:191], v[212:215], v[4:7], 0
    ds_read_b64_tr_b16 v[210:211], v242 offset:25088
    v_rcp_f32 v146, v146
    s_waitcnt lgkmcnt(6)
    v_mfma_f32_16x16x32_bf16 v[176:179], v[216:219], v[8:11], v[176:179]
    ds_read_b64_tr_b16 v[212:213], v242 offset:25600
    v_add_f32 v147, 1.0, v147
    v_mfma_f32_16x16x32_bf16 v[180:183], v[216:219], v[12:15], v[180:183]
    ds_read_b64_tr_b16 v[214:215], v242 offset:26112
    v_exp_f32 v148, v148
    v_mfma_f32_16x16x32_bf16 v[184:187], v[220:223], v[8:11], v[184:187]
    ds_read_b64_tr_b16 v[216:217], v242 offset:32768
    v_mfma_f32_16x16x32_bf16 v[188:191], v[220:223], v[12:15], v[188:191]
    ds_read_b64_tr_b16 v[218:219], v242 offset:33280
    v_mul_f32 v149, v250, v149
    s_add_u32 m0, s52, 0x24000
    s_add_u32 s50, s50, 294912
    buffer_load_dwordx4 v247, s[16:19], s50 offen lds
    s_waitcnt lgkmcnt(6)
    v_mfma_f32_16x16x32_bf16 v[176:179], v[224:227], v[16:19], v[176:179]
    ds_read_b64_tr_b16 v[220:221], v242 offset:33792
    v_mul_f32 v158, v150, v158
    v_mfma_f32_16x16x32_bf16 v[180:183], v[224:227], v[20:23], v[180:183]
    ds_read_b64_tr_b16 v[222:223], v242 offset:34304
    v_lshlrev_b32 v252, 3, v245
    v_mov_b32 v253, 1
    s_waitcnt vmcnt(11)
    s_mov_b32 exec_lo, s100
    s_mov_b32 exec_hi, 0
    buffer_atomic_add v253, v252, s[28:31], s3 offen
    s_mov_b64 exec, -1
    v_mfma_f32_16x16x32_bf16 v[184:187], v[228:231], v[16:19], v[184:187]
    ds_read_b64_tr_b16 v[224:225], v242 offset:40960
    v_mfma_f32_16x16x32_bf16 v[188:191], v[228:231], v[20:23], v[188:191]
    ds_read_b64_tr_b16 v[226:227], v242 offset:41472
    v_mul_f32 v154, v146, v154
    s_waitcnt lgkmcnt(6)
    v_mfma_f32_16x16x32_bf16 v[176:179], v[208:211], v[24:27], v[176:179]
    ds_read_b64_tr_b16 v[228:229], v242 offset:41984
    v_rcp_f32 v147, v147
    v_mfma_f32_16x16x32_bf16 v[180:183], v[208:211], v[28:31], v[180:183]
    ds_read_b64_tr_b16 v[230:231], v242 offset:42496
    v_add_f32 v148, 1.0, v148
    v_mfma_f32_16x16x32_bf16 v[184:187], v[212:215], v[24:27], v[184:187]
    ds_read_b64_tr_b16 v[208:209], v242 offset:49152
    v_mfma_f32_16x16x32_bf16 v[188:191], v[212:215], v[28:31], v[188:191]
    ds_read_b64_tr_b16 v[210:211], v242 offset:49664
    v_exp_f32 v149, v149
    s_waitcnt lgkmcnt(6)
    v_mfma_f32_16x16x32_bf16 v[176:179], v[216:219], v[32:35], v[176:179]
    ds_read_b64_tr_b16 v[212:213], v242 offset:50176
    v_mul_f32 v150, v250, v150
    v_mfma_f32_16x16x32_bf16 v[180:183], v[216:219], v[36:39], v[180:183]
    ds_read_b64_tr_b16 v[214:215], v242 offset:50688
    v_lshlrev_b32 v252, 5, v245
    v_mov_b32 v253, 1
    s_waitcnt vmcnt(10)
    s_mov_b64 exec, 7
    buffer_atomic_add v253, v252, s[24:27], s39 offen offset:0
    s_mov_b64 exec, -1
    v_mfma_f32_16x16x32_bf16 v[184:187], v[220:223], v[32:35], v[184:187]
    ds_read_b64_tr_b16 v[216:217], v242 offset:57344
    v_mul_f32 v159, v151, v159
    v_mfma_f32_16x16x32_bf16 v[188:191], v[220:223], v[36:39], v[188:191]
    ds_read_b64_tr_b16 v[218:219], v242 offset:57856
    v_mul_f32 v155, v147, v155
    s_waitcnt lgkmcnt(6)
    v_mfma_f32_16x16x32_bf16 v[176:179], v[224:227], v[40:43], v[176:179]
    ds_read_b64_tr_b16 v[220:221], v242 offset:58368
    v_mfma_f32_16x16x32_bf16 v[180:183], v[224:227], v[44:47], v[180:183]
    ds_read_b64_tr_b16 v[222:223], v242 offset:58880
    v_rcp_f32 v148, v148
    v_mfma_f32_16x16x32_bf16 v[184:187], v[228:231], v[40:43], v[184:187]
    v_add_u32 v242, 0x10000, v242
    ds_read_b64_tr_b16 v[224:225], v242 offset:0
    v_mfma_f32_16x16x32_bf16 v[188:191], v[228:231], v[44:47], v[188:191]
    ds_read_b64_tr_b16 v[226:227], v242 offset:512
    v_add_f32 v149, 1.0, v149
    s_waitcnt lgkmcnt(6)
    v_mfma_f32_16x16x32_bf16 v[176:179], v[208:211], v[48:51], v[176:179]
    ds_read_b64_tr_b16 v[228:229], v242 offset:1024
    v_mfma_f32_16x16x32_bf16 v[180:183], v[208:211], v[52:55], v[180:183]
    ds_read_b64_tr_b16 v[230:231], v242 offset:1536
    v_exp_f32 v150, v150
    v_mfma_f32_16x16x32_bf16 v[184:187], v[212:215], v[48:51], v[184:187]
    v_subrev_u32 v241, 0x20000, v241
    ds_read_b64_tr_b16 v[208:209], v241 offset:0
    v_mul_f32 v151, v250, v151
    v_mfma_f32_16x16x32_bf16 v[188:191], v[212:215], v[52:55], v[188:191]
    ds_read_b64_tr_b16 v[210:211], v241 offset:512
    v_mul_f32 v156, v148, v156
    s_waitcnt lgkmcnt(6)
    v_mfma_f32_16x16x32_bf16 v[176:179], v[216:219], v[56:59], v[176:179]
    ds_read_b64_tr_b16 v[212:213], v241 offset:1024
    v_mfma_f32_16x16x32_bf16 v[180:183], v[216:219], v[60:63], v[180:183]
    ds_read_b64_tr_b16 v[214:215], v241 offset:1536
    v_rcp_f32 v149, v149
    s_setprio 1
    v_mfma_f32_16x16x32_bf16 v[184:187], v[220:223], v[56:59], v[184:187]
    ds_read_b64_tr_b16 v[216:217], v241 offset:8192
    v_mfma_f32_16x16x32_bf16 v[188:191], v[220:223], v[60:63], v[188:191]
    ds_read_b64_tr_b16 v[218:219], v241 offset:8704
    v_add_f32 v150, 1.0, v150
    s_waitcnt lgkmcnt(6)
    v_mfma_f32_16x16x32_bf16 v[176:179], v[224:227], v[64:67], v[176:179]
    ds_read_b64_tr_b16 v[220:221], v241 offset:9216
    v_mfma_f32_16x16x32_bf16 v[180:183], v[224:227], v[68:71], v[180:183]
    ds_read_b64_tr_b16 v[222:223], v241 offset:9728
    v_exp_f32 v151, v151
    v_mfma_f32_16x16x32_bf16 v[184:187], v[228:231], v[64:67], v[184:187]
    ds_read_b64_tr_b16 v[224:225], v241 offset:16384
    v_mul_f32 v157, v149, v157
    v_mfma_f32_16x16x32_bf16 v[188:191], v[228:231], v[68:71], v[188:191]
    ds_read_b64_tr_b16 v[226:227], v241 offset:16896
    v_rcp_f32 v150, v150
    s_mov_b32 exec_lo, 0x7ff
    s_mov_b32 exec_hi, 0x0
    buffer_load_dword v255, v254, s[4:7], s36 offen
    s_mov_b64 exec, -1
    s_waitcnt lgkmcnt(6)
    v_mfma_f32_16x16x32_bf16 v[160:163], v[208:211], v[0:3], 0
    ds_read_b64_tr_b16 v[228:229], v241 offset:17408
    v_mfma_f32_16x16x32_bf16 v[164:167], v[208:211], v[4:7], 0
    ds_read_b64_tr_b16 v[230:231], v241 offset:17920
    v_add_f32 v151, 1.0, v151
    v_mfma_f32_16x16x32_bf16 v[168:171], v[212:215], v[0:3], 0
    ds_read_b64_tr_b16 v[208:209], v241 offset:24576
    v_mfma_f32_16x16x32_bf16 v[172:175], v[212:215], v[4:7], 0
    ds_read_b64_tr_b16 v[210:211], v241 offset:25088
    v_mul_f32 v158, v150, v158
    s_waitcnt lgkmcnt(6)
    v_mfma_f32_16x16x32_bf16 v[160:163], v[216:219], v[8:11], v[160:163]
    ds_read_b64_tr_b16 v[212:213], v241 offset:25600
    v_rcp_f32 v151, v151
    v_mfma_f32_16x16x32_bf16 v[164:167], v[216:219], v[12:15], v[164:167]
    ds_read_b64_tr_b16 v[214:215], v241 offset:26112
    s_nop 0
    v_mfma_f32_16x16x32_bf16 v[168:171], v[220:223], v[8:11], v[168:171]
    ds_read_b64_tr_b16 v[216:217], v241 offset:32768
    v_mfma_f32_16x16x32_bf16 v[172:175], v[220:223], v[12:15], v[172:175]
    ds_read_b64_tr_b16 v[218:219], v241 offset:33280
    v_mul_f32 v159, v151, v159
    s_mov_b32 exec_lo, 0x1ff800
    s_mov_b32 exec_hi, 0x0
    buffer_load_dword v255, v254, s[4:7], s36 offen
    s_mov_b64 exec, -1
    s_waitcnt lgkmcnt(6)
    v_mfma_f32_16x16x32_bf16 v[160:163], v[224:227], v[16:19], v[160:163]
    ds_read_b64_tr_b16 v[220:221], v241 offset:33792
    v_mfma_f32_16x16x32_bf16 v[164:167], v[224:227], v[20:23], v[164:167]
    ds_read_b64_tr_b16 v[222:223], v241 offset:34304
    v_cvt_pk_bf16_f32 v232, v152, v153
    v_mfma_f32_16x16x32_bf16 v[168:171], v[228:231], v[16:19], v[168:171]
    ds_read_b64_tr_b16 v[224:225], v241 offset:40960
    v_mfma_f32_16x16x32_bf16 v[172:175], v[228:231], v[20:23], v[172:175]
    ds_read_b64_tr_b16 v[226:227], v241 offset:41472
    v_cvt_pk_bf16_f32 v233, v154, v155
    s_waitcnt lgkmcnt(6)
    v_mfma_f32_16x16x32_bf16 v[160:163], v[208:211], v[24:27], v[160:163]
    ds_read_b64_tr_b16 v[228:229], v241 offset:41984
    v_cvt_pk_bf16_f32 v236, v156, v157
    v_mfma_f32_16x16x32_bf16 v[164:167], v[208:211], v[28:31], v[164:167]
    ds_read_b64_tr_b16 v[230:231], v241 offset:42496
    v_cvt_pk_bf16_f32 v237, v158, v159
    v_mfma_f32_16x16x32_bf16 v[168:171], v[212:215], v[24:27], v[168:171]
    ds_read_b64_tr_b16 v[208:209], v241 offset:49152
    v_mfma_f32_16x16x32_bf16 v[172:175], v[212:215], v[28:31], v[172:175]
    ds_read_b64_tr_b16 v[210:211], v241 offset:49664
    buffer_store_dwordx2 v[232:233], v251, s[24:27], s44 offen sc1
    s_mov_b32 exec_lo, 0x7ff
    s_mov_b32 exec_hi, 0x0
    buffer_load_dword v255, v254, s[8:11], s37 offen
    s_mov_b64 exec, -1
    s_waitcnt lgkmcnt(6)
    v_mfma_f32_16x16x32_bf16 v[160:163], v[216:219], v[32:35], v[160:163]
    ds_read_b64_tr_b16 v[212:213], v241 offset:50176
    v_mfma_f32_16x16x32_bf16 v[164:167], v[216:219], v[36:39], v[164:167]
    ds_read_b64_tr_b16 v[214:215], v241 offset:50688
    s_add_u32 s48, s44, 148480
    v_mfma_f32_16x16x32_bf16 v[168:171], v[220:223], v[32:35], v[168:171]
    ds_read_b64_tr_b16 v[216:217], v241 offset:57344
    v_mfma_f32_16x16x32_bf16 v[172:175], v[220:223], v[36:39], v[172:175]
    ds_read_b64_tr_b16 v[218:219], v241 offset:57856
    buffer_store_dwordx2 v[236:237], v251, s[24:27], s48 offen sc1
    s_waitcnt lgkmcnt(6)
    v_mfma_f32_16x16x32_bf16 v[160:163], v[224:227], v[40:43], v[160:163]
    ds_read_b64_tr_b16 v[220:221], v241 offset:58368
    v_mfma_f32_16x16x32_bf16 v[164:167], v[224:227], v[44:47], v[164:167]
    ds_read_b64_tr_b16 v[222:223], v241 offset:58880
    v_mfma_f32_16x16x32_bf16 v[168:171], v[228:231], v[40:43], v[168:171]
    v_add_u32 v241, 0x10000, v241
    ds_read_b64_tr_b16 v[224:225], v241 offset:0
    v_mfma_f32_16x16x32_bf16 v[172:175], v[228:231], v[44:47], v[172:175]
    ds_read_b64_tr_b16 v[226:227], v241 offset:512
    s_waitcnt lgkmcnt(6)
    v_mfma_f32_16x16x32_bf16 v[160:163], v[208:211], v[48:51], v[160:163]
    ds_read_b64_tr_b16 v[228:229], v241 offset:1024
    v_mfma_f32_16x16x32_bf16 v[164:167], v[208:211], v[52:55], v[164:167]
    ds_read_b64_tr_b16 v[230:231], v241 offset:1536
    v_mfma_f32_16x16x32_bf16 v[168:171], v[212:215], v[48:51], v[168:171]
    v_subrev_u32 v240, 0x20000, v240
    ds_read_b64_tr_b16 v[208:209], v240 offset:0
    v_mfma_f32_16x16x32_bf16 v[172:175], v[212:215], v[52:55], v[172:175]
    ds_read_b64_tr_b16 v[210:211], v240 offset:512
    s_waitcnt lgkmcnt(6)
    v_mfma_f32_16x16x32_bf16 v[160:163], v[216:219], v[56:59], v[160:163]
    ds_read_b64_tr_b16 v[212:213], v240 offset:1024
    v_mfma_f32_16x16x32_bf16 v[164:167], v[216:219], v[60:63], v[164:167]
    ds_read_b64_tr_b16 v[214:215], v240 offset:1536
    s_and_b32 s15, s13, 1
    s_lshr_b32 s32, s13, 1
    s_lshl_b32 s32, s32, 3
    s_add_u32 s32, s32, s14
    s_sub_u32 s32, s32, 24
    s_mul_i32 s54, s15, 72
    s_mul_i32 s45, s12, 9
    s_add_u32 s54, s54, s45
    s_lshl_b32 s54, s54, 14
    s_lshl_b32 s45, s32, 9
    s_add_u32 s54, s54, s45
    s_add_u32 s54, s54, 0x1300000
    s_mul_i32 s55, s12, 5616
    s_mul_i32 s53, s12, 4608
    s_lshl_b32 s101, s32, 1
    s_add_u32 s101, s101, s15
    s_lshl_b32 s101, s101, 7
    s_add_u32 s101, s101, 0x279e000
    s_mul_i32 s49, s15, 3
    s_add_u32 s49, s49, 15
    s_cmp_eq_u32 s32, 0
    s_cselect_b32 s45, 2, 3
    s_mul_i32 s49, s49, s45
    s_setprio 0
    v_mfma_f32_16x16x32_bf16 v[168:171], v[220:223], v[56:59], v[168:171]
    ds_read_b64_tr_b16 v[216:217], v240 offset:8192
    v_mfma_f32_16x16x32_bf16 v[172:175], v[220:223], v[60:63], v[172:175]
    ds_read_b64_tr_b16 v[218:219], v240 offset:8704
    s_waitcnt lgkmcnt(6)
    v_mfma_f32_16x16x32_bf16 v[160:163], v[224:227], v[64:67], v[160:163]
    ds_read_b64_tr_b16 v[220:221], v240 offset:9216
    v_lshrrev_b32 v249, 4, v245
    v_mfma_f32_16x16x32_bf16 v[164:167], v[224:227], v[68:71], v[164:167]
    ds_read_b64_tr_b16 v[222:223], v240 offset:9728
    v_lshrrev_b32 v252, 3, v249
    v_mfma_f32_16x16x32_bf16 v[168:171], v[228:231], v[64:67], v[168:171]
    ds_read_b64_tr_b16 v[224:225], v240 offset:16384
    v_mfma_f32_16x16x32_bf16 v[172:175], v[228:231], v[68:71], v[172:175]
    ds_read_b64_tr_b16 v[226:227], v240 offset:16896
    v_bfe_u32 v253, v249, 1, 2
    s_waitcnt lgkmcnt(6)
    v_mfma_f32_16x16x32_bf16 v[144:147], v[208:211], v[0:3], 0
    ds_read_b64_tr_b16 v[228:229], v240 offset:17408
    v_mfma_f32_16x16x32_bf16 v[148:151], v[208:211], v[4:7], 0
    ds_read_b64_tr_b16 v[230:231], v240 offset:17920
    v_mul_u32_u24 v246, 1152, v252
    v_mfma_f32_16x16x32_bf16 v[152:155], v[212:215], v[0:3], 0
    ds_read_b64_tr_b16 v[208:209], v240 offset:24576
    v_mfma_f32_16x16x32_bf16 v[156:159], v[212:215], v[4:7], 0
    ds_read_b64_tr_b16 v[210:211], v240 offset:25088
    v_lshrrev_b32 v252, 4, v249
    s_waitcnt lgkmcnt(6)
    v_mfma_f32_16x16x32_bf16 v[144:147], v[216:219], v[8:11], v[144:147]
    ds_read_b64_tr_b16 v[212:213], v240 offset:25600
    v_mfma_f32_16x16x32_bf16 v[148:151], v[216:219], v[12:15], v[148:151]
    ds_read_b64_tr_b16 v[214:215], v240 offset:26112
    v_xor_b32 v253, v253, v252
    v_mfma_f32_16x16x32_bf16 v[152:155], v[220:223], v[8:11], v[152:155]
    ds_read_b64_tr_b16 v[216:217], v240 offset:32768
    v_mfma_f32_16x16x32_bf16 v[156:159], v[220:223], v[12:15], v[156:159]
    ds_read_b64_tr_b16 v[218:219], v240 offset:33280
    v_lshl_add_u32 v246, v253, 5, v246
    s_waitcnt lgkmcnt(6)
    v_mfma_f32_16x16x32_bf16 v[144:147], v[224:227], v[16:19], v[144:147]
    ds_read_b64_tr_b16 v[220:221], v240 offset:33792
    v_mfma_f32_16x16x32_bf16 v[148:151], v[224:227], v[20:23], v[148:151]
    ds_read_b64_tr_b16 v[222:223], v240 offset:34304
    v_and_b32 v252, 16, v245
    v_mfma_f32_16x16x32_bf16 v[152:155], v[228:231], v[16:19], v[152:155]
    ds_read_b64_tr_b16 v[224:225], v240 offset:40960
    v_mfma_f32_16x16x32_bf16 v[156:159], v[228:231], v[20:23], v[156:159]
    ds_read_b64_tr_b16 v[226:227], v240 offset:41472
    v_add_u32 v246, v252, v246
    s_waitcnt lgkmcnt(6)
    v_mfma_f32_16x16x32_bf16 v[144:147], v[208:211], v[24:27], v[144:147]
    ds_read_b64_tr_b16 v[228:229], v240 offset:41984
    v_lshrrev_b32 v252, 2, v249
    v_mfma_f32_16x16x32_bf16 v[148:151], v[208:211], v[28:31], v[148:151]
    ds_read_b64_tr_b16 v[230:231], v240 offset:42496
    v_and_b32 v253, 3, v249
    v_mfma_f32_16x16x32_bf16 v[152:155], v[212:215], v[24:27], v[152:155]
    ds_read_b64_tr_b16 v[208:209], v240 offset:49152
    v_mfma_f32_16x16x32_bf16 v[156:159], v[212:215], v[28:31], v[156:159]
    ds_read_b64_tr_b16 v[210:211], v240 offset:49664
    v_lshlrev_b32 v253, 3, v253
    s_waitcnt lgkmcnt(6)
    v_mfma_f32_16x16x32_bf16 v[144:147], v[216:219], v[32:35], v[144:147]
    ds_read_b64_tr_b16 v[212:213], v240 offset:50176
    v_mfma_f32_16x16x32_bf16 v[148:151], v[216:219], v[36:39], v[148:151]
    ds_read_b64_tr_b16 v[214:215], v240 offset:50688
    v_lshl_add_u32 v248, v252, 7, v253
    v_mfma_f32_16x16x32_bf16 v[152:155], v[220:223], v[32:35], v[152:155]
    ds_read_b64_tr_b16 v[216:217], v240 offset:57344
    v_mfma_f32_16x16x32_bf16 v[156:159], v[220:223], v[36:39], v[156:159]
    ds_read_b64_tr_b16 v[218:219], v240 offset:57856
    v_bfe_u32 v253, v249, 3, 2
    s_waitcnt lgkmcnt(6)
    v_mfma_f32_16x16x32_bf16 v[144:147], v[224:227], v[40:43], v[144:147]
    ds_read_b64_tr_b16 v[220:221], v240 offset:58368
    v_mfma_f32_16x16x32_bf16 v[148:151], v[224:227], v[44:47], v[148:151]
    ds_read_b64_tr_b16 v[222:223], v240 offset:58880
    v_lshl_add_u32 v248, v253, 5, v248
    v_mfma_f32_16x16x32_bf16 v[152:155], v[228:231], v[40:43], v[152:155]
    v_add_u32 v240, 0x10000, v240
    ds_read_b64_tr_b16 v[224:225], v240 offset:0
    v_mfma_f32_16x16x32_bf16 v[156:159], v[228:231], v[44:47], v[156:159]
    ds_read_b64_tr_b16 v[226:227], v240 offset:512
    v_lshrrev_b32 v252, 5, v249
    s_waitcnt lgkmcnt(6)
    v_mfma_f32_16x16x32_bf16 v[144:147], v[208:211], v[48:51], v[144:147]
    ds_read_b64_tr_b16 v[228:229], v240 offset:1024
    v_mfma_f32_16x16x32_bf16 v[148:151], v[208:211], v[52:55], v[148:151]
    ds_read_b64_tr_b16 v[230:231], v240 offset:1536
    v_and_b32 v244, 0x1ff, v245
    v_mfma_f32_16x16x32_bf16 v[152:155], v[212:215], v[48:51], v[152:155]
    v_mfma_f32_16x16x32_bf16 v[156:159], v[212:215], v[52:55], v[156:159]
    v_lshl_add_u32 v244, v252, 14, v244
    s_waitcnt lgkmcnt(4)
    v_mfma_f32_16x16x32_bf16 v[144:147], v[216:219], v[56:59], v[144:147]
    v_mfma_f32_16x16x32_bf16 v[148:151], v[216:219], v[60:63], v[148:151]
    s_waitcnt vmcnt(7) lgkmcnt(0)
    s_barrier
    ds_read_b64_tr_b16 v[208:209], v240 offset:16384
    ds_read_b64_tr_b16 v[210:211], v240 offset:16896
    ds_read_b64_tr_b16 v[212:213], v240 offset:17408
    ds_read_b64_tr_b16 v[214:215], v240 offset:17920
    s_setprio 3
    v_mfma_f32_16x16x32_bf16 v[152:155], v[220:223], v[56:59], v[152:155]
    ds_read_b64_tr_b16 v[216:217], v240 offset:24576
    v_mfma_f32_16x16x32_bf16 v[156:159], v[220:223], v[60:63], v[156:159]
    ds_read_b64_tr_b16 v[218:219], v240 offset:25088
    v_mfma_f32_16x16x32_bf16 v[144:147], v[224:227], v[64:67], v[144:147]
    ds_read_b64_tr_b16 v[220:221], v240 offset:25600
    v_mfma_f32_16x16x32_bf16 v[148:151], v[224:227], v[68:71], v[148:151]
    ds_read_b64_tr_b16 v[222:223], v240 offset:26112
    v_mfma_f32_16x16x32_bf16 v[152:155], v[228:231], v[64:67], v[152:155]
    ds_read_b64_tr_b16 v[224:225], v240 offset:32768
    v_mfma_f32_16x16x32_bf16 v[156:159], v[228:231], v[68:71], v[156:159]
    ds_read_b64_tr_b16 v[226:227], v240 offset:33280
    s_waitcnt lgkmcnt(6)
    v_mfma_f32_16x16x32_bf16 v[144:147], v[208:211], v[72:75], v[144:147]
    ds_read_b64_tr_b16 v[228:229], v240 offset:33792
    v_mfma_f32_16x16x32_bf16 v[148:151], v[208:211], v[76:79], v[148:151]
    ds_read_b64_tr_b16 v[230:231], v240 offset:34304
    v_mfma_f32_16x16x32_bf16 v[152:155], v[212:215], v[72:75], v[152:155]
    ds_read_b64_tr_b16 v[208:209], v240 offset:40960
    v_mfma_f32_16x16x32_bf16 v[156:159], v[212:215], v[76:79], v[156:159]
    ds_read_b64_tr_b16 v[210:211], v240 offset:41472
    s_waitcnt lgkmcnt(6)
    v_mfma_f32_16x16x32_bf16 v[144:147], v[216:219], v[80:83], v[144:147]
    ds_read_b64_tr_b16 v[212:213], v240 offset:41984
    v_mfma_f32_16x16x32_bf16 v[148:151], v[216:219], v[84:87], v[148:151]
    ds_read_b64_tr_b16 v[214:215], v240 offset:42496
    v_mfma_f32_16x16x32_bf16 v[152:155], v[220:223], v[80:83], v[152:155]
    ds_read_b64_tr_b16 v[216:217], v240 offset:49152
    v_mfma_f32_16x16x32_bf16 v[156:159], v[220:223], v[84:87], v[156:159]
    ds_read_b64_tr_b16 v[218:219], v240 offset:49664
    s_waitcnt lgkmcnt(6)
    v_mfma_f32_16x16x32_bf16 v[144:147], v[224:227], v[88:91], v[144:147]
    ds_read_b64_tr_b16 v[220:221], v240 offset:50176
    v_mfma_f32_16x16x32_bf16 v[148:151], v[224:227], v[92:95], v[148:151]
    ds_read_b64_tr_b16 v[222:223], v240 offset:50688
    v_mfma_f32_16x16x32_bf16 v[152:155], v[228:231], v[88:91], v[152:155]
    ds_read_b64_tr_b16 v[224:225], v240 offset:57344
    v_mfma_f32_16x16x32_bf16 v[156:159], v[228:231], v[92:95], v[156:159]
    ds_read_b64_tr_b16 v[226:227], v240 offset:57856
    s_waitcnt lgkmcnt(6)
    v_mfma_f32_16x16x32_bf16 v[144:147], v[208:211], v[96:99], v[144:147]
    ds_read_b64_tr_b16 v[228:229], v240 offset:58368
    v_mfma_f32_16x16x32_bf16 v[148:151], v[208:211], v[100:103], v[148:151]
    ds_read_b64_tr_b16 v[230:231], v240 offset:58880
    v_mfma_f32_16x16x32_bf16 v[152:155], v[212:215], v[96:99], v[152:155]
    v_add_u32 v240, 0x10000, v240
    ds_read_b64_tr_b16 v[208:209], v240 offset:0
    v_mfma_f32_16x16x32_bf16 v[156:159], v[212:215], v[100:103], v[156:159]
    ds_read_b64_tr_b16 v[210:211], v240 offset:512
    s_waitcnt lgkmcnt(6)
    v_mfma_f32_16x16x32_bf16 v[144:147], v[216:219], v[104:107], v[144:147]
    ds_read_b64_tr_b16 v[212:213], v240 offset:1024
    v_mfma_f32_16x16x32_bf16 v[148:151], v[216:219], v[108:111], v[148:151]
    ds_read_b64_tr_b16 v[214:215], v240 offset:1536
    v_mfma_f32_16x16x32_bf16 v[152:155], v[220:223], v[104:107], v[152:155]
    ds_read_b64_tr_b16 v[216:217], v240 offset:8192
    v_mfma_f32_16x16x32_bf16 v[156:159], v[220:223], v[108:111], v[156:159]
    ds_read_b64_tr_b16 v[218:219], v240 offset:8704
    s_waitcnt lgkmcnt(6)
    v_mfma_f32_16x16x32_bf16 v[144:147], v[224:227], v[112:115], v[144:147]
    ds_read_b64_tr_b16 v[220:221], v240 offset:9216
    v_mfma_f32_16x16x32_bf16 v[148:151], v[224:227], v[116:119], v[148:151]
    ds_read_b64_tr_b16 v[222:223], v240 offset:9728
    v_mfma_f32_16x16x32_bf16 v[152:155], v[228:231], v[112:115], v[152:155]
    ds_read_b64_tr_b16 v[224:225], v240 offset:16384
    v_mfma_f32_16x16x32_bf16 v[156:159], v[228:231], v[116:119], v[156:159]
    ds_read_b64_tr_b16 v[226:227], v240 offset:16896
    s_waitcnt lgkmcnt(6)
    v_mfma_f32_16x16x32_bf16 v[144:147], v[208:211], v[120:123], v[144:147]
    ds_read_b64_tr_b16 v[228:229], v240 offset:17408
    v_mfma_f32_16x16x32_bf16 v[148:151], v[208:211], v[124:127], v[148:151]
    ds_read_b64_tr_b16 v[230:231], v240 offset:17920
    v_mov_b32 v252, 0
    v_mov_b32 v253, 0
    s_mov_b64 exec, 1
    buffer_atomic_add v252, v253, s[24:27], s101 offen offset:0 sc0
    s_mov_b64 exec, -1
    v_mfma_f32_16x16x32_bf16 v[152:155], v[212:215], v[120:123], v[152:155]
    ds_read_b64_tr_b16 v[208:209], v241 offset:16384
    v_mfma_f32_16x16x32_bf16 v[156:159], v[212:215], v[124:127], v[156:159]
    ds_read_b64_tr_b16 v[210:211], v241 offset:16896
    s_waitcnt lgkmcnt(6)
    v_mfma_f32_16x16x32_bf16 v[144:147], v[216:219], v[128:131], v[144:147]
    ds_read_b64_tr_b16 v[212:213], v241 offset:17408
    v_mfma_f32_16x16x32_bf16 v[148:151], v[216:219], v[132:135], v[148:151]
    ds_read_b64_tr_b16 v[214:215], v241 offset:17920
    s_setprio 2
    v_mfma_f32_16x16x32_bf16 v[152:155], v[220:223], v[128:131], v[152:155]
    ds_read_b64_tr_b16 v[216:217], v241 offset:24576
    v_mfma_f32_16x16x32_bf16 v[156:159], v[220:223], v[132:135], v[156:159]
    ds_read_b64_tr_b16 v[218:219], v241 offset:25088
    s_waitcnt lgkmcnt(6)
    v_mfma_f32_16x16x32_bf16 v[144:147], v[224:227], v[136:139], v[144:147]
    ds_read_b64_tr_b16 v[220:221], v241 offset:25600
    v_mfma_f32_16x16x32_bf16 v[148:151], v[224:227], v[140:143], v[148:151]
    ds_read_b64_tr_b16 v[222:223], v241 offset:26112
    v_mfma_f32_16x16x32_bf16 v[152:155], v[228:231], v[136:139], v[152:155]
    ds_read_b64_tr_b16 v[224:225], v241 offset:32768
    v_mfma_f32_16x16x32_bf16 v[156:159], v[228:231], v[140:143], v[156:159]
    ds_read_b64_tr_b16 v[226:227], v241 offset:33280
    s_waitcnt lgkmcnt(6)
    v_mfma_f32_16x16x32_bf16 v[160:163], v[208:211], v[72:75], v[160:163]
    ds_read_b64_tr_b16 v[228:229], v241 offset:33792
    v_mfma_f32_16x16x32_bf16 v[164:167], v[208:211], v[76:79], v[164:167]
    ds_read_b64_tr_b16 v[230:231], v241 offset:34304
    v_mfma_f32_16x16x32_bf16 v[168:171], v[212:215], v[72:75], v[168:171]
    ds_read_b64_tr_b16 v[208:209], v241 offset:40960
    v_mfma_f32_16x16x32_bf16 v[172:175], v[212:215], v[76:79], v[172:175]
    ds_read_b64_tr_b16 v[210:211], v241 offset:41472
    s_waitcnt lgkmcnt(6)
    v_mfma_f32_16x16x32_bf16 v[160:163], v[216:219], v[80:83], v[160:163]
    ds_read_b64_tr_b16 v[212:213], v241 offset:41984
    v_mul_f32 v152, v144, v152
    v_mfma_f32_16x16x32_bf16 v[164:167], v[216:219], v[84:87], v[164:167]
    ds_read_b64_tr_b16 v[214:215], v241 offset:42496
    v_mul_f32 v144, v250, v144
    v_mul_f32 v153, v145, v153
    v_mfma_f32_16x16x32_bf16 v[168:171], v[220:223], v[80:83], v[168:171]
    ds_read_b64_tr_b16 v[216:217], v241 offset:49152
    v_exp_f32 v144, v144
    v_mfma_f32_16x16x32_bf16 v[172:175], v[220:223], v[84:87], v[172:175]
    ds_read_b64_tr_b16 v[218:219], v241 offset:49664
    v_mul_f32 v145, v250, v145
    v_mul_f32 v154, v146, v154
    s_waitcnt lgkmcnt(6)
    v_mfma_f32_16x16x32_bf16 v[160:163], v[224:227], v[88:91], v[160:163]
    ds_read_b64_tr_b16 v[220:221], v241 offset:50176
    v_add_f32 v144, 1.0, v144
    v_mfma_f32_16x16x32_bf16 v[164:167], v[224:227], v[92:95], v[164:167]
    ds_read_b64_tr_b16 v[222:223], v241 offset:50688
    v_exp_f32 v145, v145
    v_mul_f32 v146, v250, v146
    v_mfma_f32_16x16x32_bf16 v[168:171], v[228:231], v[88:91], v[168:171]
    ds_read_b64_tr_b16 v[224:225], v241 offset:57344
    v_mul_f32 v155, v147, v155
    v_mfma_f32_16x16x32_bf16 v[172:175], v[228:231], v[92:95], v[172:175]
    ds_read_b64_tr_b16 v[226:227], v241 offset:57856
    v_rcp_f32 v144, v144
    v_add_f32 v145, 1.0, v145
    s_waitcnt lgkmcnt(6)
    v_mfma_f32_16x16x32_bf16 v[160:163], v[208:211], v[96:99], v[160:163]
    ds_read_b64_tr_b16 v[228:229], v241 offset:58368
    v_exp_f32 v146, v146
    v_mfma_f32_16x16x32_bf16 v[164:167], v[208:211], v[100:103], v[164:167]
    ds_read_b64_tr_b16 v[230:231], v241 offset:58880
    v_mul_f32 v147, v250, v147
    v_mul_f32 v156, v148, v156
    v_mfma_f32_16x16x32_bf16 v[168:171], v[212:215], v[96:99], v[168:171]
    v_add_u32 v241, 0x10000, v241
    ds_read_b64_tr_b16 v[208:209], v241 offset:0
    v_mul_f32 v152, v144, v152
    v_mfma_f32_16x16x32_bf16 v[172:175], v[212:215], v[100:103], v[172:175]
    ds_read_b64_tr_b16 v[210:211], v241 offset:512
    v_rcp_f32 v145, v145
    v_add_f32 v146, 1.0, v146
    s_waitcnt lgkmcnt(6)
    v_mfma_f32_16x16x32_bf16 v[160:163], v[216:219], v[104:107], v[160:163]
    ds_read_b64_tr_b16 v[212:213], v241 offset:1024
    v_exp_f32 v147, v147
    v_mfma_f32_16x16x32_bf16 v[164:167], v[216:219], v[108:111], v[164:167]
    ds_read_b64_tr_b16 v[214:215], v241 offset:1536
    v_mul_f32 v148, v250, v148
    v_mul_f32 v157, v149, v157
    v_mfma_f32_16x16x32_bf16 v[168:171], v[220:223], v[104:107], v[168:171]
    ds_read_b64_tr_b16 v[216:217], v241 offset:8192
    v_mul_f32 v153, v145, v153
    v_mfma_f32_16x16x32_bf16 v[172:175], v[220:223], v[108:111], v[172:175]
    ds_read_b64_tr_b16 v[218:219], v241 offset:8704
    v_rcp_f32 v146, v146
    v_add_f32 v147, 1.0, v147
    s_waitcnt lgkmcnt(6)
    v_mfma_f32_16x16x32_bf16 v[160:163], v[224:227], v[112:115], v[160:163]
    ds_read_b64_tr_b16 v[220:221], v241 offset:9216
    v_exp_f32 v148, v148
    v_mfma_f32_16x16x32_bf16 v[164:167], v[224:227], v[116:119], v[164:167]
    ds_read_b64_tr_b16 v[222:223], v241 offset:9728
    v_mul_f32 v149, v250, v149
    v_mul_f32 v158, v150, v158
    v_mfma_f32_16x16x32_bf16 v[168:171], v[228:231], v[112:115], v[168:171]
    ds_read_b64_tr_b16 v[224:225], v241 offset:16384
    v_mul_f32 v154, v146, v154
    v_mfma_f32_16x16x32_bf16 v[172:175], v[228:231], v[116:119], v[172:175]
    ds_read_b64_tr_b16 v[226:227], v241 offset:16896
    v_rcp_f32 v147, v147
    v_add_f32 v148, 1.0, v148
    s_waitcnt lgkmcnt(6)
    v_mfma_f32_16x16x32_bf16 v[160:163], v[208:211], v[120:123], v[160:163]
    ds_read_b64_tr_b16 v[228:229], v241 offset:17408
    v_exp_f32 v149, v149
    v_mul_f32 v150, v250, v150
    v_mfma_f32_16x16x32_bf16 v[164:167], v[208:211], v[124:127], v[164:167]
    ds_read_b64_tr_b16 v[230:231], v241 offset:17920
    v_mul_f32 v159, v151, v159
    s_waitcnt vmcnt(0)
    v_readfirstlane_b32 s45, v252
    s_nop 1
    s_cmp_lt_u32 s45, s49
    s_cbranch_scc1 KM_P0A_S
KM_P0A_X:
    v_mfma_f32_16x16x32_bf16 v[168:171], v[212:215], v[120:123], v[168:171]
    ds_read_b64_tr_b16 v[208:209], v242 offset:16384
    v_mul_f32 v155, v147, v155
    v_rcp_f32 v148, v148
    v_mfma_f32_16x16x32_bf16 v[172:175], v[212:215], v[124:127], v[172:175]
    ds_read_b64_tr_b16 v[210:211], v242 offset:16896
    v_add_f32 v149, 1.0, v149
    v_lshlrev_b32 v252, 5, v245
    v_mov_b32 v253, 1
    s_mov_b64 exec, 7
    buffer_atomic_add v253, v252, s[24:27], s39 offen offset:4
    s_mov_b64 exec, -1
    s_mov_b32 exec_hi, 0x7f
    s_add_u32 m0, s55, 36864
    s_add_u32 s45, s54, 0x23ff90
    buffer_load_dwordx4 v245, s[24:27], s45 offen sc1 lds
    s_mov_b32 exec_hi, -1
    s_waitcnt lgkmcnt(6)
    v_mfma_f32_16x16x32_bf16 v[160:163], v[216:219], v[128:131], v[160:163]
    ds_read_b64_tr_b16 v[212:213], v242 offset:17408
    v_exp_f32 v150, v150
    v_mfma_f32_16x16x32_bf16 v[164:167], v[216:219], v[132:135], v[164:167]
    ds_read_b64_tr_b16 v[214:215], v242 offset:17920
    v_mul_f32 v151, v250, v151
    v_mul_f32 v156, v148, v156
    v_mfma_f32_16x16x32_bf16 v[168:171], v[220:223], v[128:131], v[168:171]
    ds_read_b64_tr_b16 v[216:217], v242 offset:24576
    v_rcp_f32 v149, v149
    v_add_f32 v150, 1.0, v150
    v_mfma_f32_16x16x32_bf16 v[172:175], v[220:223], v[132:135], v[172:175]
    ds_read_b64_tr_b16 v[218:219], v242 offset:25088
    v_exp_f32 v151, v151
    s_mov_b32 exec_hi, 0x7f
    s_add_u32 m0, s55, 37488
    s_add_u32 s45, s54, 0x243f90
    buffer_load_dwordx4 v245, s[24:27], s45 offen sc1 lds
    s_mov_b32 exec_hi, -1
    s_waitcnt lgkmcnt(6)
    s_setprio 1
    v_mfma_f32_16x16x32_bf16 v[160:163], v[224:227], v[136:139], v[160:163]
    ds_read_b64_tr_b16 v[220:221], v242 offset:25600
    v_mul_f32 v157, v149, v157
    v_mfma_f32_16x16x32_bf16 v[164:167], v[224:227], v[140:143], v[164:167]
    ds_read_b64_tr_b16 v[222:223], v242 offset:26112
    v_rcp_f32 v150, v150
    v_add_f32 v151, 1.0, v151
    v_mfma_f32_16x16x32_bf16 v[168:171], v[228:231], v[136:139], v[168:171]
    ds_read_b64_tr_b16 v[224:225], v242 offset:32768
    v_mul_f32 v158, v150, v158
    v_rcp_f32 v151, v151
    v_mfma_f32_16x16x32_bf16 v[172:175], v[228:231], v[140:143], v[172:175]
    ds_read_b64_tr_b16 v[226:227], v242 offset:33280
    s_nop 0
    s_mov_b32 exec_hi, 0x7f
    s_add_u32 m0, s55, 38112
    s_add_u32 s45, s54, 0x247f90
    buffer_load_dwordx4 v245, s[24:27], s45 offen sc1 lds
    s_mov_b32 exec_hi, -1
    s_waitcnt lgkmcnt(6)
    v_mfma_f32_16x16x32_bf16 v[176:179], v[208:211], v[72:75], v[176:179]
    ds_read_b64_tr_b16 v[228:229], v242 offset:33792
    v_mul_f32 v159, v151, v159
    v_mfma_f32_16x16x32_bf16 v[180:183], v[208:211], v[76:79], v[180:183]
    ds_read_b64_tr_b16 v[230:231], v242 offset:34304
    v_cvt_pk_bf16_f32 v232, v152, v153
    v_cvt_pk_bf16_f32 v233, v154, v155
    v_mfma_f32_16x16x32_bf16 v[184:187], v[212:215], v[72:75], v[184:187]
    ds_read_b64_tr_b16 v[208:209], v242 offset:40960
    v_cvt_pk_bf16_f32 v236, v156, v157
    v_mfma_f32_16x16x32_bf16 v[188:191], v[212:215], v[76:79], v[188:191]
    ds_read_b64_tr_b16 v[210:211], v242 offset:41472
    v_cvt_pk_bf16_f32 v237, v158, v159
    s_mov_b32 exec_hi, 0x7f
    s_add_u32 m0, s55, 38736
    s_add_u32 s45, s54, 0x24bf90
    buffer_load_dwordx4 v245, s[24:27], s45 offen sc1 lds
    s_mov_b32 exec_hi, -1
    s_waitcnt lgkmcnt(6)
    v_mfma_f32_16x16x32_bf16 v[176:179], v[216:219], v[80:83], v[176:179]
    ds_read_b64_tr_b16 v[212:213], v242 offset:41984
    v_mul_f32 v168, v160, v168
    v_mul_f32 v160, v250, v160
    v_mfma_f32_16x16x32_bf16 v[180:183], v[216:219], v[84:87], v[180:183]
    ds_read_b64_tr_b16 v[214:215], v242 offset:42496
    v_mul_f32 v169, v161, v169
    v_exp_f32 v160, v160
    v_mfma_f32_16x16x32_bf16 v[184:187], v[220:223], v[80:83], v[184:187]
    ds_read_b64_tr_b16 v[216:217], v242 offset:49152
    v_mul_f32 v161, v250, v161
    v_mfma_f32_16x16x32_bf16 v[188:191], v[220:223], v[84:87], v[188:191]
    ds_read_b64_tr_b16 v[218:219], v242 offset:49664
    v_mul_f32 v170, v162, v170
    v_add_f32 v160, 1.0, v160
    s_waitcnt lgkmcnt(6)
    v_mfma_f32_16x16x32_bf16 v[176:179], v[224:227], v[88:91], v[176:179]
    ds_read_b64_tr_b16 v[220:221], v242 offset:50176
    v_exp_f32 v161, v161
    v_mul_f32 v162, v250, v162
    v_mfma_f32_16x16x32_bf16 v[180:183], v[224:227], v[92:95], v[180:183]
    ds_read_b64_tr_b16 v[222:223], v242 offset:50688
    v_mul_f32 v171, v163, v171
    s_mov_b32 exec_hi, 0x7f
    s_add_u32 m0, s55, 39360
    s_add_u32 s45, s54, 0x24ff90
    buffer_load_dwordx4 v245, s[24:27], s45 offen sc1 lds
    s_mov_b32 exec_hi, -1
    v_mfma_f32_16x16x32_bf16 v[184:187], v[228:231], v[88:91], v[184:187]
    ds_read_b64_tr_b16 v[224:225], v242 offset:57344
    v_rcp_f32 v160, v160
    v_mfma_f32_16x16x32_bf16 v[188:191], v[228:231], v[92:95], v[188:191]
    ds_read_b64_tr_b16 v[226:227], v242 offset:57856
    v_add_f32 v161, 1.0, v161
    v_exp_f32 v162, v162
    s_waitcnt lgkmcnt(6)
    v_mfma_f32_16x16x32_bf16 v[176:179], v[208:211], v[96:99], v[176:179]
    ds_read_b64_tr_b16 v[228:229], v242 offset:58368
    v_mul_f32 v163, v250, v163
    v_mul_f32 v172, v164, v172
    v_mfma_f32_16x16x32_bf16 v[180:183], v[208:211], v[100:103], v[180:183]
    ds_read_b64_tr_b16 v[230:231], v242 offset:58880
    v_mul_f32 v168, v160, v168
    s_mov_b32 exec_hi, 0x7f
    s_add_u32 m0, s55, 39984
    s_add_u32 s45, s54, 0x253f90
    buffer_load_dwordx4 v245, s[24:27], s45 offen sc1 lds
    s_mov_b32 exec_hi, -1
    v_mfma_f32_16x16x32_bf16 v[184:187], v[212:215], v[96:99], v[184:187]
    v_add_u32 v242, 0x10000, v242
    ds_read_b64_tr_b16 v[208:209], v242 offset:0
    v_rcp_f32 v161, v161
    v_mfma_f32_16x16x32_bf16 v[188:191], v[212:215], v[100:103], v[188:191]
    ds_read_b64_tr_b16 v[210:211], v242 offset:512
    v_add_f32 v162, 1.0, v162
    v_exp_f32 v163, v163
    s_waitcnt lgkmcnt(6)
    v_mfma_f32_16x16x32_bf16 v[176:179], v[216:219], v[104:107], v[176:179]
    ds_read_b64_tr_b16 v[212:213], v242 offset:1024
    v_mul_f32 v164, v250, v164
    v_mul_f32 v173, v165, v173
    v_mfma_f32_16x16x32_bf16 v[180:183], v[216:219], v[108:111], v[180:183]
    ds_read_b64_tr_b16 v[214:215], v242 offset:1536
    v_mul_f32 v169, v161, v169
    s_mov_b32 exec_hi, 0x7f
    s_add_u32 m0, s55, 40608
    s_add_u32 s45, s54, 0x257f90
    buffer_load_dwordx4 v245, s[24:27], s45 offen sc1 lds
    s_mov_b32 exec_hi, -1
    v_mfma_f32_16x16x32_bf16 v[184:187], v[220:223], v[104:107], v[184:187]
    ds_read_b64_tr_b16 v[216:217], v242 offset:8192
    v_rcp_f32 v162, v162
    v_mfma_f32_16x16x32_bf16 v[188:191], v[220:223], v[108:111], v[188:191]
    ds_read_b64_tr_b16 v[218:219], v242 offset:8704
    v_add_f32 v163, 1.0, v163
    v_exp_f32 v164, v164
    s_waitcnt lgkmcnt(6)
    v_mfma_f32_16x16x32_bf16 v[176:179], v[224:227], v[112:115], v[176:179]
    ds_read_b64_tr_b16 v[220:221], v242 offset:9216
    v_mul_f32 v165, v250, v165
    v_mfma_f32_16x16x32_bf16 v[180:183], v[224:227], v[116:119], v[180:183]
    ds_read_b64_tr_b16 v[222:223], v242 offset:9728
    v_mul_f32 v174, v166, v174
    v_mul_f32 v170, v162, v170
    v_mfma_f32_16x16x32_bf16 v[184:187], v[228:231], v[112:115], v[184:187]
    ds_read_b64_tr_b16 v[224:225], v242 offset:16384
    v_rcp_f32 v163, v163
    v_add_f32 v164, 1.0, v164
    v_mfma_f32_16x16x32_bf16 v[188:191], v[228:231], v[116:119], v[188:191]
    ds_read_b64_tr_b16 v[226:227], v242 offset:16896
    v_exp_f32 v165, v165
    v_mul_f32 v166, v250, v166
    s_mov_b32 exec_hi, 0x7f
    s_add_u32 m0, s55, 41232
    s_add_u32 s45, s54, 0x25bf90
    buffer_load_dwordx4 v245, s[24:27], s45 offen sc1 lds
    s_mov_b32 exec_hi, -1
    s_waitcnt lgkmcnt(6)
    v_mfma_f32_16x16x32_bf16 v[176:179], v[208:211], v[120:123], v[176:179]
    ds_read_b64_tr_b16 v[228:229], v242 offset:17408
    v_mul_f32 v175, v167, v175
    v_mfma_f32_16x16x32_bf16 v[180:183], v[208:211], v[124:127], v[180:183]
    ds_read_b64_tr_b16 v[230:231], v242 offset:17920
    v_mul_f32 v171, v163, v171
    v_rcp_f32 v164, v164
    v_mfma_f32_16x16x32_bf16 v[184:187], v[212:215], v[120:123], v[184:187]
    ds_read_b64_tr_b16 v[208:209], v243 offset:16384
    v_add_f32 v165, 1.0, v165
    v_exp_f32 v166, v166
    v_mfma_f32_16x16x32_bf16 v[188:191], v[212:215], v[124:127], v[188:191]
    ds_read_b64_tr_b16 v[210:211], v243 offset:16896
    v_mul_f32 v167, v250, v167
    s_mov_b32 exec_hi, 0x7f
    s_add_u32 m0, s55, 41856
    s_add_u32 s45, s54, 0x25ff90
    buffer_load_dwordx4 v245, s[24:27], s45 offen sc1 lds
    s_mov_b32 exec_hi, -1
    s_waitcnt lgkmcnt(6)
    v_mfma_f32_16x16x32_bf16 v[176:179], v[216:219], v[128:131], v[176:179]
    ds_read_b64_tr_b16 v[212:213], v243 offset:17408
    v_mul_f32 v172, v164, v172
    v_mfma_f32_16x16x32_bf16 v[180:183], v[216:219], v[132:135], v[180:183]
    ds_read_b64_tr_b16 v[214:215], v243 offset:17920
    v_rcp_f32 v165, v165
    v_add_f32 v166, 1.0, v166
    v_mfma_f32_16x16x32_bf16 v[184:187], v[220:223], v[128:131], v[184:187]
    ds_read_b64_tr_b16 v[216:217], v243 offset:24576
    v_exp_f32 v167, v167
    v_mul_f32 v173, v165, v173
    v_mfma_f32_16x16x32_bf16 v[188:191], v[220:223], v[132:135], v[188:191]
    ds_read_b64_tr_b16 v[218:219], v243 offset:25088
    v_rcp_f32 v166, v166
    s_add_u32 m0, s53, 0
    s_add_u32 s45, s54, 0x0
    buffer_load_dwordx4 v244, s[24:27], s45 offen sc1 lds
    s_waitcnt lgkmcnt(6)
    v_mfma_f32_16x16x32_bf16 v[176:179], v[224:227], v[136:139], v[176:179]
    ds_read_b64_tr_b16 v[220:221], v243 offset:25600
    v_add_f32 v167, 1.0, v167
    v_mfma_f32_16x16x32_bf16 v[180:183], v[224:227], v[140:143], v[180:183]
    ds_read_b64_tr_b16 v[222:223], v243 offset:26112
    v_mul_f32 v174, v166, v174
    v_rcp_f32 v167, v167
    s_setprio 0
    v_mfma_f32_16x16x32_bf16 v[184:187], v[228:231], v[136:139], v[184:187]
    ds_read_b64_tr_b16 v[224:225], v243 offset:32768
    s_nop 0
    v_mul_f32 v175, v167, v175
    v_mfma_f32_16x16x32_bf16 v[188:191], v[228:231], v[140:143], v[188:191]
    ds_read_b64_tr_b16 v[226:227], v243 offset:33280
    v_cvt_pk_bf16_f32 v234, v168, v169
    s_add_u32 m0, s53, 1024
    s_add_u32 s45, s54, 0x8000
    buffer_load_dwordx4 v244, s[24:27], s45 offen sc1 lds
    s_waitcnt lgkmcnt(6)
    v_mfma_f32_16x16x32_bf16 v[192:195], v[208:211], v[72:75], v[192:195]
    ds_read_b64_tr_b16 v[228:229], v243 offset:33792
    v_cvt_pk_bf16_f32 v235, v170, v171
    v_mfma_f32_16x16x32_bf16 v[196:199], v[208:211], v[76:79], v[196:199]
    ds_read_b64_tr_b16 v[230:231], v243 offset:34304
    v_cvt_pk_bf16_f32 v238, v172, v173
    v_cvt_pk_bf16_f32 v239, v174, v175
    v_mfma_f32_16x16x32_bf16 v[200:203], v[212:215], v[72:75], v[200:203]
    ds_read_b64_tr_b16 v[208:209], v243 offset:40960
    buffer_store_dwordx4 v[232:235], v245, s[24:27], s42 offen sc1
    v_mfma_f32_16x16x32_bf16 v[204:207], v[212:215], v[76:79], v[204:207]
    ds_read_b64_tr_b16 v[210:211], v243 offset:41472
    s_add_u32 s48, s42, 148480
    buffer_store_dwordx4 v[236:239], v245, s[24:27], s48 offen sc1
    s_waitcnt lgkmcnt(6)
    v_mfma_f32_16x16x32_bf16 v[192:195], v[216:219], v[80:83], v[192:195]
    ds_read_b64_tr_b16 v[212:213], v243 offset:41984
    v_mul_f32 v184, v176, v184
    v_mul_f32 v176, v250, v176
    v_mfma_f32_16x16x32_bf16 v[196:199], v[216:219], v[84:87], v[196:199]
    ds_read_b64_tr_b16 v[214:215], v243 offset:42496
    v_mul_f32 v185, v177, v185
    v_exp_f32 v176, v176
    s_add_u32 m0, s53, 2048
    s_add_u32 s45, s54, 0x10000
    buffer_load_dwordx4 v244, s[24:27], s45 offen sc1 lds
    v_mfma_f32_16x16x32_bf16 v[200:203], v[220:223], v[80:83], v[200:203]
    ds_read_b64_tr_b16 v[216:217], v243 offset:49152
    v_mul_f32 v177, v250, v177
    v_mfma_f32_16x16x32_bf16 v[204:207], v[220:223], v[84:87], v[204:207]
    ds_read_b64_tr_b16 v[218:219], v243 offset:49664
    v_mul_f32 v186, v178, v186
    v_add_f32 v176, 1.0, v176
    s_waitcnt lgkmcnt(6)
    v_mfma_f32_16x16x32_bf16 v[192:195], v[224:227], v[88:91], v[192:195]
    ds_read_b64_tr_b16 v[220:221], v243 offset:50176
    v_exp_f32 v177, v177
    v_mul_f32 v178, v250, v178
    v_mfma_f32_16x16x32_bf16 v[196:199], v[224:227], v[92:95], v[196:199]
    ds_read_b64_tr_b16 v[222:223], v243 offset:50688
    v_mul_f32 v187, v179, v187
    s_add_u32 m0, s53, 3072
    s_add_u32 s45, s54, 0x18000
    buffer_load_dwordx4 v244, s[24:27], s45 offen sc1 lds
    v_mfma_f32_16x16x32_bf16 v[200:203], v[228:231], v[88:91], v[200:203]
    ds_read_b64_tr_b16 v[224:225], v243 offset:57344
    v_rcp_f32 v176, v176
    v_add_f32 v177, 1.0, v177
    v_mfma_f32_16x16x32_bf16 v[204:207], v[228:231], v[92:95], v[204:207]
    ds_read_b64_tr_b16 v[226:227], v243 offset:57856
    v_exp_f32 v178, v178
    v_mul_f32 v179, v250, v179
    s_waitcnt lgkmcnt(6)
    v_mfma_f32_16x16x32_bf16 v[192:195], v[208:211], v[96:99], v[192:195]
    ds_read_b64_tr_b16 v[228:229], v243 offset:58368
    v_mul_f32 v188, v180, v188
    v_mul_f32 v184, v176, v184
    v_mfma_f32_16x16x32_bf16 v[196:199], v[208:211], v[100:103], v[196:199]
    ds_read_b64_tr_b16 v[230:231], v243 offset:58880
    v_rcp_f32 v177, v177
    s_mov_b32 exec_hi, 0
    s_add_u32 m0, s53, 4096
    s_add_u32 s45, s54, 0x20000
    buffer_load_dwordx4 v244, s[24:27], s45 offen sc1 lds
    s_mov_b32 exec_hi, -1
    v_mfma_f32_16x16x32_bf16 v[200:203], v[212:215], v[96:99], v[200:203]
    v_add_u32 v243, 0x10000, v243
    ds_read_b64_tr_b16 v[208:209], v243 offset:0
    v_add_f32 v178, 1.0, v178
    v_mfma_f32_16x16x32_bf16 v[204:207], v[212:215], v[100:103], v[204:207]
    ds_read_b64_tr_b16 v[210:211], v243 offset:512
    v_exp_f32 v179, v179
    v_mul_f32 v180, v250, v180
    s_waitcnt lgkmcnt(6)
    v_mfma_f32_16x16x32_bf16 v[192:195], v[216:219], v[104:107], v[192:195]
    ds_read_b64_tr_b16 v[212:213], v243 offset:1024
    v_mul_f32 v189, v181, v189
    v_mul_f32 v185, v177, v185
    v_mfma_f32_16x16x32_bf16 v[196:199], v[216:219], v[108:111], v[196:199]
    ds_read_b64_tr_b16 v[214:215], v243 offset:1536
    v_rcp_f32 v178, v178
    v_add_f32 v179, 1.0, v179
    v_mfma_f32_16x16x32_bf16 v[200:203], v[220:223], v[104:107], v[200:203]
    ds_read_b64_tr_b16 v[216:217], v243 offset:8192
    v_exp_f32 v180, v180
    v_mfma_f32_16x16x32_bf16 v[204:207], v[220:223], v[108:111], v[204:207]
    ds_read_b64_tr_b16 v[218:219], v243 offset:8704
    v_mul_f32 v181, v250, v181
    v_mul_f32 v190, v182, v190
    s_waitcnt lgkmcnt(6)
    v_mfma_f32_16x16x32_bf16 v[192:195], v[224:227], v[112:115], v[192:195]
    ds_read_b64_tr_b16 v[220:221], v243 offset:9216
    v_mul_f32 v186, v178, v186
    v_mfma_f32_16x16x32_bf16 v[196:199], v[224:227], v[116:119], v[196:199]
    ds_read_b64_tr_b16 v[222:223], v243 offset:9728
    v_rcp_f32 v179, v179
    v_add_f32 v180, 1.0, v180
    v_mfma_f32_16x16x32_bf16 v[200:203], v[228:231], v[112:115], v[200:203]
    ds_read_b64_tr_b16 v[224:225], v243 offset:16384
    v_exp_f32 v181, v181
    v_mul_f32 v182, v250, v182
    v_mfma_f32_16x16x32_bf16 v[204:207], v[228:231], v[116:119], v[204:207]
    ds_read_b64_tr_b16 v[226:227], v243 offset:16896
    v_mul_f32 v191, v183, v191
    v_mul_f32 v187, v179, v187
    s_waitcnt lgkmcnt(6)
    v_mfma_f32_16x16x32_bf16 v[192:195], v[208:211], v[120:123], v[192:195]
    ds_read_b64_tr_b16 v[228:229], v243 offset:17408
    v_rcp_f32 v180, v180
    v_mfma_f32_16x16x32_bf16 v[196:199], v[208:211], v[124:127], v[196:199]
    ds_read_b64_tr_b16 v[230:231], v243 offset:17920
    v_add_f32 v181, 1.0, v181
    v_exp_f32 v182, v182
    v_mfma_f32_16x16x32_bf16 v[200:203], v[212:215], v[120:123], v[200:203]
    v_mul_f32 v183, v250, v183
    v_mfma_f32_16x16x32_bf16 v[204:207], v[212:215], v[124:127], v[204:207]
    v_mul_f32 v188, v180, v188
    v_rcp_f32 v181, v181
    s_waitcnt lgkmcnt(4)
    v_mfma_f32_16x16x32_bf16 v[192:195], v[216:219], v[128:131], v[192:195]
    v_add_f32 v182, 1.0, v182
    v_exp_f32 v183, v183
    v_mfma_f32_16x16x32_bf16 v[196:199], v[216:219], v[132:135], v[196:199]
    v_mul_f32 v189, v181, v189
    v_rcp_f32 v182, v182
    v_mfma_f32_16x16x32_bf16 v[200:203], v[220:223], v[128:131], v[200:203]
    v_add_f32 v183, 1.0, v183
    v_mfma_f32_16x16x32_bf16 v[204:207], v[220:223], v[132:135], v[204:207]
    v_mul_f32 v190, v182, v190
    v_rcp_f32 v183, v183
    s_waitcnt lgkmcnt(0)
    v_mfma_f32_16x16x32_bf16 v[192:195], v[224:227], v[136:139], v[192:195]
    s_nop 0
    v_mfma_f32_16x16x32_bf16 v[196:199], v[224:227], v[140:143], v[196:199]
    v_mul_f32 v191, v183, v191
    v_cvt_pk_bf16_f32 v232, v184, v185
    v_mfma_f32_16x16x32_bf16 v[200:203], v[228:231], v[136:139], v[200:203]
    v_cvt_pk_bf16_f32 v233, v186, v187
    v_mfma_f32_16x16x32_bf16 v[204:207], v[228:231], v[140:143], v[204:207]
    v_cvt_pk_bf16_f32 v236, v188, v189
    v_cvt_pk_bf16_f32 v237, v190, v191
    v_add_u32 v141, 0x26000, v245
    ds_read_b128 v[164:167], v141 offset:5120
    ds_read_b128 v[168:171], v141 offset:6144
    ds_read_b128 v[172:175], v141 offset:7168
    ds_read_b128 v[144:147], v141 offset:0
    ds_read_b128 v[148:151], v141 offset:1024
    ds_read_b128 v[152:155], v141 offset:2048
    ds_read_b128 v[156:159], v141 offset:3072
    ds_read_b128 v[160:163], v141 offset:4096
    v_mov_b32 v136, 0x3f803f80
    v_mov_b32 v137, 0x3f803f80
    v_mov_b32 v138, 0x3f803f80
    v_mov_b32 v139, 0x3f803f80
    v_mov_b32 v140, 0x3eae1a93
    s_waitcnt lgkmcnt(6)
    v_add_u32 v164, s55, v164
    v_add_u32 v165, s55, v165
    v_add_u32 v166, s55, v166
    v_add_u32 v167, s55, v167
    v_add_u32 v168, s55, v168
    v_add_u32 v169, s53, v169
    s_waitcnt vmcnt(0)
    ds_read_b128 v[0:3], v169 offset:0
    ds_read_b128 v[12:15], v169 offset:256
    ds_read_b128 v[4:7], v169 offset:512
    ds_read_b128 v[16:19], v169 offset:768
    ds_read_b128 v[8:11], v169 offset:1024
    ds_read_b128 v[20:23], v169 offset:1280
    ds_read_b64 v[56:57], v165 offset:0
    ds_read_b64 v[58:59], v165 offset:624
    ds_read_b64 v[60:61], v165 offset:1248
    s_waitcnt lgkmcnt(13)
    ds_read_b64 v[62:63], v164 offset:0
    ds_read_b64 v[64:65], v164 offset:624
    s_waitcnt lgkmcnt(13)
    ds_read_b64 v[66:67], v164 offset:1248
    ds_read_b64 v[68:69], v164 offset:256
    s_waitcnt lgkmcnt(13)
    ds_read_b64 v[70:71], v164 offset:880
    ds_read_b64 v[72:73], v164 offset:1504
    s_waitcnt lgkmcnt(13)
    ds_read_b64 v[74:75], v165 offset:8
    ds_read_b64 v[76:77], v165 offset:632
    s_waitcnt lgkmcnt(13)
    ds_read_b64 v[78:79], v165 offset:1256
    ds_read_b64 v[80:81], v164 offset:8
    s_waitcnt lgkmcnt(13)
    ds_read_b64 v[82:83], v164 offset:632
    ds_read_b64 v[84:85], v164 offset:1256
    s_waitcnt lgkmcnt(13)
    ds_read_b64 v[86:87], v164 offset:264
    ds_read_b64 v[88:89], v164 offset:888
    s_waitcnt lgkmcnt(13)
    ds_read_b64 v[90:91], v164 offset:1512
    s_waitcnt lgkmcnt(0)
    s_barrier
    s_setprio 3
    s_add_u32 s46, s54, 0x47ff90
    s_add_u32 m0, s55, 118656
    s_nop 0
    buffer_load_dwordx4 v170, s[24:27], s46 offen sc1 lds
    s_add_u32 m0, s55, 119680
    s_nop 0
    buffer_load_dwordx4 v171, s[24:27], s46 offen sc1 lds
    s_add_u32 m0, s55, 120704
    s_nop 0
    buffer_load_dwordx4 v172, s[24:27], s46 offen sc1 lds
    s_add_u32 m0, s55, 121728
    s_nop 0
    buffer_load_dwordx4 v173, s[24:27], s46 offen sc1 lds
    s_add_u32 m0, s55, 122752
    s_nop 0
    buffer_load_dwordx4 v174, s[24:27], s46 offen sc1 lds
    s_mov_b64 exec, 0x7fffffff
    s_add_u32 m0, s55, 123776
    s_nop 0
    buffer_load_dwordx4 v175, s[24:27], s46 offen sc1 lds
    s_mov_b64 exec, -1
    s_mul_i32 s33, s15, 288
    s_lshl_b32 s44, s12, 3
    s_add_u32 s33, s33, s44
    s_mul_i32 s33, s33, 1152
    s_mov_b32 s40, 0
    s_mov_b32 s47, s10
    s_and_b32 s38, s40, 3
    s_mul_i32 s38, s38, 36864
    s_add_u32 s38, s38, s52
    s_lshl_b32 s44, s40, 7
    s_add_u32 s44, s44, s33
    s_cmp_lt_u32 s40, 9
    s_cselect_b32 s10, s47, 0
    s_add_u32 s40, s40, 1
    s_cmp_ge_u32 s12, 4
    s_cbranch_scc1 KM_LD1
    s_add_u32 m0, s38, 32768
    s_add_u32 s37, s44, 294912
    buffer_load_dwordx4 v246, s[8:11], s37 offen lds
KM_LD1:
    s_add_u32 m0, s38, 0
    s_add_u32 s37, s44, 0
    buffer_load_dwordx4 v246, s[8:11], s37 offen lds
    v_mul_f32 v200, v192, v200
    v_mul_f32 v192, v250, v192
    v_mul_f32 v201, v193, v201
    v_exp_f32 v192, v192
    v_mul_f32 v193, v250, v193
    v_mul_f32 v202, v194, v202
    v_add_f32 v192, 1.0, v192
    v_exp_f32 v193, v193
    s_add_u32 m0, s38, 8192
    s_add_u32 s37, s44, 73728
    buffer_load_dwordx4 v246, s[8:11], s37 offen lds
    v_mul_f32 v194, v250, v194
    v_mul_f32 v203, v195, v203
    v_rcp_f32 v192, v192
    v_add_f32 v193, 1.0, v193
    v_exp_f32 v194, v194
    v_mul_f32 v195, v250, v195
    v_mul_f32 v204, v196, v204
    v_mul_f32 v200, v192, v200
    s_add_u32 m0, s38, 16384
    s_add_u32 s37, s44, 147456
    buffer_load_dwordx4 v246, s[8:11], s37 offen lds
    v_rcp_f32 v193, v193
    v_add_f32 v194, 1.0, v194
    v_exp_f32 v195, v195
    v_mul_f32 v196, v250, v196
    v_mul_f32 v205, v197, v205
    v_mul_f32 v201, v193, v201
    v_rcp_f32 v194, v194
    v_add_f32 v195, 1.0, v195
    s_add_u32 m0, s38, 24576
    s_add_u32 s37, s44, 221184
    buffer_load_dwordx4 v246, s[8:11], s37 offen lds
    v_exp_f32 v196, v196
    v_mul_f32 v197, v250, v197
    v_mul_f32 v206, v198, v206
    v_mul_f32 v202, v194, v202
    v_rcp_f32 v195, v195
    v_add_f32 v196, 1.0, v196
    v_exp_f32 v197, v197
    v_mul_f32 v198, v250, v198
    s_and_b32 s38, s40, 3
    s_mul_i32 s38, s38, 36864
    s_add_u32 s38, s38, s52
    s_lshl_b32 s44, s40, 7
    s_add_u32 s44, s44, s33
    s_cmp_lt_u32 s40, 9
    s_cselect_b32 s10, s47, 0
    s_add_u32 s40, s40, 1
    s_cmp_ge_u32 s12, 4
    s_cbranch_scc1 KM_LD2
    s_add_u32 m0, s38, 32768
    s_add_u32 s37, s44, 294912
    buffer_load_dwordx4 v246, s[8:11], s37 offen lds
KM_LD2:
    s_add_u32 m0, s38, 0
    s_add_u32 s37, s44, 0
    buffer_load_dwordx4 v246, s[8:11], s37 offen lds
    v_mul_f32 v207, v199, v207
    v_mul_f32 v203, v195, v203
    v_rcp_f32 v196, v196
    v_add_f32 v197, 1.0, v197
    v_exp_f32 v198, v198
    v_mul_f32 v199, v250, v199
    v_mul_f32 v204, v196, v204
    v_rcp_f32 v197, v197
    s_add_u32 m0, s38, 8192
    s_add_u32 s37, s44, 73728
    buffer_load_dwordx4 v246, s[8:11], s37 offen lds
    v_add_f32 v198, 1.0, v198
    v_exp_f32 v199, v199
    v_mul_f32 v205, v197, v205
    v_rcp_f32 v198, v198
    v_add_f32 v199, 1.0, v199
    v_mul_f32 v206, v198, v206
    v_rcp_f32 v199, v199
    s_nop 0
    v_mul_f32 v207, v199, v207
    v_cvt_pk_bf16_f32 v234, v200, v201
    v_cvt_pk_bf16_f32 v235, v202, v203
    v_cvt_pk_bf16_f32 v238, v204, v205
    v_cvt_pk_bf16_f32 v239, v206, v207
    buffer_store_dwordx4 v[232:235], v245, s[24:27], s43 offen sc1
    s_add_u32 s48, s43, 148480
    buffer_store_dwordx4 v[236:239], v245, s[24:27], s48 offen sc1
    s_setprio 2
    v_and_b32 v24, v0, v157
    v_and_b32 v25, v1, v156
    v_and_b32 v26, v4, v156
    v_and_b32 v27, v5, v156
    v_and_b32 v28, v4, v158
    v_and_b32 v29, v5, v158
    v_and_b32 v30, v8, v158
    v_and_b32 v31, v9, v159
    v_and_b32 v32, v12, v157
    v_and_b32 v33, v13, v156
    v_and_b32 v34, v16, v156
    v_and_b32 v35, v17, v156
    v_and_b32 v36, v16, v158
    v_and_b32 v37, v17, v158
    v_and_b32 v38, v20, v158
    v_and_b32 v39, v21, v159
    v_and_b32 v40, v2, v157
    v_and_b32 v41, v3, v156
    v_and_b32 v42, v6, v156
    v_and_b32 v43, v7, v156
    v_and_b32 v44, v6, v158
    v_and_b32 v45, v7, v158
    v_and_b32 v46, v10, v158
    v_and_b32 v47, v11, v159
    v_and_b32 v48, v14, v157
    v_and_b32 v49, v15, v156
    v_and_b32 v50, v18, v156
    v_and_b32 v51, v19, v156
    v_and_b32 v52, v18, v158
    v_and_b32 v53, v19, v158
    v_and_b32 v54, v22, v158
    v_and_b32 v55, v23, v159
    v_mfma_f32_16x16x32_bf16 v[176:179], v[56:59], v[24:27], v[152:155]
    v_mfma_f32_16x16x32_bf16 v[180:183], v[62:65], v[24:27], v[148:151]
    s_add_u32 m0, s38, 16384
    s_add_u32 s37, s44, 147456
    buffer_load_dwordx4 v246, s[8:11], s37 offen lds
    v_mfma_f32_16x16x32_bf16 v[184:187], v[58:61], v[28:31], v[152:155]
    v_mfma_f32_16x16x32_bf16 v[188:191], v[64:67], v[28:31], v[148:151]
    v_mfma_f32_16x16x32_bf16 v[192:195], v[62:65], v[32:35], v[144:147]
    v_mfma_f32_16x16x32_bf16 v[196:199], v[68:71], v[32:35], v[148:151]
    s_add_u32 m0, s38, 24576
    s_add_u32 s37, s44, 221184
    buffer_load_dwordx4 v246, s[8:11], s37 offen lds
    v_mfma_f32_16x16x32_bf16 v[200:203], v[64:67], v[36:39], v[144:147]
    v_mfma_f32_16x16x32_bf16 v[204:207], v[70:73], v[36:39], v[148:151]
    v_mfma_f32_16x16x32_bf16 v[208:211], v[74:77], v[40:43], v[152:155]
    v_mfma_f32_16x16x32_bf16 v[212:215], v[80:83], v[40:43], v[148:151]
    s_and_b32 s38, s40, 3
    s_mul_i32 s38, s38, 36864
    s_add_u32 s38, s38, s52
    s_lshl_b32 s44, s40, 7
    s_add_u32 s44, s44, s33
    s_cmp_lt_u32 s40, 9
    s_cselect_b32 s10, s47, 0
    s_add_u32 s40, s40, 1
    s_cmp_ge_u32 s12, 4
    s_cbranch_scc1 KM_LD3
    s_add_u32 m0, s38, 32768
    s_add_u32 s37, s44, 294912
    buffer_load_dwordx4 v246, s[8:11], s37 offen lds
KM_LD3:
    s_add_u32 m0, s38, 0
    s_add_u32 s37, s44, 0
    buffer_load_dwordx4 v246, s[8:11], s37 offen lds
    v_mfma_f32_16x16x32_bf16 v[216:219], v[76:79], v[44:47], v[152:155]
    v_mfma_f32_16x16x32_bf16 v[220:223], v[82:85], v[44:47], v[148:151]
    v_mfma_f32_16x16x32_bf16 v[224:227], v[80:83], v[48:51], v[144:147]
    v_mfma_f32_16x16x32_bf16 v[228:231], v[86:89], v[48:51], v[148:151]
    s_add_u32 m0, s38, 8192
    s_add_u32 s37, s44, 73728
    buffer_load_dwordx4 v246, s[8:11], s37 offen lds
    v_mfma_f32_16x16x32_bf16 v[232:235], v[82:85], v[52:55], v[144:147]
    v_mfma_f32_16x16x32_bf16 v[236:239], v[88:91], v[52:55], v[148:151]
    v_max_f32 v176, v176, v180
    v_max_f32 v177, v177, v181
    v_max_f32 v178, v178, v182
    v_max_f32 v179, v179, v183
    v_max_f32 v184, v184, v188
    v_max_f32 v185, v185, v189
    v_max_f32 v186, v186, v190
    v_max_f32 v187, v187, v191
    s_add_u32 m0, s38, 16384
    s_add_u32 s37, s44, 147456
    buffer_load_dwordx4 v246, s[8:11], s37 offen lds
    v_max_f32 v192, v192, v196
    v_max_f32 v193, v193, v197
    v_max_f32 v194, v194, v198
    v_max_f32 v195, v195, v199
    v_max_f32 v200, v200, v204
    v_max_f32 v201, v201, v205
    v_max_f32 v202, v202, v206
    v_max_f32 v203, v203, v207
    s_add_u32 m0, s38, 24576
    s_add_u32 s37, s44, 221184
    buffer_load_dwordx4 v246, s[8:11], s37 offen lds
    v_max_f32 v208, v208, v212
    v_max_f32 v209, v209, v213
    v_max_f32 v210, v210, v214
    v_max_f32 v211, v211, v215
    v_max_f32 v216, v216, v220
    v_max_f32 v217, v217, v221
    v_max_f32 v218, v218, v222
    v_max_f32 v219, v219, v223
    v_max_f32 v224, v224, v228
    v_max_f32 v225, v225, v229
    v_max_f32 v226, v226, v230
    v_max_f32 v227, v227, v231
    v_max_f32 v232, v232, v236
    v_max_f32 v233, v233, v237
    v_max_f32 v234, v234, v238
    v_max_f32 v235, v235, v239
    v_max3_f32 v128, v176, v177, v178
    v_max3_f32 v129, v184, v185, v186
    v_max3_f32 v130, v192, v193, v194
    v_max3_f32 v131, v200, v201, v202
    v_max3_f32 v132, v208, v209, v210
    v_max3_f32 v133, v216, v217, v218
    v_max3_f32 v134, v224, v225, v226
    v_max3_f32 v135, v232, v233, v234
    v_max_f32 v128, v128, v179
    v_max_f32 v129, v129, v187
    v_max_f32 v130, v130, v195
    v_max_f32 v131, v131, v203
    v_max_f32 v132, v132, v211
    v_max_f32 v133, v133, v219
    v_max_f32 v134, v134, v227
    v_max_f32 v135, v135, v235
    v_permlane16_swap_b32 v128, v129
    v_permlane16_swap_b32 v130, v131
    v_permlane16_swap_b32 v132, v133
    v_permlane16_swap_b32 v134, v135
    v_max_f32 v128, v128, v129
    v_max_f32 v130, v130, v131
    v_max_f32 v132, v132, v133
    v_max_f32 v134, v134, v135
    v_mov_b32 v129, v128
    v_mov_b32 v131, v130
    v_mov_b32 v133, v132
    v_mov_b32 v135, v134
    v_permlane32_swap_b32 v128, v129
    v_permlane32_swap_b32 v130, v131
    v_permlane32_swap_b32 v132, v133
    v_permlane32_swap_b32 v134, v135
    v_max_f32 v128, v128, v129
    v_max_f32 v130, v130, v131
    v_max_f32 v132, v132, v133
    v_max_f32 v134, v134, v135
    v_mul_f32 v128, v140, v128
    v_mul_f32 v130, v140, v130
    v_mul_f32 v132, v140, v132
    v_mul_f32 v134, v140, v134
    v_mov_b32 v129, v128
    v_mov_b32 v131, v130
    v_mov_b32 v133, v132
    v_mov_b32 v135, v134
    v_permlane16_swap_b32 v128, v129
    v_permlane16_swap_b32 v130, v131
    v_permlane16_swap_b32 v132, v133
    v_permlane16_swap_b32 v134, v135
    s_waitcnt vmcnt(14)
    v_lshlrev_b32 v252, 5, v245
    v_mov_b32 v253, 1
    s_waitcnt vmcnt(6)
    s_mov_b64 exec, 7
    buffer_atomic_add v253, v252, s[24:27], s39 offen offset:8
    s_mov_b64 exec, -1
    s_setprio 1
    v_fma_f32 v176, v176, v140, -v128
    v_fma_f32 v177, v177, v140, -v128
    v_fma_f32 v178, v178, v140, -v128
    v_fma_f32 v179, v179, v140, -v128
    v_exp_f32 v176, v176
    ds_read_b64_tr_b16 v[92:93], v167 offset:0
    v_exp_f32 v177, v177
    ds_read_b64_tr_b16 v[94:95], v166 offset:0
    v_exp_f32 v178, v178
    ds_read_b64_tr_b16 v[96:97], v166 offset:256
    v_exp_f32 v179, v179
    ds_read_b64_tr_b16 v[98:99], v167 offset:2496
    ds_read_b64_tr_b16 v[100:101], v166 offset:2496
    v_fma_f32 v184, v184, v140, -v129
    v_fma_f32 v185, v185, v140, -v129
    v_fma_f32 v186, v186, v140, -v129
    v_fma_f32 v187, v187, v140, -v129
    v_exp_f32 v184, v184
    ds_read_b64_tr_b16 v[102:103], v166 offset:2752
    v_exp_f32 v185, v185
    ds_read_b64_tr_b16 v[104:105], v167 offset:3120
    v_exp_f32 v186, v186
    ds_read_b64_tr_b16 v[106:107], v166 offset:3120
    v_exp_f32 v187, v187
    ds_read_b64_tr_b16 v[108:109], v166 offset:3376
    ds_read_b64_tr_b16 v[110:111], v167 offset:8
    v_cvt_pk_bf16_f32 v180, v176, v177
    v_cvt_pk_bf16_f32 v181, v178, v179
    v_and_b32 v24, v180, v160
    v_and_b32 v25, v181, v161
    v_and_b32 v26, v180, v162
    v_and_b32 v27, v181, v163
    v_fma_f32 v192, v192, v140, -v130
    v_fma_f32 v193, v193, v140, -v130
    v_fma_f32 v194, v194, v140, -v130
    v_fma_f32 v195, v195, v140, -v130
    v_exp_f32 v192, v192
    ds_read_b64_tr_b16 v[112:113], v166 offset:8
    v_exp_f32 v193, v193
    ds_read_b64_tr_b16 v[114:115], v166 offset:264
    v_exp_f32 v194, v194
    ds_read_b64_tr_b16 v[116:117], v167 offset:2504
    v_exp_f32 v195, v195
    ds_read_b64_tr_b16 v[118:119], v166 offset:2504
    ds_read_b64_tr_b16 v[120:121], v166 offset:2760
    s_waitcnt lgkmcnt(6)
    v_mfma_f32_16x16x32_bf16 v[56:59], v[136:139], v[24:27], 0
    v_mfma_f32_16x16x32_bf16 v[176:179], v[92:95], v[24:27], 0
    v_mfma_f32_16x16x32_bf16 v[180:183], v[98:101], v[24:27], 0
    v_cvt_pk_bf16_f32 v188, v184, v185
    v_cvt_pk_bf16_f32 v189, v186, v187
    v_and_b32 v28, v188, v160
    v_and_b32 v29, v189, v161
    v_and_b32 v30, v188, v162
    v_and_b32 v31, v189, v163
    v_fma_f32 v200, v200, v140, -v131
    v_fma_f32 v201, v201, v140, -v131
    v_fma_f32 v202, v202, v140, -v131
    v_fma_f32 v203, v203, v140, -v131
    v_exp_f32 v200, v200
    ds_read_b64_tr_b16 v[122:123], v167 offset:3128
    v_exp_f32 v201, v201
    ds_read_b64_tr_b16 v[124:125], v166 offset:3128
    v_exp_f32 v202, v202
    ds_read_b64_tr_b16 v[126:127], v166 offset:3384
    v_exp_f32 v203, v203
    v_mfma_f32_16x16x32_bf16 v[60:63], v[136:139], v[28:31], 0
    v_mfma_f32_16x16x32_bf16 v[184:187], v[104:107], v[28:31], 0
    v_mfma_f32_16x16x32_bf16 v[188:191], v[98:101], v[28:31], 0
    v_cvt_pk_bf16_f32 v196, v192, v193
    v_cvt_pk_bf16_f32 v197, v194, v195
    v_and_b32 v32, v196, v160
    v_and_b32 v33, v197, v161
    v_and_b32 v34, v196, v162
    v_and_b32 v35, v197, v163
    v_fma_f32 v208, v208, v140, -v132
    v_fma_f32 v209, v209, v140, -v132
    v_fma_f32 v210, v210, v140, -v132
    v_fma_f32 v211, v211, v140, -v132
    v_exp_f32 v208, v208
    v_exp_f32 v209, v209
    v_exp_f32 v210, v210
    v_exp_f32 v211, v211
    v_mfma_f32_16x16x32_bf16 v[64:67], v[136:139], v[32:35], 0
    v_mfma_f32_16x16x32_bf16 v[192:195], v[94:97], v[32:35], 0
    v_mfma_f32_16x16x32_bf16 v[196:199], v[100:103], v[32:35], 0
    v_cvt_pk_bf16_f32 v204, v200, v201
    v_cvt_pk_bf16_f32 v205, v202, v203
    v_and_b32 v36, v204, v160
    v_and_b32 v37, v205, v161
    v_and_b32 v38, v204, v162
    v_and_b32 v39, v205, v163
    v_rcp_f32 v56, v56
    s_nop 0
    v_mul_f32 v176, v176, v56
    v_mul_f32 v177, v177, v56
    v_mul_f32 v178, v178, v56
    v_mul_f32 v179, v179, v56
    v_mul_f32 v180, v180, v56
    v_mul_f32 v181, v181, v56
    v_cvt_pk_bf16_f32 v176, v176, v177
    v_cvt_pk_bf16_f32 v177, v178, v179
    v_cvt_pk_bf16_f32 v0, v180, v181
    ds_write_b64 v168, v[176:177] offset:0
    v_fma_f32 v216, v216, v140, -v133
    v_fma_f32 v217, v217, v140, -v133
    v_fma_f32 v218, v218, v140, -v133
    v_fma_f32 v219, v219, v140, -v133
    v_exp_f32 v216, v216
    v_exp_f32 v217, v217
    v_exp_f32 v218, v218
    v_exp_f32 v219, v219
    v_mfma_f32_16x16x32_bf16 v[68:71], v[136:139], v[36:39], 0
    v_mfma_f32_16x16x32_bf16 v[200:203], v[106:109], v[36:39], 0
    v_mfma_f32_16x16x32_bf16 v[204:207], v[100:103], v[36:39], 0
    v_cvt_pk_bf16_f32 v212, v208, v209
    v_cvt_pk_bf16_f32 v213, v210, v211
    v_and_b32 v40, v212, v160
    v_and_b32 v41, v213, v161
    v_and_b32 v42, v212, v162
    v_and_b32 v43, v213, v163
    v_rcp_f32 v60, v60
    s_nop 0
    v_mul_f32 v184, v184, v60
    v_mul_f32 v185, v185, v60
    v_mul_f32 v186, v186, v60
    v_mul_f32 v187, v187, v60
    v_mul_f32 v190, v190, v60
    v_mul_f32 v191, v191, v60
    v_cvt_pk_bf16_f32 v184, v184, v185
    v_cvt_pk_bf16_f32 v185, v186, v187
    v_cvt_pk_bf16_f32 v1, v190, v191
    ds_write_b64 v168, v[184:185] offset:3120
    s_setprio 0
    v_fma_f32 v224, v224, v140, -v134
    v_fma_f32 v225, v225, v140, -v134
    v_fma_f32 v226, v226, v140, -v134
    v_fma_f32 v227, v227, v140, -v134
    v_exp_f32 v224, v224
    v_exp_f32 v225, v225
    v_exp_f32 v226, v226
    v_exp_f32 v227, v227
    s_waitcnt lgkmcnt(2)
    v_mfma_f32_16x16x32_bf16 v[72:75], v[136:139], v[40:43], 0
    v_mfma_f32_16x16x32_bf16 v[208:211], v[110:113], v[40:43], 0
    v_mfma_f32_16x16x32_bf16 v[212:215], v[116:119], v[40:43], 0
    v_cvt_pk_bf16_f32 v220, v216, v217
    v_cvt_pk_bf16_f32 v221, v218, v219
    v_and_b32 v44, v220, v160
    v_and_b32 v45, v221, v161
    v_and_b32 v46, v220, v162
    v_and_b32 v47, v221, v163
    v_rcp_f32 v64, v64
    s_nop 0
    v_mul_f32 v192, v192, v64
    v_mul_f32 v193, v193, v64
    v_mul_f32 v194, v194, v64
    v_mul_f32 v195, v195, v64
    v_mul_f32 v196, v196, v64
    v_mul_f32 v197, v197, v64
    v_cvt_pk_bf16_f32 v192, v192, v193
    v_cvt_pk_bf16_f32 v193, v194, v195
    v_cvt_pk_bf16_f32 v2, v196, v197
    ds_write_b64 v168, v[192:193] offset:256
    v_fma_f32 v232, v232, v140, -v135
    v_fma_f32 v233, v233, v140, -v135
    v_fma_f32 v234, v234, v140, -v135
    v_fma_f32 v235, v235, v140, -v135
    v_exp_f32 v232, v232
    v_exp_f32 v233, v233
    v_exp_f32 v234, v234
    v_exp_f32 v235, v235
    v_mfma_f32_16x16x32_bf16 v[76:79], v[136:139], v[44:47], 0
    v_mfma_f32_16x16x32_bf16 v[216:219], v[122:125], v[44:47], 0
    v_mfma_f32_16x16x32_bf16 v[220:223], v[116:119], v[44:47], 0
    v_cvt_pk_bf16_f32 v228, v224, v225
    v_cvt_pk_bf16_f32 v229, v226, v227
    v_and_b32 v48, v228, v160
    v_and_b32 v49, v229, v161
    v_and_b32 v50, v228, v162
    v_and_b32 v51, v229, v163
    v_rcp_f32 v68, v68
    s_nop 0
    v_mul_f32 v200, v200, v68
    v_mul_f32 v201, v201, v68
    v_mul_f32 v202, v202, v68
    v_mul_f32 v203, v203, v68
    v_mul_f32 v206, v206, v68
    v_mul_f32 v207, v207, v68
    v_cvt_pk_bf16_f32 v200, v200, v201
    v_cvt_pk_bf16_f32 v201, v202, v203
    v_cvt_pk_bf16_f32 v3, v206, v207
    ds_write_b64 v168, v[200:201] offset:3376
    v_mfma_f32_16x16x32_bf16 v[80:83], v[136:139], v[48:51], 0
    v_mfma_f32_16x16x32_bf16 v[224:227], v[112:115], v[48:51], 0
    v_mfma_f32_16x16x32_bf16 v[228:231], v[118:121], v[48:51], 0
    v_cvt_pk_bf16_f32 v236, v232, v233
    v_cvt_pk_bf16_f32 v237, v234, v235
    v_and_b32 v52, v236, v160
    v_and_b32 v53, v237, v161
    v_and_b32 v54, v236, v162
    v_and_b32 v55, v237, v163
    v_rcp_f32 v72, v72
    s_nop 0
    v_mul_f32 v208, v208, v72
    v_mul_f32 v209, v209, v72
    v_mul_f32 v210, v210, v72
    v_mul_f32 v211, v211, v72
    v_mul_f32 v212, v212, v72
    v_mul_f32 v213, v213, v72
    v_cvt_pk_bf16_f32 v208, v208, v209
    v_cvt_pk_bf16_f32 v209, v210, v211
    v_cvt_pk_bf16_f32 v4, v212, v213
    ds_write_b64 v168, v[208:209] offset:8
    v_mfma_f32_16x16x32_bf16 v[84:87], v[136:139], v[52:55], 0
    v_mfma_f32_16x16x32_bf16 v[232:235], v[124:127], v[52:55], 0
    v_mfma_f32_16x16x32_bf16 v[236:239], v[118:121], v[52:55], 0
    s_nop 7
    v_rcp_f32 v76, v76
    s_nop 0
    v_mul_f32 v216, v216, v76
    v_mul_f32 v217, v217, v76
    v_mul_f32 v218, v218, v76
    v_mul_f32 v219, v219, v76
    v_mul_f32 v222, v222, v76
    v_mul_f32 v223, v223, v76
    v_cvt_pk_bf16_f32 v216, v216, v217
    v_cvt_pk_bf16_f32 v217, v218, v219
    v_cvt_pk_bf16_f32 v5, v222, v223
    ds_write_b64 v168, v[216:217] offset:3128
    s_nop 7
    v_rcp_f32 v80, v80
    s_nop 0
    v_mul_f32 v224, v224, v80
    v_mul_f32 v225, v225, v80
    v_mul_f32 v226, v226, v80
    v_mul_f32 v227, v227, v80
    v_mul_f32 v228, v228, v80
    v_mul_f32 v229, v229, v80
    v_cvt_pk_bf16_f32 v224, v224, v225
    v_cvt_pk_bf16_f32 v225, v226, v227
    v_cvt_pk_bf16_f32 v6, v228, v229
    ds_write_b64 v168, v[224:225] offset:264
    s_nop 7
    v_rcp_f32 v84, v84
    s_nop 0
    v_mul_f32 v232, v232, v84
    v_mul_f32 v233, v233, v84
    v_mul_f32 v234, v234, v84
    v_mul_f32 v235, v235, v84
    v_mul_f32 v238, v238, v84
    v_mul_f32 v239, v239, v84
    v_cvt_pk_bf16_f32 v232, v232, v233
    v_cvt_pk_bf16_f32 v233, v234, v235
    v_cvt_pk_bf16_f32 v7, v238, v239
    ds_write_b64 v168, v[232:233] offset:3384
    s_mov_b64 exec, 0xffff
    ds_write_b64 v168, v[0:1] offset:2496
    ds_write_b64 v168, v[2:3] offset:2752
    ds_write_b64 v168, v[4:5] offset:2504
    ds_write_b64 v168, v[6:7] offset:2760
    s_mov_b64 exec, -1
    s_waitcnt vmcnt(0) lgkmcnt(0)
    s_barrier
    s_and_b32 s34, s12, 1
    s_bfe_u32 s35, s12, 0x10001
    s_lshr_b32 s46, s12, 2
    s_lshl_b32 s37, s35, 6
    v_xor_b32 v176, s37, v248
    s_mul_i32 s37, s46, 36864
    v_add_u32 v176, s37, v176
    v_xor_b32 v177, 32, v176
    v_and_b32 v178, 15, v249
    v_lshlrev_b32 v178, 3, v178
    v_lshrrev_b32 v250, 4, v249
    v_mul_u32_u24 v250, 624, v250
    v_add_u32 v178, v250, v178
    s_lshl_b32 s37, s34, 8
    s_add_u32 s37, s37, 118656
    v_add_u32 v178, s37, v178
    s_lshl_b32 s36, s32, 2
    s_lshl_b32 s37, s34, 1
    s_add_u32 s36, s36, s37
    s_mul_i32 s36, s36, 18
    s_add_u32 s36, s36, s35
    s_lshl_b32 s37, s46, 1
    s_add_u32 s36, s36, s37
    s_lshl_b32 s36, s36, 10
    s_mul_i32 s37, s15, 2359296
    s_add_u32 s36, s36, s37
    s_add_u32 s36, s36, 0x2300000
    ds_read_b64 v[32:33], v178 offset:0
    ds_read_b64 v[34:35], v178 offset:2496
    ds_read_b64 v[36:37], v178 offset:128
    ds_read_b64 v[38:39], v178 offset:2624
    ds_read_b64 v[40:41], v178 offset:4992
    ds_read_b64 v[42:43], v178 offset:7488
    ds_read_b64 v[44:45], v178 offset:5120
    ds_read_b64 v[46:47], v178 offset:7616
    ds_read_b64 v[48:49], v178 offset:9984
    ds_read_b64 v[50:51], v178 offset:12480
    ds_read_b64 v[52:53], v178 offset:10112
    ds_read_b64 v[54:55], v178 offset:12608
    ds_read_b64 v[56:57], v178 offset:14976
    ds_read_b64 v[58:59], v178 offset:17472
    ds_read_b64 v[60:61], v178 offset:15104
    s_waitcnt lgkmcnt(13)
    ds_read_b64 v[62:63], v178 offset:17600
    ds_read_b64 v[64:65], v178 offset:19968
    s_waitcnt lgkmcnt(13)
    ds_read_b64 v[66:67], v178 offset:22464
    ds_read_b64 v[68:69], v178 offset:20096
    s_waitcnt lgkmcnt(13)
    ds_read_b64 v[70:71], v178 offset:22592
    ds_read_b64 v[72:73], v178 offset:24960
    s_waitcnt lgkmcnt(13)
    ds_read_b64 v[74:75], v178 offset:27456
    ds_read_b64 v[76:77], v178 offset:25088
    s_waitcnt lgkmcnt(13)
    ds_read_b64 v[78:79], v178 offset:27584
    ds_read_b64 v[80:81], v178 offset:29952
    s_waitcnt lgkmcnt(13)
    ds_read_b64 v[82:83], v178 offset:32448
    ds_read_b64 v[84:85], v178 offset:30080
    s_waitcnt lgkmcnt(13)
    ds_read_b64 v[86:87], v178 offset:32576
    ds_read_b64 v[88:89], v178 offset:34944
    s_waitcnt lgkmcnt(13)
    ds_read_b64 v[90:91], v178 offset:37440
    ds_read_b64 v[92:93], v178 offset:35072
    s_waitcnt lgkmcnt(13)
    ds_read_b64 v[94:95], v178 offset:37568
    ds_read_b64 v[96:97], v178 offset:39936
    s_waitcnt lgkmcnt(13)
    ds_read_b64 v[98:99], v178 offset:42432
    ds_read_b64 v[100:101], v178 offset:40064
    s_waitcnt lgkmcnt(13)
    ds_read_b64 v[102:103], v178 offset:42560
    ds_read_b64_tr_b16 v[104:105], v176 offset:0
    s_waitcnt lgkmcnt(13)
    ds_read_b64_tr_b16 v[106:107], v176 offset:2048
    ds_read_b64_tr_b16 v[108:109], v177 offset:0
    s_waitcnt lgkmcnt(13)
    ds_read_b64_tr_b16 v[110:111], v177 offset:2048
    ds_read_b64_tr_b16 v[112:113], v176 offset:4096
    s_waitcnt lgkmcnt(13)
    ds_read_b64_tr_b16 v[114:115], v176 offset:6144
    ds_read_b64_tr_b16 v[116:117], v177 offset:4096
    s_waitcnt lgkmcnt(13)
    ds_read_b64_tr_b16 v[118:119], v177 offset:6144
    ds_read_b64_tr_b16 v[120:121], v176 offset:8192
    s_waitcnt lgkmcnt(13)
    ds_read_b64_tr_b16 v[122:123], v176 offset:10240
    s_waitcnt lgkmcnt(10)
    s_barrier
    s_and_b32 s38, s40, 3
    s_mul_i32 s38, s38, 36864
    s_add_u32 s38, s38, s52
    s_lshl_b32 s44, s40, 7
    s_add_u32 s44, s44, s33
    s_cmp_lt_u32 s40, 9
    s_cselect_b32 s10, s47, 0
    s_add_u32 s40, s40, 1
    s_cmp_ge_u32 s12, 4
    s_cbranch_scc1 KM_LD4
    s_add_u32 m0, s38, 32768
    s_add_u32 s37, s44, 294912
    buffer_load_dwordx4 v246, s[8:11], s37 offen lds
KM_LD4:
    s_add_u32 m0, s38, 0
    s_add_u32 s37, s44, 0
    buffer_load_dwordx4 v246, s[8:11], s37 offen lds
    s_add_u32 m0, s38, 8192
    s_add_u32 s37, s44, 73728
    buffer_load_dwordx4 v246, s[8:11], s37 offen lds
    s_add_u32 m0, s38, 16384
    s_add_u32 s37, s44, 147456
    buffer_load_dwordx4 v246, s[8:11], s37 offen lds
    s_add_u32 m0, s38, 24576
    s_add_u32 s37, s44, 221184
    buffer_load_dwordx4 v246, s[8:11], s37 offen lds
    s_cmp_eq_u32 s46, 0
    s_cbranch_scc1 KM_ANOX
    s_barrier
KM_ANOX:
    s_waitcnt lgkmcnt(6)
    v_mfma_f32_16x16x32_bf16 v[0:3], v[104:107], v[32:35], 0
    ds_read_b64_tr_b16 v[124:125], v177 offset:8192
    v_mfma_f32_16x16x32_bf16 v[8:11], v[104:107], v[36:39], 0
    ds_read_b64_tr_b16 v[126:127], v177 offset:10240
    v_mfma_f32_16x16x32_bf16 v[4:7], v[108:111], v[32:35], 0
    ds_read_b64_tr_b16 v[104:105], v176 offset:12288
    v_mfma_f32_16x16x32_bf16 v[12:15], v[108:111], v[36:39], 0
    ds_read_b64_tr_b16 v[106:107], v176 offset:14336
    s_waitcnt lgkmcnt(6)
    v_mfma_f32_16x16x32_bf16 v[0:3], v[112:115], v[40:43], v[0:3]
    ds_read_b64_tr_b16 v[108:109], v177 offset:12288
    v_mfma_f32_16x16x32_bf16 v[8:11], v[112:115], v[44:47], v[8:11]
    ds_read_b64_tr_b16 v[110:111], v177 offset:14336
    v_mfma_f32_16x16x32_bf16 v[4:7], v[116:119], v[40:43], v[4:7]
    ds_read_b64_tr_b16 v[112:113], v176 offset:16384
    v_mfma_f32_16x16x32_bf16 v[12:15], v[116:119], v[44:47], v[12:15]
    ds_read_b64_tr_b16 v[114:115], v176 offset:18432
    s_waitcnt lgkmcnt(6)
    v_mfma_f32_16x16x32_bf16 v[0:3], v[120:123], v[48:51], v[0:3]
    ds_read_b64_tr_b16 v[116:117], v177 offset:16384
    v_mfma_f32_16x16x32_bf16 v[8:11], v[120:123], v[52:55], v[8:11]
    ds_read_b64_tr_b16 v[118:119], v177 offset:18432
    v_mfma_f32_16x16x32_bf16 v[4:7], v[124:127], v[48:51], v[4:7]
    ds_read_b64_tr_b16 v[120:121], v176 offset:20480
    v_mfma_f32_16x16x32_bf16 v[12:15], v[124:127], v[52:55], v[12:15]
    ds_read_b64_tr_b16 v[122:123], v176 offset:22528
    s_barrier
    s_cmp_eq_u32 s46, 0
    s_cbranch_scc1 KM_ASK1
    s_and_b32 s38, s40, 3
    s_mul_i32 s38, s38, 36864
    s_add_u32 s38, s38, s52
    s_lshl_b32 s44, s40, 7
    s_add_u32 s44, s44, s33
    s_cmp_lt_u32 s40, 9
    s_cselect_b32 s10, s47, 0
    s_add_u32 s40, s40, 1
    s_cmp_ge_u32 s12, 4
    s_cbranch_scc1 KM_LD5
    s_add_u32 m0, s38, 32768
    s_add_u32 s37, s44, 294912
    buffer_load_dwordx4 v246, s[8:11], s37 offen lds
KM_LD5:
    s_add_u32 m0, s38, 0
    s_add_u32 s37, s44, 0
    buffer_load_dwordx4 v246, s[8:11], s37 offen lds
    s_add_u32 m0, s38, 8192
    s_add_u32 s37, s44, 73728
    buffer_load_dwordx4 v246, s[8:11], s37 offen lds
    s_add_u32 m0, s38, 16384
    s_add_u32 s37, s44, 147456
    buffer_load_dwordx4 v246, s[8:11], s37 offen lds
    s_add_u32 m0, s38, 24576
    s_add_u32 s37, s44, 221184
    buffer_load_dwordx4 v246, s[8:11], s37 offen lds
KM_ASK1:
    s_waitcnt lgkmcnt(6)
    v_mfma_f32_16x16x32_bf16 v[0:3], v[104:107], v[56:59], v[0:3]
    ds_read_b64_tr_b16 v[124:125], v177 offset:20480
    v_mfma_f32_16x16x32_bf16 v[8:11], v[104:107], v[60:63], v[8:11]
    ds_read_b64_tr_b16 v[126:127], v177 offset:22528
    v_mfma_f32_16x16x32_bf16 v[4:7], v[108:111], v[56:59], v[4:7]
    ds_read_b64_tr_b16 v[104:105], v176 offset:24576
    v_mfma_f32_16x16x32_bf16 v[12:15], v[108:111], v[60:63], v[12:15]
    ds_read_b64_tr_b16 v[106:107], v176 offset:26624
    s_waitcnt lgkmcnt(6)
    v_mfma_f32_16x16x32_bf16 v[0:3], v[112:115], v[64:67], v[0:3]
    ds_read_b64_tr_b16 v[108:109], v177 offset:24576
    v_mfma_f32_16x16x32_bf16 v[8:11], v[112:115], v[68:71], v[8:11]
    ds_read_b64_tr_b16 v[110:111], v177 offset:26624
    v_mfma_f32_16x16x32_bf16 v[4:7], v[116:119], v[64:67], v[4:7]
    ds_read_b64_tr_b16 v[112:113], v176 offset:28672
    v_mfma_f32_16x16x32_bf16 v[12:15], v[116:119], v[68:71], v[12:15]
    ds_read_b64_tr_b16 v[114:115], v176 offset:30720
    s_waitcnt lgkmcnt(6)
    v_mfma_f32_16x16x32_bf16 v[0:3], v[120:123], v[72:75], v[0:3]
    ds_read_b64_tr_b16 v[116:117], v177 offset:28672
    v_mfma_f32_16x16x32_bf16 v[8:11], v[120:123], v[76:79], v[8:11]
    ds_read_b64_tr_b16 v[118:119], v177 offset:30720
    v_mfma_f32_16x16x32_bf16 v[4:7], v[124:127], v[72:75], v[4:7]
    ds_read_b64_tr_b16 v[120:121], v176 offset:32768
    v_mfma_f32_16x16x32_bf16 v[12:15], v[124:127], v[76:79], v[12:15]
    ds_read_b64_tr_b16 v[122:123], v176 offset:34816
    s_waitcnt lgkmcnt(6)
    v_mfma_f32_16x16x32_bf16 v[0:3], v[104:107], v[80:83], v[0:3]
    ds_read_b64_tr_b16 v[124:125], v177 offset:32768
    v_mfma_f32_16x16x32_bf16 v[8:11], v[104:107], v[84:87], v[8:11]
    ds_read_b64_tr_b16 v[126:127], v177 offset:34816
    v_mfma_f32_16x16x32_bf16 v[4:7], v[108:111], v[80:83], v[4:7]
    v_mfma_f32_16x16x32_bf16 v[12:15], v[108:111], v[84:87], v[12:15]
    s_waitcnt lgkmcnt(4)
    v_mfma_f32_16x16x32_bf16 v[0:3], v[112:115], v[88:91], v[0:3]
    v_mfma_f32_16x16x32_bf16 v[8:11], v[112:115], v[92:95], v[8:11]
    s_waitcnt vmcnt(4)
    s_waitcnt lgkmcnt(0)
    s_barrier
    v_add_u32 v176, 0x12000, v176
    ds_read_b64_tr_b16 v[104:105], v176 offset:0
    ds_read_b64_tr_b16 v[106:107], v176 offset:2048
    v_add_u32 v177, 0x12000, v177
    ds_read_b64_tr_b16 v[108:109], v177 offset:0
    ds_read_b64_tr_b16 v[110:111], v177 offset:2048
    s_and_b32 s38, s40, 3
    s_mul_i32 s38, s38, 36864
    s_add_u32 s38, s38, s52
    s_lshl_b32 s44, s40, 7
    s_add_u32 s44, s44, s33
    s_cmp_lt_u32 s40, 9
    s_cselect_b32 s10, s47, 0
    s_add_u32 s40, s40, 1
    s_cmp_ge_u32 s12, 4
    s_cbranch_scc1 KM_LD6
    s_add_u32 m0, s38, 32768
    s_add_u32 s37, s44, 294912
    buffer_load_dwordx4 v246, s[8:11], s37 offen lds
KM_LD6:
    s_add_u32 m0, s38, 0
    s_add_u32 s37, s44, 0
    buffer_load_dwordx4 v246, s[8:11], s37 offen lds
    v_mfma_f32_16x16x32_bf16 v[4:7], v[116:119], v[88:91], v[4:7]
    ds_read_b64_tr_b16 v[112:113], v176 offset:4096
    v_mfma_f32_16x16x32_bf16 v[12:15], v[116:119], v[92:95], v[12:15]
    ds_read_b64_tr_b16 v[114:115], v176 offset:6144
    s_add_u32 m0, s38, 8192
    s_add_u32 s37, s44, 73728
    buffer_load_dwordx4 v246, s[8:11], s37 offen lds
    v_mfma_f32_16x16x32_bf16 v[0:3], v[120:123], v[96:99], v[0:3]
    ds_read_b64_tr_b16 v[116:117], v177 offset:4096
    v_mfma_f32_16x16x32_bf16 v[8:11], v[120:123], v[100:103], v[8:11]
    ds_read_b64_tr_b16 v[118:119], v177 offset:6144
    s_add_u32 m0, s38, 16384
    s_add_u32 s37, s44, 147456
    buffer_load_dwordx4 v246, s[8:11], s37 offen lds
    v_mfma_f32_16x16x32_bf16 v[4:7], v[124:127], v[96:99], v[4:7]
    ds_read_b64_tr_b16 v[120:121], v176 offset:8192
    v_mfma_f32_16x16x32_bf16 v[12:15], v[124:127], v[100:103], v[12:15]
    ds_read_b64_tr_b16 v[122:123], v176 offset:10240
    s_add_u32 m0, s38, 24576
    s_add_u32 s37, s44, 221184
    buffer_load_dwordx4 v246, s[8:11], s37 offen lds
    s_waitcnt lgkmcnt(6)
    v_mfma_f32_16x16x32_bf16 v[16:19], v[104:107], v[32:35], 0
    ds_read_b64_tr_b16 v[124:125], v177 offset:8192
    v_mfma_f32_16x16x32_bf16 v[24:27], v[104:107], v[36:39], 0
    ds_read_b64_tr_b16 v[126:127], v177 offset:10240
    v_mfma_f32_16x16x32_bf16 v[20:23], v[108:111], v[32:35], 0
    ds_read_b64_tr_b16 v[104:105], v176 offset:12288
    v_mfma_f32_16x16x32_bf16 v[28:31], v[108:111], v[36:39], 0
    ds_read_b64_tr_b16 v[106:107], v176 offset:14336
    s_waitcnt lgkmcnt(6)
    v_mfma_f32_16x16x32_bf16 v[16:19], v[112:115], v[40:43], v[16:19]
    ds_read_b64_tr_b16 v[108:109], v177 offset:12288
    v_mfma_f32_16x16x32_bf16 v[24:27], v[112:115], v[44:47], v[24:27]
    ds_read_b64_tr_b16 v[110:111], v177 offset:14336
    v_mfma_f32_16x16x32_bf16 v[20:23], v[116:119], v[40:43], v[20:23]
    ds_read_b64_tr_b16 v[112:113], v176 offset:16384
    v_mfma_f32_16x16x32_bf16 v[28:31], v[116:119], v[44:47], v[28:31]
    ds_read_b64_tr_b16 v[114:115], v176 offset:18432
    v_cvt_pk_bf16_f32 v128, v0, v1
    s_waitcnt lgkmcnt(6)
    v_mfma_f32_16x16x32_bf16 v[16:19], v[120:123], v[48:51], v[16:19]
    ds_read_b64_tr_b16 v[116:117], v177 offset:16384
    v_mfma_f32_16x16x32_bf16 v[24:27], v[120:123], v[52:55], v[24:27]
    ds_read_b64_tr_b16 v[118:119], v177 offset:18432
    v_cvt_pk_bf16_f32 v129, v2, v3
    v_mfma_f32_16x16x32_bf16 v[20:23], v[124:127], v[48:51], v[20:23]
    ds_read_b64_tr_b16 v[120:121], v176 offset:20480
    v_mfma_f32_16x16x32_bf16 v[28:31], v[124:127], v[52:55], v[28:31]
    ds_read_b64_tr_b16 v[122:123], v176 offset:22528
    s_waitcnt vmcnt(4)
    s_barrier
    s_and_b32 s38, s40, 3
    s_mul_i32 s38, s38, 36864
    s_add_u32 s38, s38, s52
    s_lshl_b32 s44, s40, 7
    s_add_u32 s44, s44, s33
    s_cmp_lt_u32 s40, 9
    s_cselect_b32 s10, s47, 0
    s_add_u32 s40, s40, 1
    s_cmp_ge_u32 s12, 4
    s_cbranch_scc1 KM_LD7
    s_add_u32 m0, s38, 32768
    s_add_u32 s37, s44, 294912
    buffer_load_dwordx4 v246, s[8:11], s37 offen lds
KM_LD7:
    s_add_u32 m0, s38, 0
    s_add_u32 s37, s44, 0
    buffer_load_dwordx4 v246, s[8:11], s37 offen lds
    v_cvt_pk_bf16_f32 v130, v4, v5
    s_waitcnt lgkmcnt(6)
    v_mfma_f32_16x16x32_bf16 v[16:19], v[104:107], v[56:59], v[16:19]
    ds_read_b64_tr_b16 v[124:125], v177 offset:20480
    v_mfma_f32_16x16x32_bf16 v[24:27], v[104:107], v[60:63], v[24:27]
    ds_read_b64_tr_b16 v[126:127], v177 offset:22528
    s_add_u32 m0, s38, 8192
    s_add_u32 s37, s44, 73728
    buffer_load_dwordx4 v246, s[8:11], s37 offen lds
    v_cvt_pk_bf16_f32 v131, v6, v7
    v_mfma_f32_16x16x32_bf16 v[20:23], v[108:111], v[56:59], v[20:23]
    ds_read_b64_tr_b16 v[104:105], v176 offset:24576
    v_mfma_f32_16x16x32_bf16 v[28:31], v[108:111], v[60:63], v[28:31]
    ds_read_b64_tr_b16 v[106:107], v176 offset:26624
    s_add_u32 m0, s38, 16384
    s_add_u32 s37, s44, 147456
    buffer_load_dwordx4 v246, s[8:11], s37 offen lds
    v_cvt_pk_bf16_f32 v132, v8, v9
    s_waitcnt lgkmcnt(6)
    v_mfma_f32_16x16x32_bf16 v[16:19], v[112:115], v[64:67], v[16:19]
    ds_read_b64_tr_b16 v[108:109], v177 offset:24576
    v_mfma_f32_16x16x32_bf16 v[24:27], v[112:115], v[68:71], v[24:27]
    ds_read_b64_tr_b16 v[110:111], v177 offset:26624
    s_add_u32 m0, s38, 24576
    s_add_u32 s37, s44, 221184
    buffer_load_dwordx4 v246, s[8:11], s37 offen lds
    v_cvt_pk_bf16_f32 v133, v10, v11
    v_mfma_f32_16x16x32_bf16 v[20:23], v[116:119], v[64:67], v[20:23]
    ds_read_b64_tr_b16 v[112:113], v176 offset:28672
    v_mfma_f32_16x16x32_bf16 v[28:31], v[116:119], v[68:71], v[28:31]
    ds_read_b64_tr_b16 v[114:115], v176 offset:30720
    v_cvt_pk_bf16_f32 v134, v12, v13
    s_waitcnt lgkmcnt(6)
    v_mfma_f32_16x16x32_bf16 v[16:19], v[120:123], v[72:75], v[16:19]
    ds_read_b64_tr_b16 v[116:117], v177 offset:28672
    v_mfma_f32_16x16x32_bf16 v[24:27], v[120:123], v[76:79], v[24:27]
    ds_read_b64_tr_b16 v[118:119], v177 offset:30720
    v_cvt_pk_bf16_f32 v135, v14, v15
    v_mfma_f32_16x16x32_bf16 v[20:23], v[124:127], v[72:75], v[20:23]
    ds_read_b64_tr_b16 v[120:121], v176 offset:32768
    v_mfma_f32_16x16x32_bf16 v[28:31], v[124:127], v[76:79], v[28:31]
    ds_read_b64_tr_b16 v[122:123], v176 offset:34816
    s_waitcnt lgkmcnt(6)
    v_mfma_f32_16x16x32_bf16 v[16:19], v[104:107], v[80:83], v[16:19]
    ds_read_b64_tr_b16 v[124:125], v177 offset:32768
    v_mfma_f32_16x16x32_bf16 v[24:27], v[104:107], v[84:87], v[24:27]
    ds_read_b64_tr_b16 v[126:127], v177 offset:34816
    v_mfma_f32_16x16x32_bf16 v[20:23], v[108:111], v[80:83], v[20:23]
    v_mfma_f32_16x16x32_bf16 v[28:31], v[108:111], v[84:87], v[28:31]
    s_waitcnt lgkmcnt(4)
    v_mfma_f32_16x16x32_bf16 v[16:19], v[112:115], v[88:91], v[16:19]
    v_mfma_f32_16x16x32_bf16 v[24:27], v[112:115], v[92:95], v[24:27]
    s_waitcnt vmcnt(4) lgkmcnt(0)
    s_barrier
    v_subrev_u32 v176, 0x12000, v176
    ds_read_b64_tr_b16 v[104:105], v176 offset:0
    ds_read_b64_tr_b16 v[106:107], v176 offset:2048
    v_subrev_u32 v177, 0x12000, v177
    ds_read_b64_tr_b16 v[108:109], v177 offset:0
    ds_read_b64_tr_b16 v[110:111], v177 offset:2048
    s_and_b32 s38, s40, 3
    s_mul_i32 s38, s38, 36864
    s_add_u32 s38, s38, s52
    s_lshl_b32 s44, s40, 7
    s_add_u32 s44, s44, s33
    s_cmp_lt_u32 s40, 9
    s_cselect_b32 s10, s47, 0
    s_add_u32 s40, s40, 1
    s_cmp_ge_u32 s12, 4
    s_cbranch_scc1 KM_LD8
    s_add_u32 m0, s38, 32768
    s_add_u32 s37, s44, 294912
    buffer_load_dwordx4 v246, s[8:11], s37 offen lds
KM_LD8:
    s_add_u32 m0, s38, 0
    s_add_u32 s37, s44, 0
    buffer_load_dwordx4 v246, s[8:11], s37 offen lds
    v_mfma_f32_16x16x32_bf16 v[20:23], v[116:119], v[88:91], v[20:23]
    ds_read_b64_tr_b16 v[112:113], v176 offset:4096
    v_mfma_f32_16x16x32_bf16 v[28:31], v[116:119], v[92:95], v[28:31]
    ds_read_b64_tr_b16 v[114:115], v176 offset:6144
    s_add_u32 m0, s38, 8192
    s_add_u32 s37, s44, 73728
    buffer_load_dwordx4 v246, s[8:11], s37 offen lds
    v_mfma_f32_16x16x32_bf16 v[16:19], v[120:123], v[96:99], v[16:19]
    ds_read_b64_tr_b16 v[116:117], v177 offset:4096
    v_mfma_f32_16x16x32_bf16 v[24:27], v[120:123], v[100:103], v[24:27]
    ds_read_b64_tr_b16 v[118:119], v177 offset:6144
    s_add_u32 m0, s38, 16384
    s_add_u32 s37, s44, 147456
    buffer_load_dwordx4 v246, s[8:11], s37 offen lds
    v_mfma_f32_16x16x32_bf16 v[20:23], v[124:127], v[96:99], v[20:23]
    ds_read_b64_tr_b16 v[120:121], v176 offset:8192
    v_mfma_f32_16x16x32_bf16 v[28:31], v[124:127], v[100:103], v[28:31]
    ds_read_b64_tr_b16 v[122:123], v176 offset:10240
    s_add_u32 m0, s38, 24576
    s_add_u32 s37, s44, 221184
    buffer_load_dwordx4 v246, s[8:11], s37 offen lds
    s_waitcnt lgkmcnt(6)
    v_mfma_f32_16x16x32_bf16 v[0:3], v[104:107], v[32:35], 0
    ds_read_b64_tr_b16 v[124:125], v177 offset:8192
    v_mfma_f32_16x16x32_bf16 v[8:11], v[104:107], v[36:39], 0
    ds_read_b64_tr_b16 v[126:127], v177 offset:10240
    v_mfma_f32_16x16x32_bf16 v[4:7], v[108:111], v[32:35], 0
    ds_read_b64_tr_b16 v[104:105], v176 offset:12288
    v_mfma_f32_16x16x32_bf16 v[12:15], v[108:111], v[36:39], 0
    ds_read_b64_tr_b16 v[106:107], v176 offset:14336
    s_waitcnt lgkmcnt(6)
    v_mfma_f32_16x16x32_bf16 v[0:3], v[112:115], v[40:43], v[0:3]
    ds_read_b64_tr_b16 v[108:109], v177 offset:12288
    v_mfma_f32_16x16x32_bf16 v[8:11], v[112:115], v[44:47], v[8:11]
    ds_read_b64_tr_b16 v[110:111], v177 offset:14336
    v_mfma_f32_16x16x32_bf16 v[4:7], v[116:119], v[40:43], v[4:7]
    ds_read_b64_tr_b16 v[112:113], v176 offset:16384
    v_mfma_f32_16x16x32_bf16 v[12:15], v[116:119], v[44:47], v[12:15]
    ds_read_b64_tr_b16 v[114:115], v176 offset:18432
    v_cvt_pk_bf16_f32 v136, v16, v17
    s_waitcnt lgkmcnt(6)
    v_mfma_f32_16x16x32_bf16 v[0:3], v[120:123], v[48:51], v[0:3]
    ds_read_b64_tr_b16 v[116:117], v177 offset:16384
    v_mfma_f32_16x16x32_bf16 v[8:11], v[120:123], v[52:55], v[8:11]
    ds_read_b64_tr_b16 v[118:119], v177 offset:18432
    v_cvt_pk_bf16_f32 v137, v18, v19
    v_mfma_f32_16x16x32_bf16 v[4:7], v[124:127], v[48:51], v[4:7]
    ds_read_b64_tr_b16 v[120:121], v176 offset:20480
    v_mfma_f32_16x16x32_bf16 v[12:15], v[124:127], v[52:55], v[12:15]
    ds_read_b64_tr_b16 v[122:123], v176 offset:22528
    s_waitcnt vmcnt(4)
    s_barrier
    s_and_b32 s38, s40, 3
    s_mul_i32 s38, s38, 36864
    s_add_u32 s38, s38, s52
    s_lshl_b32 s44, s40, 7
    s_add_u32 s44, s44, s33
    s_cmp_lt_u32 s40, 9
    s_cselect_b32 s10, s47, 0
    s_add_u32 s40, s40, 1
    s_cmp_ge_u32 s12, 4
    s_cbranch_scc1 KM_LD9
    s_add_u32 m0, s38, 32768
    s_add_u32 s37, s44, 294912
    buffer_load_dwordx4 v246, s[8:11], s37 offen lds
KM_LD9:
    s_add_u32 m0, s38, 0
    s_add_u32 s37, s44, 0
    buffer_load_dwordx4 v246, s[8:11], s37 offen lds
    v_cvt_pk_bf16_f32 v138, v20, v21
    s_waitcnt lgkmcnt(6)
    v_mfma_f32_16x16x32_bf16 v[0:3], v[104:107], v[56:59], v[0:3]
    ds_read_b64_tr_b16 v[124:125], v177 offset:20480
    v_mfma_f32_16x16x32_bf16 v[8:11], v[104:107], v[60:63], v[8:11]
    ds_read_b64_tr_b16 v[126:127], v177 offset:22528
    s_add_u32 m0, s38, 8192
    s_add_u32 s37, s44, 73728
    buffer_load_dwordx4 v246, s[8:11], s37 offen lds
    v_cvt_pk_bf16_f32 v139, v22, v23
    v_mfma_f32_16x16x32_bf16 v[4:7], v[108:111], v[56:59], v[4:7]
    ds_read_b64_tr_b16 v[104:105], v176 offset:24576
    v_mfma_f32_16x16x32_bf16 v[12:15], v[108:111], v[60:63], v[12:15]
    ds_read_b64_tr_b16 v[106:107], v176 offset:26624
    s_add_u32 m0, s38, 16384
    s_add_u32 s37, s44, 147456
    buffer_load_dwordx4 v246, s[8:11], s37 offen lds
    v_cvt_pk_bf16_f32 v140, v24, v25
    s_waitcnt lgkmcnt(6)
    v_mfma_f32_16x16x32_bf16 v[0:3], v[112:115], v[64:67], v[0:3]
    ds_read_b64_tr_b16 v[108:109], v177 offset:24576
    v_mfma_f32_16x16x32_bf16 v[8:11], v[112:115], v[68:71], v[8:11]
    ds_read_b64_tr_b16 v[110:111], v177 offset:26624
    s_add_u32 m0, s38, 24576
    s_add_u32 s37, s44, 221184
    buffer_load_dwordx4 v246, s[8:11], s37 offen lds
    v_cvt_pk_bf16_f32 v141, v26, v27
    v_mfma_f32_16x16x32_bf16 v[4:7], v[116:119], v[64:67], v[4:7]
    ds_read_b64_tr_b16 v[112:113], v176 offset:28672
    v_mfma_f32_16x16x32_bf16 v[12:15], v[116:119], v[68:71], v[12:15]
    ds_read_b64_tr_b16 v[114:115], v176 offset:30720
    v_cvt_pk_bf16_f32 v142, v28, v29
    s_waitcnt lgkmcnt(6)
    v_mfma_f32_16x16x32_bf16 v[0:3], v[120:123], v[72:75], v[0:3]
    ds_read_b64_tr_b16 v[116:117], v177 offset:28672
    v_mfma_f32_16x16x32_bf16 v[8:11], v[120:123], v[76:79], v[8:11]
    ds_read_b64_tr_b16 v[118:119], v177 offset:30720
    v_cvt_pk_bf16_f32 v143, v30, v31
    v_mfma_f32_16x16x32_bf16 v[4:7], v[124:127], v[72:75], v[4:7]
    ds_read_b64_tr_b16 v[120:121], v176 offset:32768
    v_mfma_f32_16x16x32_bf16 v[12:15], v[124:127], v[76:79], v[12:15]
    ds_read_b64_tr_b16 v[122:123], v176 offset:34816
    s_waitcnt lgkmcnt(6)
    v_mfma_f32_16x16x32_bf16 v[0:3], v[104:107], v[80:83], v[0:3]
    ds_read_b64_tr_b16 v[124:125], v177 offset:32768
    v_mfma_f32_16x16x32_bf16 v[8:11], v[104:107], v[84:87], v[8:11]
    ds_read_b64_tr_b16 v[126:127], v177 offset:34816
    v_mfma_f32_16x16x32_bf16 v[4:7], v[108:111], v[80:83], v[4:7]
    v_mfma_f32_16x16x32_bf16 v[12:15], v[108:111], v[84:87], v[12:15]
    s_waitcnt lgkmcnt(4)
    v_mfma_f32_16x16x32_bf16 v[0:3], v[112:115], v[88:91], v[0:3]
    v_mfma_f32_16x16x32_bf16 v[8:11], v[112:115], v[92:95], v[8:11]
    s_waitcnt vmcnt(4) lgkmcnt(0)
    s_barrier
    v_add_u32 v176, 0x12000, v176
    ds_read_b64_tr_b16 v[104:105], v176 offset:0
    ds_read_b64_tr_b16 v[106:107], v176 offset:2048
    v_add_u32 v177, 0x12000, v177
    ds_read_b64_tr_b16 v[108:109], v177 offset:0
    ds_read_b64_tr_b16 v[110:111], v177 offset:2048
    s_and_b32 s38, s40, 3
    s_mul_i32 s38, s38, 36864
    s_add_u32 s38, s38, s52
    s_lshl_b32 s44, s40, 7
    s_add_u32 s44, s44, s33
    s_cmp_lt_u32 s40, 9
    s_cselect_b32 s10, s47, 0
    s_add_u32 s40, s40, 1
    s_cmp_ge_u32 s12, 4
    s_cbranch_scc1 KM_LD10
    s_add_u32 m0, s38, 32768
    s_add_u32 s37, s44, 294912
    buffer_load_dwordx4 v246, s[8:11], s37 offen lds
KM_LD10:
    s_add_u32 m0, s38, 0
    s_add_u32 s37, s44, 0
    buffer_load_dwordx4 v246, s[8:11], s37 offen lds
    v_mfma_f32_16x16x32_bf16 v[4:7], v[116:119], v[88:91], v[4:7]
    ds_read_b64_tr_b16 v[112:113], v176 offset:4096
    v_mfma_f32_16x16x32_bf16 v[12:15], v[116:119], v[92:95], v[12:15]
    ds_read_b64_tr_b16 v[114:115], v176 offset:6144
    s_add_u32 m0, s38, 8192
    s_add_u32 s37, s44, 73728
    buffer_load_dwordx4 v246, s[8:11], s37 offen lds
    v_mfma_f32_16x16x32_bf16 v[0:3], v[120:123], v[96:99], v[0:3]
    ds_read_b64_tr_b16 v[116:117], v177 offset:4096
    v_mfma_f32_16x16x32_bf16 v[8:11], v[120:123], v[100:103], v[8:11]
    ds_read_b64_tr_b16 v[118:119], v177 offset:6144
    s_add_u32 m0, s38, 16384
    s_add_u32 s37, s44, 147456
    buffer_load_dwordx4 v246, s[8:11], s37 offen lds
    v_mfma_f32_16x16x32_bf16 v[4:7], v[124:127], v[96:99], v[4:7]
    ds_read_b64_tr_b16 v[120:121], v176 offset:8192
    v_mfma_f32_16x16x32_bf16 v[12:15], v[124:127], v[100:103], v[12:15]
    ds_read_b64_tr_b16 v[122:123], v176 offset:10240
    s_add_u32 m0, s38, 24576
    s_add_u32 s37, s44, 221184
    buffer_load_dwordx4 v246, s[8:11], s37 offen lds
    s_waitcnt lgkmcnt(6)
    v_mfma_f32_16x16x32_bf16 v[16:19], v[104:107], v[32:35], 0
    ds_read_b64_tr_b16 v[124:125], v177 offset:8192
    v_mfma_f32_16x16x32_bf16 v[24:27], v[104:107], v[36:39], 0
    ds_read_b64_tr_b16 v[126:127], v177 offset:10240
    v_mfma_f32_16x16x32_bf16 v[20:23], v[108:111], v[32:35], 0
    ds_read_b64_tr_b16 v[104:105], v176 offset:12288
    v_mfma_f32_16x16x32_bf16 v[28:31], v[108:111], v[36:39], 0
    ds_read_b64_tr_b16 v[106:107], v176 offset:14336
    s_waitcnt lgkmcnt(6)
    v_mfma_f32_16x16x32_bf16 v[16:19], v[112:115], v[40:43], v[16:19]
    ds_read_b64_tr_b16 v[108:109], v177 offset:12288
    v_mfma_f32_16x16x32_bf16 v[24:27], v[112:115], v[44:47], v[24:27]
    ds_read_b64_tr_b16 v[110:111], v177 offset:14336
    v_mfma_f32_16x16x32_bf16 v[20:23], v[116:119], v[40:43], v[20:23]
    ds_read_b64_tr_b16 v[112:113], v176 offset:16384
    v_mfma_f32_16x16x32_bf16 v[28:31], v[116:119], v[44:47], v[28:31]
    ds_read_b64_tr_b16 v[114:115], v176 offset:18432
    v_cvt_pk_bf16_f32 v144, v0, v1
    s_waitcnt lgkmcnt(6)
    v_mfma_f32_16x16x32_bf16 v[16:19], v[120:123], v[48:51], v[16:19]
    ds_read_b64_tr_b16 v[116:117], v177 offset:16384
    v_mfma_f32_16x16x32_bf16 v[24:27], v[120:123], v[52:55], v[24:27]
    ds_read_b64_tr_b16 v[118:119], v177 offset:18432
    v_cvt_pk_bf16_f32 v145, v2, v3
    v_mfma_f32_16x16x32_bf16 v[20:23], v[124:127], v[48:51], v[20:23]
    ds_read_b64_tr_b16 v[120:121], v176 offset:20480
    v_mfma_f32_16x16x32_bf16 v[28:31], v[124:127], v[52:55], v[28:31]
    ds_read_b64_tr_b16 v[122:123], v176 offset:22528
    s_waitcnt vmcnt(4)
    s_barrier
    v_cvt_pk_bf16_f32 v146, v4, v5
    s_waitcnt lgkmcnt(6)
    v_mfma_f32_16x16x32_bf16 v[16:19], v[104:107], v[56:59], v[16:19]
    ds_read_b64_tr_b16 v[124:125], v177 offset:20480
    v_mfma_f32_16x16x32_bf16 v[24:27], v[104:107], v[60:63], v[24:27]
    ds_read_b64_tr_b16 v[126:127], v177 offset:22528
    v_cvt_pk_bf16_f32 v147, v6, v7
    v_mfma_f32_16x16x32_bf16 v[20:23], v[108:111], v[56:59], v[20:23]
    ds_read_b64_tr_b16 v[104:105], v176 offset:24576
    v_mfma_f32_16x16x32_bf16 v[28:31], v[108:111], v[60:63], v[28:31]
    ds_read_b64_tr_b16 v[106:107], v176 offset:26624
    v_cvt_pk_bf16_f32 v148, v8, v9
    s_waitcnt lgkmcnt(6)
    v_mfma_f32_16x16x32_bf16 v[16:19], v[112:115], v[64:67], v[16:19]
    ds_read_b64_tr_b16 v[108:109], v177 offset:24576
    v_mfma_f32_16x16x32_bf16 v[24:27], v[112:115], v[68:71], v[24:27]
    ds_read_b64_tr_b16 v[110:111], v177 offset:26624
    v_cvt_pk_bf16_f32 v149, v10, v11
    v_mfma_f32_16x16x32_bf16 v[20:23], v[116:119], v[64:67], v[20:23]
    ds_read_b64_tr_b16 v[112:113], v176 offset:28672
    v_mfma_f32_16x16x32_bf16 v[28:31], v[116:119], v[68:71], v[28:31]
    ds_read_b64_tr_b16 v[114:115], v176 offset:30720
    v_cvt_pk_bf16_f32 v150, v12, v13
    s_waitcnt lgkmcnt(6)
    v_mfma_f32_16x16x32_bf16 v[16:19], v[120:123], v[72:75], v[16:19]
    ds_read_b64_tr_b16 v[116:117], v177 offset:28672
    v_mfma_f32_16x16x32_bf16 v[24:27], v[120:123], v[76:79], v[24:27]
    ds_read_b64_tr_b16 v[118:119], v177 offset:30720
    v_cvt_pk_bf16_f32 v151, v14, v15
    v_mfma_f32_16x16x32_bf16 v[20:23], v[124:127], v[72:75], v[20:23]
    ds_read_b64_tr_b16 v[120:121], v176 offset:32768
    v_mfma_f32_16x16x32_bf16 v[28:31], v[124:127], v[76:79], v[28:31]
    ds_read_b64_tr_b16 v[122:123], v176 offset:34816
    s_waitcnt lgkmcnt(6)
    v_mfma_f32_16x16x32_bf16 v[16:19], v[104:107], v[80:83], v[16:19]
    ds_read_b64_tr_b16 v[124:125], v177 offset:32768
    v_mfma_f32_16x16x32_bf16 v[24:27], v[104:107], v[84:87], v[24:27]
    ds_read_b64_tr_b16 v[126:127], v177 offset:34816
    v_mfma_f32_16x16x32_bf16 v[20:23], v[108:111], v[80:83], v[20:23]
    v_mfma_f32_16x16x32_bf16 v[28:31], v[108:111], v[84:87], v[28:31]
    s_waitcnt lgkmcnt(4)
    v_mfma_f32_16x16x32_bf16 v[16:19], v[112:115], v[88:91], v[16:19]
    v_mfma_f32_16x16x32_bf16 v[24:27], v[112:115], v[92:95], v[24:27]
    s_waitcnt vmcnt(0) lgkmcnt(0)
    s_barrier
    v_subrev_u32 v176, 0x12000, v176
    ds_read_b64_tr_b16 v[104:105], v176 offset:0
    ds_read_b64_tr_b16 v[106:107], v176 offset:2048
    v_subrev_u32 v177, 0x12000, v177
    ds_read_b64_tr_b16 v[108:109], v177 offset:0
    ds_read_b64_tr_b16 v[110:111], v177 offset:2048
    v_mfma_f32_16x16x32_bf16 v[20:23], v[116:119], v[88:91], v[20:23]
    ds_read_b64_tr_b16 v[112:113], v176 offset:4096
    v_mfma_f32_16x16x32_bf16 v[28:31], v[116:119], v[92:95], v[28:31]
    ds_read_b64_tr_b16 v[114:115], v176 offset:6144
    v_mfma_f32_16x16x32_bf16 v[16:19], v[120:123], v[96:99], v[16:19]
    ds_read_b64_tr_b16 v[116:117], v177 offset:4096
    v_mfma_f32_16x16x32_bf16 v[24:27], v[120:123], v[100:103], v[24:27]
    ds_read_b64_tr_b16 v[118:119], v177 offset:6144
    v_mfma_f32_16x16x32_bf16 v[20:23], v[124:127], v[96:99], v[20:23]
    ds_read_b64_tr_b16 v[120:121], v176 offset:8192
    v_mfma_f32_16x16x32_bf16 v[28:31], v[124:127], v[100:103], v[28:31]
    ds_read_b64_tr_b16 v[122:123], v176 offset:10240
    s_cmp_eq_u32 s46, 0
    s_cbranch_scc1 KM_AR4
    s_add_u32 s37, s36, 0
    buffer_store_dwordx4 v[128:131], v245, s[24:27], s37 offen sc1
    s_add_u32 s37, s36, 18432
    buffer_store_dwordx4 v[132:135], v245, s[24:27], s37 offen sc1
    s_add_u32 s37, s36, 4096
    buffer_store_dwordx4 v[136:139], v245, s[24:27], s37 offen sc1
    s_add_u32 s37, s36, 22528
    buffer_store_dwordx4 v[140:143], v245, s[24:27], s37 offen sc1
    s_add_u32 s37, s36, 8192
    buffer_store_dwordx4 v[144:147], v245, s[24:27], s37 offen sc1
    s_add_u32 s37, s36, 26624
    buffer_store_dwordx4 v[148:151], v245, s[24:27], s37 offen sc1
    v_cvt_pk_bf16_f32 v152, v16, v17
    v_cvt_pk_bf16_f32 v153, v18, v19
    v_cvt_pk_bf16_f32 v154, v20, v21
    v_cvt_pk_bf16_f32 v155, v22, v23
    v_cvt_pk_bf16_f32 v156, v24, v25
    v_cvt_pk_bf16_f32 v157, v26, v27
    v_cvt_pk_bf16_f32 v158, v28, v29
    v_cvt_pk_bf16_f32 v159, v30, v31
    s_add_u32 s37, s36, 12288
    buffer_store_dwordx4 v[152:155], v245, s[24:27], s37 offen sc1
    s_add_u32 s37, s36, 30720
    buffer_store_dwordx4 v[156:159], v245, s[24:27], s37 offen sc1
    s_branch KM_AAFIN
KM_AR4:
    s_waitcnt lgkmcnt(6)
    v_mfma_f32_16x16x32_bf16 v[0:3], v[104:107], v[32:35], 0
    ds_read_b64_tr_b16 v[124:125], v177 offset:8192
    v_mfma_f32_16x16x32_bf16 v[8:11], v[104:107], v[36:39], 0
    ds_read_b64_tr_b16 v[126:127], v177 offset:10240
    v_mfma_f32_16x16x32_bf16 v[4:7], v[108:111], v[32:35], 0
    ds_read_b64_tr_b16 v[104:105], v176 offset:12288
    v_mfma_f32_16x16x32_bf16 v[12:15], v[108:111], v[36:39], 0
    ds_read_b64_tr_b16 v[106:107], v176 offset:14336
    s_waitcnt lgkmcnt(6)
    v_mfma_f32_16x16x32_bf16 v[0:3], v[112:115], v[40:43], v[0:3]
    ds_read_b64_tr_b16 v[108:109], v177 offset:12288
    v_mfma_f32_16x16x32_bf16 v[8:11], v[112:115], v[44:47], v[8:11]
    ds_read_b64_tr_b16 v[110:111], v177 offset:14336
    v_mfma_f32_16x16x32_bf16 v[4:7], v[116:119], v[40:43], v[4:7]
    ds_read_b64_tr_b16 v[112:113], v176 offset:16384
    v_mfma_f32_16x16x32_bf16 v[12:15], v[116:119], v[44:47], v[12:15]
    ds_read_b64_tr_b16 v[114:115], v176 offset:18432
    v_cvt_pk_bf16_f32 v152, v16, v17
    s_waitcnt lgkmcnt(6)
    v_mfma_f32_16x16x32_bf16 v[0:3], v[120:123], v[48:51], v[0:3]
    ds_read_b64_tr_b16 v[116:117], v177 offset:16384
    v_mfma_f32_16x16x32_bf16 v[8:11], v[120:123], v[52:55], v[8:11]
    ds_read_b64_tr_b16 v[118:119], v177 offset:18432
    v_cvt_pk_bf16_f32 v153, v18, v19
    v_mfma_f32_16x16x32_bf16 v[4:7], v[124:127], v[48:51], v[4:7]
    ds_read_b64_tr_b16 v[120:121], v176 offset:20480
    v_mfma_f32_16x16x32_bf16 v[12:15], v[124:127], v[52:55], v[12:15]
    ds_read_b64_tr_b16 v[122:123], v176 offset:22528
    s_barrier
    v_cvt_pk_bf16_f32 v154, v20, v21
    s_waitcnt lgkmcnt(6)
    v_mfma_f32_16x16x32_bf16 v[0:3], v[104:107], v[56:59], v[0:3]
    ds_read_b64_tr_b16 v[124:125], v177 offset:20480
    v_mfma_f32_16x16x32_bf16 v[8:11], v[104:107], v[60:63], v[8:11]
    ds_read_b64_tr_b16 v[126:127], v177 offset:22528
    v_cvt_pk_bf16_f32 v155, v22, v23
    v_mfma_f32_16x16x32_bf16 v[4:7], v[108:111], v[56:59], v[4:7]
    ds_read_b64_tr_b16 v[104:105], v176 offset:24576
    v_mfma_f32_16x16x32_bf16 v[12:15], v[108:111], v[60:63], v[12:15]
    ds_read_b64_tr_b16 v[106:107], v176 offset:26624
    v_cvt_pk_bf16_f32 v156, v24, v25
    s_waitcnt lgkmcnt(6)
    v_mfma_f32_16x16x32_bf16 v[0:3], v[112:115], v[64:67], v[0:3]
    ds_read_b64_tr_b16 v[108:109], v177 offset:24576
    v_mfma_f32_16x16x32_bf16 v[8:11], v[112:115], v[68:71], v[8:11]
    ds_read_b64_tr_b16 v[110:111], v177 offset:26624
    v_cvt_pk_bf16_f32 v157, v26, v27
    v_mfma_f32_16x16x32_bf16 v[4:7], v[116:119], v[64:67], v[4:7]
    ds_read_b64_tr_b16 v[112:113], v176 offset:28672
    v_mfma_f32_16x16x32_bf16 v[12:15], v[116:119], v[68:71], v[12:15]
    ds_read_b64_tr_b16 v[114:115], v176 offset:30720
    v_cvt_pk_bf16_f32 v158, v28, v29
    s_waitcnt lgkmcnt(6)
    v_mfma_f32_16x16x32_bf16 v[0:3], v[120:123], v[72:75], v[0:3]
    ds_read_b64_tr_b16 v[116:117], v177 offset:28672
    v_mfma_f32_16x16x32_bf16 v[8:11], v[120:123], v[76:79], v[8:11]
    ds_read_b64_tr_b16 v[118:119], v177 offset:30720
    v_cvt_pk_bf16_f32 v159, v30, v31
    v_mfma_f32_16x16x32_bf16 v[4:7], v[124:127], v[72:75], v[4:7]
    ds_read_b64_tr_b16 v[120:121], v176 offset:32768
    v_mfma_f32_16x16x32_bf16 v[12:15], v[124:127], v[76:79], v[12:15]
    ds_read_b64_tr_b16 v[122:123], v176 offset:34816
    s_waitcnt lgkmcnt(6)
    v_mfma_f32_16x16x32_bf16 v[0:3], v[104:107], v[80:83], v[0:3]
    ds_read_b64_tr_b16 v[124:125], v177 offset:32768
    v_mfma_f32_16x16x32_bf16 v[8:11], v[104:107], v[84:87], v[8:11]
    ds_read_b64_tr_b16 v[126:127], v177 offset:34816
    v_mfma_f32_16x16x32_bf16 v[4:7], v[108:111], v[80:83], v[4:7]
    v_mfma_f32_16x16x32_bf16 v[12:15], v[108:111], v[84:87], v[12:15]
    s_waitcnt lgkmcnt(4)
    v_mfma_f32_16x16x32_bf16 v[0:3], v[112:115], v[88:91], v[0:3]
    v_mfma_f32_16x16x32_bf16 v[8:11], v[112:115], v[92:95], v[8:11]
    v_mfma_f32_16x16x32_bf16 v[4:7], v[116:119], v[88:91], v[4:7]
    v_mfma_f32_16x16x32_bf16 v[12:15], v[116:119], v[92:95], v[12:15]
    s_waitcnt lgkmcnt(0)
    v_mfma_f32_16x16x32_bf16 v[0:3], v[120:123], v[96:99], v[0:3]
    v_mfma_f32_16x16x32_bf16 v[8:11], v[120:123], v[100:103], v[8:11]
    v_mfma_f32_16x16x32_bf16 v[4:7], v[124:127], v[96:99], v[4:7]
    v_mfma_f32_16x16x32_bf16 v[12:15], v[124:127], v[100:103], v[12:15]
    s_add_u32 s37, s36, 0
    buffer_store_dwordx4 v[128:131], v245, s[24:27], s37 offen sc1
    s_add_u32 s37, s36, 18432
    buffer_store_dwordx4 v[132:135], v245, s[24:27], s37 offen sc1
    s_add_u32 s37, s36, 4096
    buffer_store_dwordx4 v[136:139], v245, s[24:27], s37 offen sc1
    s_add_u32 s37, s36, 22528
    buffer_store_dwordx4 v[140:143], v245, s[24:27], s37 offen sc1
    s_add_u32 s37, s36, 8192
    buffer_store_dwordx4 v[144:147], v245, s[24:27], s37 offen sc1
    s_add_u32 s37, s36, 26624
    buffer_store_dwordx4 v[148:151], v245, s[24:27], s37 offen sc1
    s_add_u32 s37, s36, 12288
    buffer_store_dwordx4 v[152:155], v245, s[24:27], s37 offen sc1
    s_add_u32 s37, s36, 30720
    buffer_store_dwordx4 v[156:159], v245, s[24:27], s37 offen sc1
    v_cvt_pk_bf16_f32 v160, v0, v1
    v_cvt_pk_bf16_f32 v161, v2, v3
    v_cvt_pk_bf16_f32 v162, v4, v5
    v_cvt_pk_bf16_f32 v163, v6, v7
    v_cvt_pk_bf16_f32 v164, v8, v9
    v_cvt_pk_bf16_f32 v165, v10, v11
    v_cvt_pk_bf16_f32 v166, v12, v13
    v_cvt_pk_bf16_f32 v167, v14, v15
    s_add_u32 s37, s36, 16384
    buffer_store_dwordx4 v[160:163], v245, s[24:27], s37 offen sc1
    s_add_u32 s37, s36, 34816
    buffer_store_dwordx4 v[164:167], v245, s[24:27], s37 offen sc1
KM_AAFIN:
    s_lshr_b32 s37, s32, 1
    s_mul_i32 s37, s37, 48
    s_lshl_b32 s38, s34, 3
    s_add_u32 s37, s37, s38
    s_and_b32 s38, s32, 1
    s_add_u32 s37, s37, s38
    s_lshl_b32 s37, s37, 7
    s_add_u32 s37, s37, 0x2780000
    v_lshrrev_b32 v181, 2, v249
    v_lshlrev_b32 v181, 11, v181
    v_and_b32 v182, 3, v249
    v_lshl_add_u32 v181, v182, 8, v181
    v_mov_b32 v180, 1
    s_waitcnt vmcnt(0)
    s_mov_b64 exec, 0xfff
    buffer_atomic_add v180, v181, s[24:27], s37 offen
    s_mov_b64 exec, -1
    s_endpgm
KM_CONST:
    v_lshrrev_b32 v176, 4, v255
    v_and_b32 v177, 15, v255
    v_mul_u32_u24 v178, 1248, v176
    v_add_u32 v178, 36864, v178
    v_lshl_add_u32 v164, v177, 4, v178
    v_add_u32 v164, 112, v164
    v_max_u32 v165, 9, v177
    v_subrev_u32 v165, 9, v165
    v_lshl_add_u32 v165, v165, 4, v178
    v_lshlrev_b32 v169, 4, v177
    v_lshl_add_u32 v169, v176, 10, v169
    v_and_b32 v178, 3, v255
    v_mul_u32_u24 v178, 624, v178
    v_add_u32 v178, 118656, v178
    v_lshrrev_b32 v167, 2, v255
    v_lshl_add_u32 v166, v167, 4, v178
    v_add_u32 v166, 112, v166
    v_max_u32 v167, 9, v167
    v_subrev_u32 v167, 9, v167
    v_lshl_add_u32 v167, v167, 4, v178
    v_mul_u32_u24 v168, 624, v176
    v_lshl_add_u32 v168, v177, 4, v168
    v_add_u32 v168, 118656, v168
    v_add_u32 v178, 0, v255
    v_mul_u32_u24 v170, 1681, v178
    v_lshrrev_b32 v170, 16, v170
    v_mul_u32_u24 v170, 15760, v170
    v_lshl_add_u32 v170, v178, 4, v170
    v_add_u32 v178, 64, v255
    v_mul_u32_u24 v171, 1681, v178
    v_lshrrev_b32 v171, 16, v171
    v_mul_u32_u24 v171, 15760, v171
    v_lshl_add_u32 v171, v178, 4, v171
    v_add_u32 v178, 128, v255
    v_mul_u32_u24 v172, 1681, v178
    v_lshrrev_b32 v172, 16, v172
    v_mul_u32_u24 v172, 15760, v172
    v_lshl_add_u32 v172, v178, 4, v172
    v_add_u32 v178, 192, v255
    v_mul_u32_u24 v173, 1681, v178
    v_lshrrev_b32 v173, 16, v173
    v_mul_u32_u24 v173, 15760, v173
    v_lshl_add_u32 v173, v178, 4, v173
    v_add_u32 v178, 256, v255
    v_mul_u32_u24 v174, 1681, v178
    v_lshrrev_b32 v174, 16, v174
    v_mul_u32_u24 v174, 15760, v174
    v_lshl_add_u32 v174, v178, 4, v174
    v_add_u32 v178, 320, v255
    v_mul_u32_u24 v175, 1681, v178
    v_lshrrev_b32 v175, 16, v175
    v_mul_u32_u24 v175, 15760, v175
    v_lshl_add_u32 v175, v178, 4, v175
    v_mov_b32 v156, 0
    s_mov_b32 exec_lo, 0xffffffff
    s_mov_b32 exec_hi, 0x0
    v_mov_b32 v156, -1
    s_mov_b64 exec, -1
    v_mov_b32 v157, 0
    s_mov_b32 exec_lo, 0xffffffff
    s_mov_b32 exec_hi, 0xffff
    v_mov_b32 v157, -1
    s_mov_b64 exec, -1
    v_mov_b32 v158, 0
    s_mov_b32 exec_lo, 0x0
    s_mov_b32 exec_hi, 0xffffffff
    v_mov_b32 v158, -1
    s_mov_b64 exec, -1
    v_mov_b32 v159, 0
    s_mov_b32 exec_lo, 0xffff0000
    s_mov_b32 exec_hi, 0xffffffff
    v_mov_b32 v159, -1
    s_mov_b64 exec, -1
    v_mov_b32 v179, 0xce6e6b28
    v_lshlrev_b32 v178, 2, v176
    v_sub_u32 v178, v178, v177
    v_cmp_le_i32 s[84:85], 9, v178
    v_add_u32 v180, 7, v178
    v_cmp_gt_u32 s[86:87], 8, v180
    v_cndmask_b32 v144, v179, 0, s[84:85]
    s_nop 1
    v_cndmask_b32 v148, v179, 0, s[86:87]
    v_cmp_le_i32 s[84:85], 8, v178
    v_add_u32 v180, 8, v178
    v_cmp_gt_u32 s[86:87], 8, v180
    v_cndmask_b32 v145, v179, 0, s[84:85]
    s_nop 1
    v_cndmask_b32 v149, v179, 0, s[86:87]
    v_cmp_le_i32 s[84:85], 7, v178
    v_add_u32 v180, 9, v178
    v_cmp_gt_u32 s[86:87], 8, v180
    v_cndmask_b32 v146, v179, 0, s[84:85]
    s_nop 1
    v_cndmask_b32 v150, v179, 0, s[86:87]
    v_cmp_le_i32 s[84:85], 6, v178
    v_add_u32 v180, 10, v178
    v_cmp_gt_u32 s[86:87], 8, v180
    v_cndmask_b32 v147, v179, 0, s[84:85]
    s_nop 1
    v_cndmask_b32 v151, v179, 0, s[86:87]
    v_ashrrev_i32 v180, 31, v144
    v_ashrrev_i32 v181, 31, v145
    v_and_b32 v180, 0xffff, v180
    v_and_b32 v181, 0xffff0000, v181
    v_or_b32 v180, v180, v181
    v_not_b32 v160, v180
    v_ashrrev_i32 v180, 31, v146
    v_ashrrev_i32 v181, 31, v147
    v_and_b32 v180, 0xffff, v180
    v_and_b32 v181, 0xffff0000, v181
    v_or_b32 v180, v180, v181
    v_not_b32 v161, v180
    v_ashrrev_i32 v180, 31, v148
    v_ashrrev_i32 v181, 31, v149
    v_and_b32 v180, 0xffff, v180
    v_and_b32 v181, 0xffff0000, v181
    v_or_b32 v180, v180, v181
    v_not_b32 v162, v180
    v_ashrrev_i32 v180, 31, v150
    v_ashrrev_i32 v181, 31, v151
    v_and_b32 v180, 0xffff, v180
    v_and_b32 v181, 0xffff0000, v181
    v_or_b32 v180, v180, v181
    v_not_b32 v163, v180
    s_lshr_b32 s84, s2, 1
    s_cmp_eq_u32 s84, 96
    s_cselect_b64 s[84:85], -1, 0
    v_cndmask_b32 v152, v144, v179, s[84:85]
    v_cndmask_b32 v153, v145, v179, s[84:85]
    v_cndmask_b32 v154, v146, v179, s[84:85]
    v_cndmask_b32 v155, v147, v179, s[84:85]
    v_cndmask_b32 v165, v165, v164, s[84:85]
    v_cndmask_b32 v167, v167, v166, s[84:85]
    v_lshlrev_b32 v178, 4, v255
    v_add_u32 v178, 0x26000, v178
    ds_write_b128 v178, v[144:147] offset:0
    ds_write_b128 v178, v[148:151] offset:1024
    ds_write_b128 v178, v[152:155] offset:2048
    ds_write_b128 v178, v[156:159] offset:3072
    ds_write_b128 v178, v[160:163] offset:4096
    ds_write_b128 v178, v[164:167] offset:5120
    ds_write_b128 v178, v[168:171] offset:6144
    ds_write_b128 v178, v[172:175] offset:7168
    s_waitcnt lgkmcnt(0)
    s_branch KM_CONSTX
KM_P0F_S:
    s_mov_b32 s47, 0x100000
    s_mov_b64 exec, 1
KM_P0F_L:
    v_mov_b32 v252, 0
    buffer_atomic_add v252, v253, s[24:27], s101 offen offset:0 sc0
    s_waitcnt vmcnt(0)
    v_readfirstlane_b32 s45, v252
    s_sub_u32 s47, s47, 1
    s_cbranch_scc1 KM_P0F_E
    s_cmp_lt_u32 s45, s49
    s_cbranch_scc1 KM_P0F_L
KM_P0F_E:
    s_mov_b64 exec, -1
    s_branch KM_P0F_X
KM_P1_S:
    s_mov_b32 s47, 0x100000
    s_mov_b64 exec, 1
KM_P1_L:
    v_mov_b32 v160, 0
    buffer_atomic_add v160, v161, s[24:27], s101 offen offset:4 sc0
    s_waitcnt vmcnt(0)
    v_readfirstlane_b32 s45, v160
    s_sub_u32 s47, s47, 1
    s_cbranch_scc1 KM_P1_E
    s_cmp_lt_u32 s45, s49
    s_cbranch_scc1 KM_P1_L
KM_P1_E:
    s_mov_b64 exec, -1
    s_branch KM_P1_X
KM_P2_S:
    s_mov_b32 s47, 0x100000
    s_mov_b64 exec, 1
KM_P2_L:
    v_mov_b32 v160, 0
    buffer_atomic_add v160, v161, s[24:27], s101 offen offset:8 sc0
    s_waitcnt vmcnt(0)
    v_readfirstlane_b32 s45, v160
    s_sub_u32 s47, s47, 1
    s_cbranch_scc1 KM_P2_E
    s_cmp_lt_u32 s45, s49
    s_cbranch_scc1 KM_P2_L
KM_P2_E:
    s_mov_b64 exec, -1
    s_branch KM_P2_X
KM_P0A_S:
    s_mov_b32 s47, 0x100000
    s_mov_b64 exec, 1
KM_P0A_L:
    v_mov_b32 v252, 0
    buffer_atomic_add v252, v253, s[24:27], s101 offen offset:0 sc0
    s_waitcnt vmcnt(0)
    v_readfirstlane_b32 s45, v252
    s_sub_u32 s47, s47, 1
    s_cbranch_scc1 KM_P0A_E
    s_cmp_lt_u32 s45, s49
    s_cbranch_scc1 KM_P0A_L
KM_P0A_E:
    s_mov_b64 exec, -1
    s_branch KM_P0A_X
KM_END:
    s_endpgm
.section .rodata,"a"
.p2align 6
.amdhsa_kernel k0_ln_kernel
  .amdhsa_next_free_vgpr 64
  .amdhsa_next_free_sgpr 64
  .amdhsa_accum_offset 64
  .amdhsa_group_segment_fixed_size 0
  .amdhsa_kernarg_size 80
  .amdhsa_user_sgpr_count 2
  .amdhsa_user_sgpr_kernarg_segment_ptr 1
  .amdhsa_system_sgpr_workgroup_id_x 1
.end_amdhsa_kernel
.section .rodata,"a"
.p2align 6
.amdhsa_kernel km_main_kernel
  .amdhsa_next_free_vgpr 256
  .amdhsa_next_free_sgpr 102
  .amdhsa_accum_offset 256
  .amdhsa_group_segment_fixed_size 0
  .amdhsa_kernarg_size 80
  .amdhsa_user_sgpr_count 2
  .amdhsa_user_sgpr_kernarg_segment_ptr 1
  .amdhsa_system_sgpr_workgroup_id_x 1
.end_amdhsa_kernel
```
